```python
import torch

def _softmax(x, axis=-1):
    return torch.softmax(x, dim=axis)
def _gelu(x):
    return torch.nn.functional.gelu(x, approximate="tanh")
def _silu(x):
    return torch.nn.functional.silu(x)
def _sigmoid(x):
    return torch.sigmoid(x)
def _layernorm(x, axis=-1, eps=1e-5):
    m = x.mean(dim=axis, keepdim=True)
    v = x.var(dim=axis, keepdim=True, unbiased=False)
    return (x - m) / torch.sqrt(v + eps)
def _scatter_add(tgt, idx, src, axis=0):
    return tgt.clone().index_add_(axis, idx, src)
def _segment_sum(src, seg, n):
    out = torch.zeros((n,) + src.shape[1:], dtype=src.dtype)
    return out.index_add_(0, seg, src)
def _pad(x, pw):
    flat = tuple(v for pair in reversed(pw) for v in pair)
    return torch.nn.functional.pad(x, flat)

kernel_name = 'parallel_sum__compressed_kv_cla__dense_activation_squared_relu__prompt'

def setup_inputs():

    _w = (lambda a: (lambda t: t.to(torch.bfloat16) if t.is_floating_point() else t)(torch.as_tensor(a)))
    def _A_setup():
        B, H, Sq, Sk, D, M = 1, 16, 2048, 2048, 256, 448
        Dc = 4 * D
        return {
            "x": _w((lambda *s: torch.randn(*s, dtype=torch.bfloat16) * 0.05)(B, Sq, M)),
            "c_kv": _w((lambda *s: torch.randn(*s, dtype=torch.bfloat16) * 1.6)(B, Sk, Dc)),
            "w_q": _w((lambda *s: torch.randn(*s, dtype=torch.bfloat16) * 0.8)(M, H, D) * (M ** -0.5)),
            "w_uk": _w((lambda *s: torch.randn(*s, dtype=torch.bfloat16) * 0.8)(Dc, H, D) * (Dc ** -0.5)),
            "w_uv": _w((lambda *s: torch.randn(*s, dtype=torch.bfloat16) * 1.6)(Dc, H, D) * (Dc ** -0.5)),
            "w_o": _w((lambda *s: torch.randn(*s, dtype=torch.bfloat16) * 1.6)(H, D, M) * ((H * D) ** -0.5)),
        }
    _A_in = _A_setup()

    def _B_setup():
        B, S, D, F = 1, 2048, 448, 1792
        return {
            "x": _w((lambda *s: torch.randn(*s, dtype=torch.bfloat16) * 0.05)(B, S, D)),
            "w1": _w((lambda *s: torch.randn(*s, dtype=torch.bfloat16) * 0.05)(D, F)),
            "b1": _w((lambda *s: torch.randn(*s, dtype=torch.bfloat16) * 0.2)(F)),
            "w2": _w((lambda *s: torch.randn(*s, dtype=torch.bfloat16) * 0.05)(F, D)),
            "b2": _w((lambda *s: torch.randn(*s, dtype=torch.bfloat16) * 0.8)(D)),
        }
    _B_in = _B_setup()

    return {
        "A_x": _A_in["x"],
        "A_c_kv": _A_in["c_kv"],
        "A_w_q": _A_in["w_q"],
        "A_w_uk": _A_in["w_uk"],
        "A_w_uv": _A_in["w_uv"],
        "A_w_o": _A_in["w_o"],
        "B_x": _B_in["x"],
        "B_w1": _B_in["w1"],
        "B_b1": _B_in["b1"],
        "B_w2": _B_in["w2"],
        "B_b2": _B_in["b2"],
    }

def reference(A_x, A_c_kv, A_w_q, A_w_uk, A_w_uv, A_w_o, B_x, B_w1, B_b1, B_w2, B_b2):
    def _A_ref(x, c_kv, w_q, w_uk, w_uv, w_o):
        B, Sq, M = x.shape[0], x.shape[1], x.shape[2]
        Sk = c_kv.shape[1]
        H, D = w_q.shape[1], w_q.shape[2]
        q = torch.einsum("bqm,mhd->bhqd", x, w_q)
        k = torch.einsum("bkc,chd->bhkd", c_kv, w_uk)
        v = torch.einsum("bkc,chd->bhkd", c_kv, w_uv)
        scores = torch.einsum("bhqd,bhkd->bhqk", q, k) * (D ** -0.5)
        off = Sk - Sq
        qi = torch.arange(Sq)[:, None]
        kj = torch.arange(Sk)[None, :]
        cmask = kj <= (qi + off)
        scores = torch.where(cmask[None, None], scores, -1e9)
        p = _softmax(scores, axis=-1)
        ctx = torch.einsum("bhqk,bhkd->bhqd", p, v)
        return torch.einsum("bhqd,hdm->bqm", ctx, w_o)

    def _B_ref(x, w1, b1, w2, b2):
        h = torch.einsum("bsd,df->bsf", x, w1) + b1
        zero = torch.zeros_like(h)
        r = torch.where(h > zero, h, zero)
        h = r * r
        out = torch.einsum("bsf,fd->bsd", h, w2) + b2
        return out

    x = A_x
    xn = _layernorm(x, axis=-1)
    return x + _A_ref(xn, A_c_kv, A_w_q, A_w_uk, A_w_uv, A_w_o) + _B_ref(xn, B_w1, B_b1, B_w2, B_b2)
```

```asm
; @launch grid=(256,1,1) block=(256,1,1) lds=163840
.amdgcn_target "amdgcn-amd-amdhsa--gfx950"
.macro AR d,s
v_accvgpr_read_b32 v\d, a\s
.endm
.macro CV d,x,y
v_cvt_pk_bf16_f32 v\d, v\x, v\y
.endm
.macro RT d,a,o
ds_read_b64_tr_b16 v[\d:\d+1], v\a offset:\o
.endm
.macro LW n
s_waitcnt lgkmcnt(\n)
.endm
.macro Mavvz d,x,y
v_mfma_f32_16x16x32_bf16 a[\d:\d+3], v[\x:\x+3], v[\y:\y+3], 0
.endm
.macro Mavvs d,x,y
v_mfma_f32_16x16x32_bf16 a[\d:\d+3], v[\x:\x+3], v[\y:\y+3], a[\d:\d+3]
.endm
.macro AW d,s
v_accvgpr_write_b32 a\d, \s
.endm
.macro R4 d,a,o
ds_read_b128 v[\d:\d+3], v\a offset:\o
.endm
.macro Mvvac d,x,y,c
v_mfma_f32_16x16x32_bf16 v[\d:\d+3], v[\x:\x+3], a[\y:\y+3], v[\c:\c+3]
.endm
.macro Mvvas d,x,y
v_mfma_f32_16x16x32_bf16 v[\d:\d+3], v[\x:\x+3], a[\y:\y+3], v[\d:\d+3]
.endm
.macro Mvvvs d,x,y
v_mfma_f32_16x16x32_bf16 v[\d:\d+3], v[\x:\x+3], v[\y:\y+3], v[\d:\d+3]
.endm
.macro Mvvvc d,x,y,c
v_mfma_f32_16x16x32_bf16 v[\d:\d+3], v[\x:\x+3], v[\y:\y+3], v[\c:\c+3]
.endm
.macro Mvvvz d,x,y
v_mfma_f32_16x16x32_bf16 v[\d:\d+3], v[\x:\x+3], v[\y:\y+3], 0
.endm
.text
.p2align 8
M_CODE_START:
OD_21:
s_nop 7
s_nop 0
AR 208,64
AR 209,65
AR 210,66
AR 211,67
AR 212,68
AR 213,69
AR 214,70
AR 215,71
v_mul_f32 v208, s100, v208
v_mul_f32 v209, s100, v209
v_mul_f32 v210, s100, v210
v_mul_f32 v211, s100, v211
v_mul_f32 v212, s100, v212
v_mul_f32 v213, s100, v213
v_mul_f32 v214, s100, v214
v_mul_f32 v215, s100, v215
CV 64,208,209
CV 65,210,211
CV 66,212,213
CV 67,214,215
s_add_u32 s62, s62, s89
s_nop 0
buffer_store_dwordx4 v[64:67], v4, s[4:7], s62 offen sc1
AR 216,72
AR 217,73
AR 218,74
AR 219,75
AR 220,76
AR 221,77
AR 222,78
AR 223,79
v_mul_f32 v216, s100, v216
v_mul_f32 v217, s100, v217
v_mul_f32 v218, s100, v218
v_mul_f32 v219, s100, v219
v_mul_f32 v220, s100, v220
v_mul_f32 v221, s100, v221
v_mul_f32 v222, s100, v222
v_mul_f32 v223, s100, v223
CV 68,216,217
CV 69,218,219
CV 70,220,221
CV 71,222,223
s_add_u32 s62, s62, s86
s_nop 0
buffer_store_dwordx4 v[68:71], v4, s[4:7], s62 offen sc1
AR 208,80
AR 209,81
AR 210,82
AR 211,83
AR 212,84
AR 213,85
AR 214,86
AR 215,87
v_mul_f32 v208, s100, v208
v_mul_f32 v209, s100, v209
v_mul_f32 v210, s100, v210
v_mul_f32 v211, s100, v211
v_mul_f32 v212, s100, v212
v_mul_f32 v213, s100, v213
v_mul_f32 v214, s100, v214
v_mul_f32 v215, s100, v215
CV 72,208,209
CV 73,210,211
CV 74,212,213
CV 75,214,215
s_add_u32 s62, s62, s87
s_nop 0
buffer_store_dwordx4 v[72:75], v4, s[4:7], s62 offen sc1
AR 216,88
AR 217,89
AR 218,90
AR 219,91
AR 220,92
AR 221,93
AR 222,94
AR 223,95
v_mul_f32 v216, s100, v216
v_mul_f32 v217, s100, v217
v_mul_f32 v218, s100, v218
v_mul_f32 v219, s100, v219
v_mul_f32 v220, s100, v220
v_mul_f32 v221, s100, v221
v_mul_f32 v222, s100, v222
v_mul_f32 v223, s100, v223
CV 76,216,217
CV 77,218,219
CV 78,220,221
CV 79,222,223
s_add_u32 s62, s62, s86
s_nop 0
buffer_store_dwordx4 v[76:79], v4, s[4:7], s62 offen sc1
AR 208,96
AR 209,97
AR 210,98
AR 211,99
AR 212,100
AR 213,101
AR 214,102
AR 215,103
v_mul_f32 v208, s100, v208
v_mul_f32 v209, s100, v209
v_mul_f32 v210, s100, v210
v_mul_f32 v211, s100, v211
v_mul_f32 v212, s100, v212
v_mul_f32 v213, s100, v213
v_mul_f32 v214, s100, v214
v_mul_f32 v215, s100, v215
CV 80,208,209
CV 81,210,211
CV 82,212,213
CV 83,214,215
s_add_u32 s62, s62, s88
s_nop 0
buffer_store_dwordx4 v[80:83], v4, s[4:7], s62 offen sc1
AR 216,104
AR 217,105
AR 218,106
AR 219,107
AR 220,108
AR 221,109
AR 222,110
AR 223,111
v_mul_f32 v216, s100, v216
v_mul_f32 v217, s100, v217
v_mul_f32 v218, s100, v218
v_mul_f32 v219, s100, v219
v_mul_f32 v220, s100, v220
v_mul_f32 v221, s100, v221
v_mul_f32 v222, s100, v222
v_mul_f32 v223, s100, v223
CV 84,216,217
CV 85,218,219
CV 86,220,221
CV 87,222,223
s_add_u32 s62, s62, s86
s_nop 0
buffer_store_dwordx4 v[84:87], v4, s[4:7], s62 offen sc1
AR 208,112
AR 209,113
AR 210,114
AR 211,115
AR 212,116
AR 213,117
AR 214,118
AR 215,119
v_mul_f32 v208, s100, v208
v_mul_f32 v209, s100, v209
v_mul_f32 v210, s100, v210
v_mul_f32 v211, s100, v211
v_mul_f32 v212, s100, v212
v_mul_f32 v213, s100, v213
v_mul_f32 v214, s100, v214
v_mul_f32 v215, s100, v215
CV 88,208,209
CV 89,210,211
CV 90,212,213
CV 91,214,215
AR 216,120
AR 217,121
AR 218,122
AR 219,123
AR 220,124
AR 221,125
AR 222,126
AR 223,127
v_mul_f32 v216, s100, v216
v_mul_f32 v217, s100, v217
v_mul_f32 v218, s100, v218
v_mul_f32 v219, s100, v219
v_mul_f32 v220, s100, v220
v_mul_f32 v221, s100, v221
v_mul_f32 v222, s100, v222
v_mul_f32 v223, s100, v223
CV 92,216,217
CV 93,218,219
CV 94,220,221
CV 95,222,223
s_waitcnt vmcnt(38)
s_barrier
RT 192,240,0
RT 194,240,2048
RT 196,241,0
RT 198,241,2048
RT 200,242,0
RT 202,242,2048
RT 204,243,0
RT 206,243,2048
RT 208,244,0
RT 210,244,2048
RT 212,245,0
RT 214,245,2048
LW 8
Mavvz 0,192,160
RT 216,246,0
s_add_u32 s75, s71, 4096
Mavvz 4,192,164
RT 218,246,2048
AR 16,128
Mavvz 8,196,160
RT 220,247,0
AR 17,129
AR 18,130
Mavvz 12,196,164
LW 7
RT 222,247,2048
AR 19,131
AR 20,132
AR 21,133
AR 22,134
Mavvz 16,200,160
buffer_load_dwordx4 v[32:35], v10, s[4:7], s75 offen offset:0 sc1
Mavvz 20,200,164
RT 192,240,256
RT 194,240,2304
Mavvz 24,204,160
RT 196,241,256
AR 23,135
v_mul_f32 v16, s100, v16
v_mul_f32 v17, s100, v17
Mavvz 28,204,164
LW 7
RT 198,241,2304
v_mul_f32 v18, s100, v18
v_mul_f32 v19, s100, v19
v_mul_f32 v20, s100, v20
v_mul_f32 v21, s100, v21
v_mul_f32 v22, s100, v22
v_mul_f32_e64 v23, s100, v23
CV 96,16,17
CV 97,18,19
CV 98,20,21
CV 99,22,23
Mavvz 32,208,160
buffer_load_dwordx4 v[36:39], v11, s[4:7], s75 offen offset:0 sc1
Mavvz 36,208,164
RT 200,242,256
RT 202,242,2304
Mavvz 40,212,160
RT 204,243,256
AR 16,136
AR 17,137
AR 18,138
Mavvz 44,212,164
LW 7
s_nop 0
RT 206,243,2304
AR 19,139
AR 20,140
AR 21,141
AR 22,142
AR 23,143
v_mul_f32 v16, s100, v16
v_mul_f32 v17, s100, v17
v_mul_f32 v18, s100, v18
v_mul_f32 v19, s100, v19
v_mul_f32 v20, s100, v20
v_mul_f32 v21, s100, v21
v_mul_f32 v22, s100, v22
v_mul_f32 v23, s100, v23
Mavvz 48,216,160
buffer_load_dwordx4 v[40:43], v10, s[4:7], s75 offen offset:1024 sc1
Mavvz 52,216,164
RT 208,244,256
RT 210,244,2304
Mavvz 56,220,160
RT 212,245,256
buffer_load_dwordx4 v[44:47], v11, s[4:7], s75 offen offset:1024 sc1
Mavvz 60,220,164
LW 7
RT 214,245,2304
CV 100,16,17
CV 101,18,19
CV 102,20,21
Mavvz 64,192,160
s_nop 0
RT 216,246,256
s_add_u32 m0, s52, 49152
CV 103,22,23
AR 16,144
AR 17,145
AR 18,146
AR 19,147
AR 20,148
AR 21,149
Mavvz 68,192,164
s_waitcnt vmcnt(24)
s_barrier
RT 218,246,2304
Mavvz 72,196,160
RT 220,247,256
s_mov_b32 s74, 786432
AR 22,150
AR 23,151
v_mul_f32_e64 v16, s100, v16
Mavvz 76,196,164
LW 7
RT 222,247,2304
v_mul_f32 v17, s100, v17
v_mul_f32 v18, s100, v18
v_mul_f32 v19, s100, v19
v_mul_f32 v20, s100, v20
v_mul_f32 v21, s100, v21
v_mul_f32 v22, s100, v22
v_mul_f32 v23, s100, v23
CV 104,16,17
CV 105,18,19
Mavvz 80,200,160
buffer_load_dwordx4 v12, s[16:19], s74 offen lds
Mavvz 84,200,164
RT 192,240,16384
RT 194,240,18432
Mavvz 88,204,160
RT 196,241,16384
CV 106,20,21
CV 107,22,23
AR 16,152
AR 17,153
Mavvz 92,204,164
LW 7
s_nop 0
RT 198,241,18432
AR 18,154
AR 19,155
AR 20,156
AR 21,157
AR 22,158
AR 23,159
v_mul_f32 v16, s100, v16
v_mul_f32 v17, s100, v17
v_mul_f32_e64 v18, s100, v18
Mavvz 96,208,160
buffer_load_dwordx4 v13, s[16:19], s74 offen offset:1024 lds
Mavvz 100,208,164
RT 200,242,16384
RT 202,242,18432
Mavvz 104,212,160
RT 204,243,16384
v_mul_f32 v19, s100, v19
v_mul_f32 v20, s100, v20
v_mul_f32_e64 v21, s100, v21
Mavvz 108,212,164
LW 7
s_nop 0
RT 206,243,18432
v_mul_f32 v22, s100, v22
v_mul_f32 v23, s100, v23
CV 108,16,17
CV 109,18,19
CV 110,20,21
CV 111,22,23
AR 16,160
AR 17,161
AR 18,162
AR 19,163
Mavvz 112,216,160
buffer_load_dwordx4 v14, s[16:19], s74 offen offset:2048 lds
Mavvz 116,216,164
RT 208,244,16384
RT 210,244,18432
Mavvz 120,220,160
RT 212,245,16384
AR 20,164
AR 21,165
AR 22,166
Mavvz 124,220,164
LW 7
RT 214,245,18432
AR 23,167
v_mul_f32 v16, s100, v16
v_mul_f32 v17, s100, v17
v_mul_f32 v18, s100, v18
v_mul_f32 v19, s100, v19
v_mul_f32 v20, s100, v20
v_mul_f32 v21, s100, v21
v_mul_f32 v22, s100, v22
v_mul_f32_e64 v23, s100, v23
CV 112,16,17
Mavvs 0,192,168
buffer_load_dwordx4 v15, s[16:19], s74 offen offset:3072 lds
Mavvs 4,192,172
RT 216,246,16384
RT 218,246,18432
Mavvs 8,196,168
RT 220,247,16384
s_add_u32 m0, s53, 122880
CV 113,18,19
CV 114,20,21
CV 115,22,23
Mavvs 12,196,172
LW 7
RT 222,247,18432
AR 16,168
AR 17,169
AR 18,170
Mavvs 16,200,168
s_nop 0
RT 192,240,16640
s_mov_b32 s74, 344064
s_add_u32 s62, s62, s87
s_nop 0
buffer_store_dwordx4 v[88:91], v4, s[4:7], s62 offen sc1
AR 19,171
AR 20,172
AR 21,173
AR 22,174
AR 23,175
v_mul_f32 v16, s100, v16
v_mul_f32 v17, s100, v17
Mavvs 20,200,172
RT 194,240,18688
buffer_load_dwordx4 v28, s[20:23], s74 offen lds
Mavvs 24,204,168
RT 196,241,16640
s_add_u32 s62, s62, s86
v_mul_f32 v18, s100, v18
v_mul_f32 v19, s100, v19
v_mul_f32 v20, s100, v20
Mavvs 28,204,172
LW 7
RT 198,241,18688
buffer_store_dwordx4 v[92:95], v4, s[4:7], s62 offen sc1
v_mul_f32 v21, s100, v21
v_mul_f32 v22, s100, v22
v_mul_f32 v23, s100, v23
CV 116,16,17
CV 117,18,19
CV 118,20,21
CV 119,22,23
s_waitcnt vmcnt(41)
v_lshlrev_b32 v2, 16, v224
v_and_b32 v3, 0xffff0000, v224
Mavvs 32,208,168
buffer_load_dwordx4 v29, s[20:23], s74 offen offset:1024 lds
Mavvs 36,208,172
RT 200,242,16640
RT 202,242,18688
Mavvs 40,212,168
RT 204,243,16640
s_add_u32 s62, s62, s89
AW 128,v2
AW 129,v3
AW 132,v2
Mavvs 44,212,172
LW 7
RT 206,243,18688
AW 133,v3
v_lshlrev_b32_e64 v2, 16, v225
v_and_b32 v3, 0xffff0000, v225
Mavvs 48,216,168
RT 208,244,16640
buffer_store_dwordx4 v[96:99], v4, s[4:7], s62 offen sc1
AW 130,v2
AW 131,v3
AW 134,v2
Mavvs 52,216,172
RT 210,244,18688
AW 135,v3
v_lshlrev_b32_e64 v2, 16, v226
v_and_b32 v3, 0xffff0000, v226
AW 136,v2
Mavvs 56,220,168
RT 212,245,16640
AW 137,v3
AW 140,v2
AW 141,v3
Mavvs 60,220,172
LW 7
RT 214,245,18688
s_add_u32 s62, s62, s86
v_lshlrev_b32_e64 v2, 16, v227
v_and_b32 v3, 0xffff0000, v227
AW 138,v2
Mavvs 64,192,168
RT 216,246,16640
buffer_store_dwordx4 v[100:103], v4, s[4:7], s62 offen sc1
AW 139,v3
AW 142,v2
AW 143,v3
Mavvs 68,192,172
RT 218,246,18688
v_lshlrev_b32_e64 v2, 16, v228
v_and_b32 v3, 0xffff0000, v228
AW 144,v2
Mavvs 72,196,168
RT 220,247,16640
AW 145,v3
AW 148,v2
AW 149,v3
v_lshlrev_b32_e64 v2, 16, v229
Mavvs 76,196,172
LW 7
RT 222,247,18688
s_add_u32 s62, s62, s87
v_and_b32 v3, 0xffff0000, v229
AW 146,v2
AW 147,v3
Mavvs 80,200,168
RT 192,248,0
AW 150,v2
AW 151,v3
v_lshlrev_b32_e64 v2, 16, v230
Mavvs 84,200,172
RT 194,248,1024
buffer_store_dwordx4 v[104:107], v4, s[4:7], s62 offen sc1
v_and_b32 v3, 0xffff0000, v230
AW 152,v2
AW 153,v3
Mavvs 88,204,168
RT 196,249,0
AW 156,v2
AW 157,v3
v_lshlrev_b32_e64 v2, 16, v231
v_and_b32 v3, 0xffff0000, v231
Mavvs 92,204,172
LW 7
RT 198,249,1024
AW 154,v2
AW 155,v3
AW 158,v2
Mavvs 96,208,168
RT 200,250,0
AW 159,v3
v_lshlrev_b32 v2, 16, v232
v_and_b32 v3, 0xffff0000, v232
Mavvs 100,208,172
RT 202,250,1024
AW 160,v2
AW 161,v3
AW 164,v2
Mavvs 104,212,168
RT 204,251,0
AW 165,v3
v_lshlrev_b32_e64 v2, 16, v233
v_and_b32 v3, 0xffff0000, v233
Mavvs 108,212,172
LW 7
s_nop 0
RT 206,251,1024
AW 162,v2
AW 163,v3
AW 166,v2
AW 167,v3
v_lshlrev_b32_e64 v2, 16, v234
v_and_b32 v3, 0xffff0000, v234
AW 168,v2
AW 169,v3
AW 172,v2
AW 173,v3
v_lshlrev_b32_e64 v2, 16, v235
v_and_b32 v3, 0xffff0000, v235
AW 170,v2
AW 171,v3
AW 174,v2
AW 175,v3
Mavvs 112,216,168
RT 208,252,0
s_add_u32 s62, s62, s86
Mavvs 116,216,172
RT 210,252,1024
buffer_store_dwordx4 v[108:111], v4, s[4:7], s62 offen sc1
Mavvs 120,220,168
RT 212,253,0
s_add_u32 s62, s62, s88
Mavvs 124,220,172
LW 7
RT 214,253,1024
Mavvs 128,192,160
buffer_store_dwordx4 v[112:115], v4, s[4:7], s62 offen sc1
Mavvs 132,192,164
RT 216,248,8192
RT 218,248,9216
Mavvs 136,196,160
RT 220,249,8192
s_add_u32 s62, s62, s86
Mavvs 140,196,164
LW 7
RT 222,249,9216
Mavvs 144,200,160
buffer_store_dwordx4 v[116:119], v4, s[4:7], s62 offen sc1
Mavvs 148,200,164
RT 192,250,8192
RT 194,250,9216
Mavvs 152,204,160
RT 196,251,8192
s_add_u32 s62, s62, s87
Mavvs 156,204,164
LW 7
RT 198,251,9216
Mavvs 160,208,160
RT 200,252,8192
AR 16,176
Mavvs 164,208,164
s_waitcnt vmcnt(32)
s_barrier
RT 202,252,9216
Mavvs 168,212,160
RT 204,253,8192
s_add_u32 m0, s52, 0
Mavvs 172,212,164
LW 7
RT 206,253,9216
Mavvs 128,216,168
RT 208,240,32768
s_mov_b32 s74, 1048576
Mavvs 132,216,172
RT 210,240,34816
AR 17,177
Mavvs 136,220,168
RT 212,241,32768
AR 18,178
AR 19,179
Mavvs 140,220,172
LW 7
RT 214,241,34816
AR 20,180
Mavvs 144,192,168
buffer_load_dwordx4 v12, s[16:19], s74 offen lds
Mavvs 148,192,172
RT 216,242,32768
RT 218,242,34816
Mavvs 152,196,168
RT 220,243,32768
AR 21,181
AR 22,182
Mavvs 156,196,172
LW 7
RT 222,243,34816
AR 23,183
v_mul_f32 v16, s100, v16
Mavvs 160,200,168
buffer_load_dwordx4 v13, s[16:19], s74 offen offset:1024 lds
Mavvs 164,200,172
RT 192,244,32768
RT 194,244,34816
Mavvs 168,204,168
RT 196,245,32768
v_mul_f32 v17, s100, v17
v_mul_f32 v18, s100, v18
Mavvs 172,204,172
LW 7
RT 198,245,34816
v_mul_f32 v19, s100, v19
Mavvs 0,208,176
buffer_load_dwordx4 v14, s[16:19], s74 offen offset:2048 lds
Mavvs 4,208,180
RT 200,246,32768
RT 202,246,34816
Mavvs 8,212,176
RT 204,247,32768
v_mul_f32 v20, s100, v20
v_mul_f32 v21, s100, v21
Mavvs 12,212,180
LW 7
RT 206,247,34816
Mavvs 16,216,176
RT 208,240,33024
v_mul_f32 v22, s100, v22
Mavvs 20,216,180
RT 210,240,35072
v_mul_f32_e64 v23, s100, v23
Mavvs 24,220,176
RT 212,241,33024
CV 120,16,17
CV 121,18,19
Mavvs 28,220,180
LW 7
RT 214,241,35072
CV 122,20,21
Mavvs 32,192,176
buffer_load_dwordx4 v15, s[16:19], s74 offen offset:3072 lds
Mavvs 36,192,180
RT 216,242,33024
RT 218,242,35072
Mavvs 40,196,176
RT 220,243,33024
s_add_u32 m0, s53, 131072
CV 123,22,23
Mavvs 44,196,180
LW 7
RT 222,243,35072
buffer_store_dwordx4 v[120:123], v4, s[4:7], s62 offen sc1
Mavvs 48,200,176
RT 192,244,33024
s_mov_b32 s74, 458752
Mavvs 52,200,180
RT 194,244,35072
s_add_u32 s62, s62, s86
Mavvs 56,204,176
RT 196,245,33024
AR 16,184
AR 17,185
Mavvs 60,204,180
LW 7
RT 198,245,35072
AR 18,186
Mavvs 64,208,176
buffer_load_dwordx4 v28, s[20:23], s74 offen lds
Mavvs 68,208,180
RT 200,246,33024
RT 202,246,35072
Mavvs 72,212,176
RT 204,247,33024
AR 19,187
AR 20,188
Mavvs 76,212,180
LW 7
RT 206,247,35072
AR 21,189
Mavvs 80,216,176
buffer_load_dwordx4 v29, s[20:23], s74 offen offset:1024 lds
Mavvs 84,216,180
RT 208,248,16384
RT 210,248,17408
Mavvs 88,220,176
RT 212,249,16384
AR 22,190
AR 23,191
Mavvs 92,220,180
LW 7
RT 214,249,17408
Mavvs 96,192,176
RT 216,250,16384
v_mul_f32_e64 v16, s100, v16
Mavvs 100,192,180
RT 218,250,17408
v_mul_f32_e64 v17, s100, v17
Mavvs 104,196,176
RT 220,251,16384
v_mul_f32_e64 v18, s100, v18
Mavvs 108,196,180
LW 7
RT 222,251,17408
Mavvs 112,200,176
RT 192,252,16384
v_mul_f32 v19, s100, v19
v_mul_f32_e64 v20, s100, v20
Mavvs 116,200,180
s_waitcnt vmcnt(13)
s_barrier
RT 194,252,17408
Mavvs 120,204,176
RT 196,253,16384
s_add_u32 s75, s71, 6144
v_mul_f32_e64 v21, s100, v21
Mavvs 124,204,180
LW 7
RT 198,253,17408
v_mul_f32 v22, s100, v22
v_mul_f32_e64 v23, s100, v23
CV 124,16,17
Mavvs 128,208,176
buffer_load_dwordx4 v[48:51], v10, s[4:7], s75 offen offset:0 sc1
Mavvs 132,208,180
RT 200,240,49152
RT 202,240,51200
Mavvs 136,212,176
RT 204,241,49152
CV 125,18,19
CV 126,20,21
Mavvs 140,212,180
LW 7
RT 206,241,51200
CV 127,22,23
Mavvs 144,216,176
buffer_load_dwordx4 v[52:55], v11, s[4:7], s75 offen offset:0 sc1
Mavvs 148,216,180
RT 208,242,49152
RT 210,242,51200
Mavvs 152,220,176
RT 212,243,49152
buffer_store_dwordx4 v[124:127], v4, s[4:7], s62 offen sc1
Mavvs 156,220,180
LW 7
RT 214,243,51200
s_add_u32 s62, s62, s89
Mavvs 160,192,176
buffer_load_dwordx4 v[56:59], v10, s[4:7], s75 offen offset:1024 sc1
Mavvs 164,192,180
RT 216,244,49152
RT 218,244,51200
Mavvs 168,196,176
RT 220,245,49152
AR 16,192
AR 17,193
Mavvs 172,196,180
LW 7
RT 222,245,51200
AR 18,194
AR 19,195
Mavvs 0,200,184
buffer_load_dwordx4 v[60:63], v11, s[4:7], s75 offen offset:1024 sc1
Mavvs 4,200,188
RT 192,246,49152
RT 194,246,51200
Mavvs 8,204,184
RT 196,247,49152
s_add_u32 m0, s52, 16384
AR 20,196
Mavvs 12,204,188
LW 7
RT 198,247,51200
AR 21,197
Mavvs 16,208,184
RT 200,240,49408
s_mov_b32 s74, 1310720
Mavvs 20,208,188
RT 202,240,51456
AR 22,198
Mavvs 24,212,184
RT 204,241,49408
AR 23,199
v_mul_f32 v16, s100, v16
Mavvs 28,212,188
LW 7
RT 206,241,51456
v_mul_f32 v17, s100, v17
v_mul_f32 v18, s100, v18
v_mul_f32 v19, s100, v19
Mavvs 32,216,184
buffer_load_dwordx4 v12, s[16:19], s74 offen lds
Mavvs 36,216,188
RT 208,242,49408
RT 210,242,51456
Mavvs 40,220,184
RT 212,243,49408
buffer_load_dwordx4 v13, s[16:19], s74 offen offset:1024 lds
Mavvs 44,220,188
LW 7
RT 214,243,51456
v_mul_f32 v20, s100, v20
v_mul_f32_e64 v21, s100, v21
Mavvs 48,192,184
buffer_load_dwordx4 v14, s[16:19], s74 offen offset:2048 lds
Mavvs 52,192,188
RT 216,244,49408
RT 218,244,51456
Mavvs 56,196,184
RT 220,245,49408
v_mul_f32 v22, s100, v22
v_mul_f32 v23, s100, v23
Mavvs 60,196,188
LW 7
RT 222,245,51456
CV 128,16,17
CV 129,18,19
Mavvs 64,200,184
buffer_load_dwordx4 v15, s[16:19], s74 offen offset:3072 lds
Mavvs 68,200,188
RT 192,246,49408
RT 194,246,51456
Mavvs 72,204,184
RT 196,247,49408
s_add_u32 m0, s53, 139264
CV 130,20,21
Mavvs 76,204,188
LW 7
RT 198,247,51456
CV 131,22,23
Mavvs 80,208,184
RT 200,248,24576
s_mov_b32 s74, 573440
buffer_store_dwordx4 v[128:131], v4, s[4:7], s62 offen sc1
Mavvs 84,208,188
RT 202,248,25600
s_add_u32 s62, s62, s86
Mavvs 88,212,184
RT 204,249,24576
AR 16,200
AR 17,201
Mavvs 92,212,188
LW 7
RT 206,249,25600
AR 18,202
Mavvs 96,216,184
buffer_load_dwordx4 v28, s[20:23], s74 offen lds
Mavvs 100,216,188
RT 208,250,24576
RT 210,250,25600
Mavvs 104,220,184
RT 212,251,24576
buffer_load_dwordx4 v29, s[20:23], s74 offen offset:1024 lds
Mavvs 108,220,188
LW 7
RT 214,251,25600
Mavvs 112,192,184
RT 216,252,24576
AR 19,203
AR 20,204
Mavvs 116,192,188
s_waitcnt vmcnt(12)
s_barrier
RT 218,252,25600
Mavvs 120,196,184
RT 220,253,24576
s_add_u32 m0, s52, 32768
AR 21,205
Mavvs 124,196,188
LW 7
RT 222,253,25600
AR 22,206
Mavvs 128,200,184
RT 192,240,0
s_mov_b32 s74, 1572864
Mavvs 132,200,188
RT 194,240,2048
AR 23,207
Mavvs 136,204,184
RT 196,241,0
v_mul_f32 v16, s100, v16
v_mul_f32 v17, s100, v17
Mavvs 140,204,188
LW 7
RT 198,241,2048
v_mul_f32 v18, s100, v18
v_mul_f32_e64 v19, s100, v19
Mavvs 144,208,184
buffer_load_dwordx4 v12, s[16:19], s74 offen lds
Mavvs 148,208,188
RT 200,242,0
RT 202,242,2048
Mavvs 152,212,184
RT 204,243,0
v_mul_f32 v20, s100, v20
v_mul_f32 v21, s100, v21
Mavvs 156,212,188
LW 7
RT 206,243,2048
v_mul_f32 v22, s100, v22
Mavvs 160,216,184
buffer_load_dwordx4 v13, s[16:19], s74 offen offset:1024 lds
Mavvs 164,216,188
RT 208,244,0
RT 210,244,2048
Mavvs 168,220,184
RT 212,245,0
v_mul_f32_e64 v23, s100, v23
CV 132,16,17
Mavvs 172,220,188
LW 7
RT 214,245,2048
CV 133,18,19
CV 134,20,21
Mavvs 0,192,32
buffer_load_dwordx4 v14, s[16:19], s74 offen offset:2048 lds
Mavvs 4,192,36
RT 216,246,0
RT 218,246,2048
Mavvs 8,196,32
RT 220,247,0
CV 135,22,23
buffer_store_dwordx4 v[132:135], v4, s[4:7], s62 offen sc1
Mavvs 12,196,36
LW 7
RT 222,247,2048
Mavvs 16,200,32
RT 192,240,256
s_add_u32 s62, s62, s87
Mavvs 20,200,36
RT 194,240,2304
AR 16,208
Mavvs 24,204,32
RT 196,241,256
AR 17,209
AR 18,210
Mavvs 28,204,36
LW 7
RT 198,241,2304
AR 19,211
Mavvs 32,208,32
buffer_load_dwordx4 v15, s[16:19], s74 offen offset:3072 lds
Mavvs 36,208,36
RT 200,242,256
RT 202,242,2304
Mavvs 40,212,32
RT 204,243,256
s_add_u32 m0, s53, 147456
AR 20,212
Mavvs 44,212,36
LW 7
RT 206,243,2304
Mavvs 48,216,32
RT 208,244,256
s_mov_b32 s74, 688128
Mavvs 52,216,36
RT 210,244,2304
AR 21,213
Mavvs 56,220,32
RT 212,245,256
AR 22,214
AR 23,215
Mavvs 60,220,36
LW 7
RT 214,245,2304
v_mul_f32_e64 v16, s100, v16
Mavvs 64,192,32
buffer_load_dwordx4 v28, s[20:23], s74 offen lds
Mavvs 68,192,36
RT 216,246,256
RT 218,246,2304
Mavvs 72,196,32
RT 220,247,256
v_mul_f32 v17, s100, v17
v_mul_f32 v18, s100, v18
Mavvs 76,196,36
LW 7
RT 222,247,2304
v_mul_f32 v19, s100, v19
v_mul_f32_e64 v20, s100, v20
Mavvs 80,200,32
buffer_load_dwordx4 v29, s[20:23], s74 offen offset:1024 lds
Mavvs 84,200,36
RT 192,248,32768
RT 194,248,33792
Mavvs 88,204,32
RT 196,249,32768
v_mul_f32 v21, s100, v21
v_mul_f32 v22, s100, v22
Mavvs 92,204,36
LW 7
RT 198,249,33792
Mavvs 96,208,32
RT 200,250,32768
v_mul_f32 v23, s100, v23
Mavvs 100,208,36
RT 202,250,33792
CV 136,16,17
Mavvs 104,212,32
RT 204,251,32768
CV 137,18,19
Mavvs 108,212,36
LW 7
RT 206,251,33792
Mavvs 112,216,32
RT 208,252,32768
CV 138,20,21
CV 139,22,23
Mavvs 116,216,36
s_waitcnt vmcnt(7)
s_barrier
RT 210,252,33792
Mavvs 120,220,32
RT 212,253,32768
s_add_u32 s75, s71, 8192
buffer_store_dwordx4 v[136:139], v4, s[4:7], s62 offen sc1
Mavvs 124,220,36
LW 7
RT 214,253,33792
s_add_u32 s62, s62, s86
Mavvs 128,192,32
buffer_load_dwordx4 v[64:67], v10, s[4:7], s75 offen offset:0 sc1
Mavvs 132,192,36
RT 216,240,16384
RT 218,240,18432
Mavvs 136,196,32
RT 220,241,16384
AR 16,216
AR 17,217
Mavvs 140,196,36
LW 7
RT 222,241,18432
AR 18,218
Mavvs 144,200,32
buffer_load_dwordx4 v[68:71], v11, s[4:7], s75 offen offset:0 sc1
Mavvs 148,200,36
RT 192,242,16384
RT 194,242,18432
Mavvs 152,204,32
RT 196,243,16384
AR 19,219
AR 20,220
Mavvs 156,204,36
LW 7
RT 198,243,18432
AR 21,221
AR 22,222
Mavvs 160,208,32
buffer_load_dwordx4 v[72:75], v10, s[4:7], s75 offen offset:1024 sc1
Mavvs 164,208,36
RT 200,244,16384
RT 202,244,18432
Mavvs 168,212,32
RT 204,245,16384
AR 23,223
v_mul_f32 v16, s100, v16
Mavvs 172,212,36
LW 7
RT 206,245,18432
v_mul_f32 v17, s100, v17
Mavvs 0,216,40
buffer_load_dwordx4 v[76:79], v11, s[4:7], s75 offen offset:1024 sc1
Mavvs 4,216,44
RT 208,246,16384
RT 210,246,18432
Mavvs 8,220,40
RT 212,247,16384
s_add_u32 m0, s52, 49152
v_mul_f32_e64 v18, s100, v18
Mavvs 12,220,44
LW 7
RT 214,247,18432
v_mul_f32 v19, s100, v19
Mavvs 16,192,40
RT 216,240,16640
s_mov_b32 s74, 1835008
v_mul_f32_e64 v20, s100, v20
Mavvs 20,192,44
RT 218,240,18688
v_mul_f32_e64 v21, s100, v21
Mavvs 24,196,40
RT 220,241,16640
v_mul_f32 v22, s100, v22
v_mul_f32 v23, s100, v23
Mavvs 28,196,44
LW 7
RT 222,241,18688
CV 140,16,17
CV 141,18,19
Mavvs 32,200,40
buffer_load_dwordx4 v12, s[16:19], s74 offen lds
Mavvs 36,200,44
RT 192,242,16640
RT 194,242,18688
Mavvs 40,204,40
RT 196,243,16640
buffer_load_dwordx4 v13, s[16:19], s74 offen offset:1024 lds
Mavvs 44,204,44
LW 7
RT 198,243,18688
CV 142,20,21
CV 143,22,23
buffer_store_dwordx4 v[140:143], v4, s[4:7], s62 offen sc1
Mavvs 48,208,40
buffer_load_dwordx4 v14, s[16:19], s74 offen offset:2048 lds
Mavvs 52,208,44
RT 200,244,16640
RT 202,244,18688
Mavvs 56,212,40
RT 204,245,16640
s_add_u32 s62, s62, s88
AR 16,224
Mavvs 60,212,44
LW 7
RT 206,245,18688
AR 17,225
Mavvs 64,216,40
buffer_load_dwordx4 v15, s[16:19], s74 offen offset:3072 lds
Mavvs 68,216,44
RT 208,246,16640
RT 210,246,18688
Mavvs 72,220,40
RT 212,247,16640
s_add_u32 m0, s53, 155648
AR 18,226
Mavvs 76,220,44
LW 7
RT 214,247,18688
Mavvs 80,192,40
RT 216,248,40960
s_mov_b32 s74, 802816
Mavvs 84,192,44
RT 218,248,41984
AR 19,227
Mavvs 88,196,40
RT 220,249,40960
AR 20,228
AR 21,229
Mavvs 92,196,44
LW 7
RT 222,249,41984
AR 22,230
AR 23,231
v_mul_f32_e64 v16, s100, v16
Mavvs 96,200,40
buffer_load_dwordx4 v28, s[20:23], s74 offen lds
Mavvs 100,200,44
RT 192,250,40960
RT 194,250,41984
Mavvs 104,204,40
RT 196,251,40960
buffer_load_dwordx4 v29, s[20:23], s74 offen offset:1024 lds
Mavvs 108,204,44
LW 7
RT 198,251,41984
v_mul_f32 v17, s100, v17
Mavvs 112,208,40
RT 200,252,40960
v_mul_f32 v18, s100, v18
v_mul_f32 v19, s100, v19
Mavvs 116,208,44
s_waitcnt vmcnt(12)
s_barrier
RT 202,252,41984
Mavvs 120,212,40
RT 204,253,40960
s_add_u32 m0, s52, 0
v_mul_f32 v20, s100, v20
Mavvs 124,212,44
LW 7
RT 206,253,41984
v_mul_f32 v21, s100, v21
Mavvs 128,216,40
RT 208,240,32768
s_mov_b32 s74, 2097152
Mavvs 132,216,44
RT 210,240,34816
v_mul_f32_e64 v22, s100, v22
Mavvs 136,220,40
RT 212,241,32768
v_mul_f32_e64 v23, s100, v23
CV 144,16,17
Mavvs 140,220,44
LW 7
RT 214,241,34816
CV 145,18,19
CV 146,20,21
Mavvs 144,192,40
buffer_load_dwordx4 v12, s[16:19], s74 offen lds
Mavvs 148,192,44
RT 216,242,32768
RT 218,242,34816
Mavvs 152,196,40
RT 220,243,32768
CV 147,22,23
buffer_store_dwordx4 v[144:147], v4, s[4:7], s62 offen sc1
Mavvs 156,196,44
LW 7
RT 222,243,34816
Mavvs 160,200,40
buffer_load_dwordx4 v13, s[16:19], s74 offen offset:1024 lds
Mavvs 164,200,44
RT 192,244,32768
RT 194,244,34816
Mavvs 168,204,40
RT 196,245,32768
s_add_u32 s62, s62, s86
AR 16,232
Mavvs 172,204,44
LW 7
RT 198,245,34816
AR 17,233
Mavvs 0,208,48
buffer_load_dwordx4 v14, s[16:19], s74 offen offset:2048 lds
Mavvs 4,208,52
RT 200,246,32768
RT 202,246,34816
Mavvs 8,212,48
RT 204,247,32768
AR 18,234
Mavvs 12,212,52
LW 7
RT 206,247,34816
Mavvs 16,216,48
RT 208,240,33024
AR 19,235
Mavvs 20,216,52
RT 210,240,35072
AR 20,236
Mavvs 24,220,48
RT 212,241,33024
AR 21,237
AR 22,238
Mavvs 28,220,52
LW 7
RT 214,241,35072
AR 23,239
v_mul_f32_e64 v16, s100, v16
Mavvs 32,192,48
buffer_load_dwordx4 v15, s[16:19], s74 offen offset:3072 lds
Mavvs 36,192,52
RT 216,242,33024
RT 218,242,35072
Mavvs 40,196,48
RT 220,243,33024
s_add_u32 m0, s53, 98304
v_mul_f32_e64 v17, s100, v17
Mavvs 44,196,52
LW 7
RT 222,243,35072
v_mul_f32 v18, s100, v18
Mavvs 48,200,48
RT 192,244,33024
s_mov_b32 s74, 917504
v_mul_f32_e64 v19, s100, v19
Mavvs 52,200,52
RT 194,244,35072
v_mul_f32_e64 v20, s100, v20
Mavvs 56,204,48
RT 196,245,33024
v_mul_f32 v21, s100, v21
v_mul_f32 v22, s100, v22
Mavvs 60,204,52
LW 7
RT 198,245,35072
v_mul_f32 v23, s100, v23
Mavvs 64,208,48
buffer_load_dwordx4 v28, s[20:23], s74 offen lds
Mavvs 68,208,52
RT 200,246,33024
RT 202,246,35072
Mavvs 72,212,48
RT 204,247,33024
CV 148,16,17
CV 149,18,19
Mavvs 76,212,52
LW 7
RT 206,247,35072
CV 150,20,21
CV 151,22,23
Mavvs 80,216,48
buffer_load_dwordx4 v29, s[20:23], s74 offen offset:1024 lds
Mavvs 84,216,52
RT 208,248,49152
RT 210,248,50176
Mavvs 88,220,48
RT 212,249,49152
buffer_store_dwordx4 v[148:151], v4, s[4:7], s62 offen sc1
Mavvs 92,220,52
LW 7
RT 214,249,50176
Mavvs 96,192,48
RT 216,250,49152
s_add_u32 s62, s62, s87
Mavvs 100,192,52
RT 218,250,50176
AR 16,240
Mavvs 104,196,48
RT 220,251,49152
AR 17,241
Mavvs 108,196,52
LW 7
RT 222,251,50176
Mavvs 112,200,48
RT 192,252,49152
AR 18,242
AR 19,243
Mavvs 116,200,52
s_waitcnt vmcnt(8)
s_barrier
RT 194,252,50176
Mavvs 120,204,48
RT 196,253,49152
s_add_u32 s75, s71, 10240
AR 20,244
Mavvs 124,204,52
LW 7
RT 198,253,50176
AR 21,245
Mavvs 128,208,48
buffer_load_dwordx4 v[80:83], v10, s[4:7], s75 offen offset:0 sc1
Mavvs 132,208,52
RT 200,240,49152
RT 202,240,51200
Mavvs 136,212,48
RT 204,241,49152
AR 22,246
AR 23,247
Mavvs 140,212,52
LW 7
RT 206,241,51200
v_mul_f32 v16, s100, v16
v_mul_f32 v17, s100, v17
Mavvs 144,216,48
buffer_load_dwordx4 v[84:87], v11, s[4:7], s75 offen offset:0 sc1
Mavvs 148,216,52
RT 208,242,49152
RT 210,242,51200
Mavvs 152,220,48
RT 212,243,49152
v_mul_f32 v18, s100, v18
v_mul_f32 v19, s100, v19
Mavvs 156,220,52
LW 7
RT 214,243,51200
v_mul_f32 v20, s100, v20
Mavvs 160,192,48
buffer_load_dwordx4 v[88:91], v10, s[4:7], s75 offen offset:1024 sc1
Mavvs 164,192,52
RT 216,244,49152
RT 218,244,51200
Mavvs 168,196,48
RT 220,245,49152
v_mul_f32 v21, s100, v21
v_mul_f32 v22, s100, v22
Mavvs 172,196,52
LW 7
RT 222,245,51200
v_mul_f32 v23, s100, v23
CV 152,16,17
Mavvs 0,200,56
buffer_load_dwordx4 v[92:95], v11, s[4:7], s75 offen offset:1024 sc1
Mavvs 4,200,60
RT 192,246,49152
RT 194,246,51200
Mavvs 8,204,56
RT 196,247,49152
s_add_u32 m0, s52, 16384
CV 153,18,19
Mavvs 12,204,60
LW 7
RT 198,247,51200
CV 154,20,21
Mavvs 16,208,56
RT 200,240,49408
s_mov_b32 s74, 2359296
CV 155,22,23
Mavvs 20,208,60
RT 202,240,51456
buffer_store_dwordx4 v[152:155], v4, s[4:7], s62 offen sc1
Mavvs 24,212,56
RT 204,241,49408
s_add_u32 s62, s62, s86
AR 16,248
Mavvs 28,212,60
LW 7
RT 206,241,51456
AR 17,249
Mavvs 32,216,56
buffer_load_dwordx4 v12, s[16:19], s74 offen lds
Mavvs 36,216,60
RT 208,242,49408
RT 210,242,51456
Mavvs 40,220,56
RT 212,243,49408
buffer_load_dwordx4 v13, s[16:19], s74 offen offset:1024 lds
Mavvs 44,220,60
LW 7
RT 214,243,51456
AR 18,250
AR 19,251
Mavvs 48,192,56
buffer_load_dwordx4 v14, s[16:19], s74 offen offset:2048 lds
Mavvs 52,192,60
RT 216,244,49408
RT 218,244,51456
Mavvs 56,196,56
RT 220,245,49408
AR 20,252
AR 21,253
Mavvs 60,196,60
LW 7
RT 222,245,51456
AR 22,254
Mavvs 64,200,56
buffer_load_dwordx4 v15, s[16:19], s74 offen offset:3072 lds
Mavvs 68,200,60
RT 192,246,49408
RT 194,246,51456
Mavvs 72,204,56
RT 196,247,49408
s_add_u32 m0, s53, 106496
AR 23,255
Mavvs 76,204,60
LW 7
RT 198,247,51456
v_mul_f32_e64 v16, s100, v16
Mavvs 80,208,56
RT 200,248,57344
s_mov_b32 s74, 1032192
v_mul_f32_e64 v17, s100, v17
Mavvs 84,208,60
RT 202,248,58368
v_mul_f32_e64 v18, s100, v18
Mavvs 88,212,56
RT 204,249,57344
v_mul_f32 v19, s100, v19
v_mul_f32 v20, s100, v20
Mavvs 92,212,60
LW 7
RT 206,249,58368
v_mul_f32 v21, s100, v21
v_mul_f32_e64 v22, s100, v22
Mavvs 96,216,56
buffer_load_dwordx4 v28, s[20:23], s74 offen lds
Mavvs 100,216,60
RT 208,250,57344
RT 210,250,58368
Mavvs 104,220,56
RT 212,251,57344
buffer_load_dwordx4 v29, s[20:23], s74 offen offset:1024 lds
Mavvs 108,220,60
LW 7
RT 214,251,58368
v_mul_f32 v23, s100, v23
Mavvs 112,192,56
RT 216,252,57344
CV 156,16,17
CV 157,18,19
Mavvs 116,192,60
s_waitcnt vmcnt(12)
s_barrier
RT 218,252,58368
Mavvs 120,196,56
RT 220,253,57344
s_add_u32 m0, s52, 32768
CV 158,20,21
Mavvs 124,196,60
LW 7
RT 222,253,58368
CV 159,22,23
buffer_store_dwordx4 v[156:159], v4, s[4:7], s62 offen sc1
Mavvs 128,200,56
RT 192,240,0
s_mov_b32 s74, 2621440
Mavvs 132,200,60
RT 194,240,2048
Mavvs 136,204,56
RT 196,241,0
Mavvs 140,204,60
LW 7
RT 198,241,2048
Mavvs 144,208,56
buffer_load_dwordx4 v12, s[16:19], s74 offen lds
Mavvs 148,208,60
RT 200,242,0
RT 202,242,2048
Mavvs 152,212,56
RT 204,243,0
Mavvs 156,212,60
LW 7
RT 206,243,2048
Mavvs 160,216,56
buffer_load_dwordx4 v13, s[16:19], s74 offen offset:1024 lds
Mavvs 164,216,60
RT 208,244,0
RT 210,244,2048
Mavvs 168,220,56
RT 212,245,0
Mavvs 172,220,60
LW 7
RT 214,245,2048
Mavvs 0,192,64
buffer_load_dwordx4 v14, s[16:19], s74 offen offset:2048 lds
Mavvs 4,192,68
RT 216,246,0
RT 218,246,2048
Mavvs 8,196,64
RT 220,247,0
Mavvs 12,196,68
LW 7
RT 222,247,2048
Mavvs 16,200,64
RT 192,240,256
Mavvs 20,200,68
RT 194,240,2304
Mavvs 24,204,64
RT 196,241,256
Mavvs 28,204,68
LW 7
RT 198,241,2304
Mavvs 32,208,64
buffer_load_dwordx4 v15, s[16:19], s74 offen offset:3072 lds
Mavvs 36,208,68
RT 200,242,256
RT 202,242,2304
Mavvs 40,212,64
RT 204,243,256
s_add_u32 m0, s53, 114688
Mavvs 44,212,68
LW 7
RT 206,243,2304
Mavvs 48,216,64
RT 208,244,256
s_mov_b32 s74, 1146880
Mavvs 52,216,68
RT 210,244,2304
Mavvs 56,220,64
RT 212,245,256
Mavvs 60,220,68
LW 7
RT 214,245,2304
Mavvs 64,192,64
buffer_load_dwordx4 v28, s[20:23], s74 offen lds
Mavvs 68,192,68
RT 216,246,256
RT 218,246,2304
Mavvs 72,196,64
RT 220,247,256
Mavvs 76,196,68
LW 7
RT 222,247,2304
Mavvs 80,200,64
buffer_load_dwordx4 v29, s[20:23], s74 offen offset:1024 lds
Mavvs 84,200,68
RT 192,248,0
RT 194,248,1024
Mavvs 88,204,64
RT 196,249,0
Mavvs 92,204,68
LW 7
RT 198,249,1024
Mavvs 96,208,64
RT 200,250,0
Mavvs 100,208,68
RT 202,250,1024
Mavvs 104,212,64
RT 204,251,0
Mavvs 108,212,68
LW 7
RT 206,251,1024
Mavvs 112,216,64
RT 208,252,0
Mavvs 116,216,68
s_waitcnt vmcnt(7)
s_barrier
RT 210,252,1024
Mavvs 120,220,64
RT 212,253,0
s_add_u32 s75, s71, 12288
Mavvs 124,220,68
LW 7
RT 214,253,1024
Mavvs 128,192,64
buffer_load_dwordx4 v[96:99], v10, s[4:7], s75 offen offset:0 sc1
Mavvs 132,192,68
RT 216,240,16384
RT 218,240,18432
Mavvs 136,196,64
RT 220,241,16384
Mavvs 140,196,68
LW 7
RT 222,241,18432
Mavvs 144,200,64
buffer_load_dwordx4 v[100:103], v11, s[4:7], s75 offen offset:0 sc1
Mavvs 148,200,68
RT 192,242,16384
RT 194,242,18432
Mavvs 152,204,64
RT 196,243,16384
Mavvs 156,204,68
LW 7
RT 198,243,18432
Mavvs 160,208,64
buffer_load_dwordx4 v[104:107], v10, s[4:7], s75 offen offset:1024 sc1
Mavvs 164,208,68
RT 200,244,16384
RT 202,244,18432
Mavvs 168,212,64
RT 204,245,16384
Mavvs 172,212,68
LW 7
RT 206,245,18432
Mavvs 0,216,72
buffer_load_dwordx4 v[108:111], v11, s[4:7], s75 offen offset:1024 sc1
Mavvs 4,216,76
RT 208,246,16384
RT 210,246,18432
Mavvs 8,220,72
RT 212,247,16384
s_add_u32 m0, s52, 49152
Mavvs 12,220,76
LW 7
RT 214,247,18432
Mavvs 16,192,72
RT 216,240,16640
s_mov_b32 s74, 2883584
Mavvs 20,192,76
RT 218,240,18688
Mavvs 24,196,72
RT 220,241,16640
Mavvs 28,196,76
LW 7
RT 222,241,18688
Mavvs 32,200,72
buffer_load_dwordx4 v12, s[16:19], s74 offen lds
Mavvs 36,200,76
RT 192,242,16640
RT 194,242,18688
Mavvs 40,204,72
RT 196,243,16640
buffer_load_dwordx4 v13, s[16:19], s74 offen offset:1024 lds
Mavvs 44,204,76
LW 7
RT 198,243,18688
Mavvs 48,208,72
buffer_load_dwordx4 v14, s[16:19], s74 offen offset:2048 lds
Mavvs 52,208,76
RT 200,244,16640
RT 202,244,18688
Mavvs 56,212,72
RT 204,245,16640
Mavvs 60,212,76
LW 7
RT 206,245,18688
Mavvs 64,216,72
buffer_load_dwordx4 v15, s[16:19], s74 offen offset:3072 lds
Mavvs 68,216,76
RT 208,246,16640
RT 210,246,18688
Mavvs 72,220,72
RT 212,247,16640
s_add_u32 m0, s53, 122880
Mavvs 76,220,76
LW 7
RT 214,247,18688
Mavvs 80,192,72
RT 216,248,8192
s_mov_b32 s74, 1261568
Mavvs 84,192,76
RT 218,248,9216
Mavvs 88,196,72
RT 220,249,8192
Mavvs 92,196,76
LW 7
RT 222,249,9216
Mavvs 96,200,72
buffer_load_dwordx4 v28, s[20:23], s74 offen lds
Mavvs 100,200,76
RT 192,250,8192
RT 194,250,9216
Mavvs 104,204,72
RT 196,251,8192
buffer_load_dwordx4 v29, s[20:23], s74 offen offset:1024 lds
Mavvs 108,204,76
LW 7
RT 198,251,9216
Mavvs 112,208,72
RT 200,252,8192
Mavvs 116,208,76
s_waitcnt vmcnt(10)
s_barrier
RT 202,252,9216
Mavvs 120,212,72
RT 204,253,8192
s_add_u32 m0, s52, 0
Mavvs 124,212,76
LW 7
RT 206,253,9216
Mavvs 128,216,72
RT 208,240,32768
s_mov_b32 s74, 3145728
Mavvs 132,216,76
RT 210,240,34816
Mavvs 136,220,72
RT 212,241,32768
Mavvs 140,220,76
LW 7
RT 214,241,34816
Mavvs 144,192,72
buffer_load_dwordx4 v12, s[16:19], s74 offen lds
Mavvs 148,192,76
RT 216,242,32768
RT 218,242,34816
Mavvs 152,196,72
RT 220,243,32768
Mavvs 156,196,76
LW 7
RT 222,243,34816
Mavvs 160,200,72
buffer_load_dwordx4 v13, s[16:19], s74 offen offset:1024 lds
Mavvs 164,200,76
RT 192,244,32768
RT 194,244,34816
Mavvs 168,204,72
RT 196,245,32768
Mavvs 172,204,76
LW 7
RT 198,245,34816
Mavvs 0,208,80
buffer_load_dwordx4 v14, s[16:19], s74 offen offset:2048 lds
Mavvs 4,208,84
RT 200,246,32768
RT 202,246,34816
Mavvs 8,212,80
RT 204,247,32768
Mavvs 12,212,84
LW 7
RT 206,247,34816
Mavvs 16,216,80
buffer_load_dwordx4 v15, s[16:19], s74 offen offset:3072 lds
Mavvs 20,216,84
RT 208,240,33024
RT 210,240,35072
Mavvs 24,220,80
RT 212,241,33024
s_add_u32 m0, s53, 131072
Mavvs 28,220,84
LW 7
RT 214,241,35072
Mavvs 32,192,80
RT 216,242,33024
s_mov_b32 s74, 1376256
Mavvs 36,192,84
RT 218,242,35072
buffer_load_dwordx4 v28, s[20:23], s74 offen lds
Mavvs 40,196,80
RT 220,243,33024
Mavvs 44,196,84
LW 7
RT 222,243,35072
Mavvs 48,200,80
buffer_load_dwordx4 v29, s[20:23], s74 offen offset:1024 lds
Mavvs 52,200,84
RT 192,244,33024
RT 194,244,35072
Mavvs 56,204,80
RT 196,245,33024
Mavvs 60,204,84
LW 7
RT 198,245,35072
Mavvs 64,208,80
RT 200,246,33024
Mavvs 68,208,84
s_waitcnt vmcnt(22)
s_waitcnt vmcnt(6)
s_barrier
RT 202,246,35072
Mavvs 72,212,80
RT 204,247,33024
s_add_u32 m0, s52, 16384
Mavvs 76,212,84
LW 7
RT 206,247,35072
Mavvs 80,216,80
RT 208,240,49152
s_mov_b32 s74, 3407872
Mavvs 84,216,84
RT 210,240,51200
s_lshr_b32 s79, s2, 4
Mavvs 88,220,80
RT 212,241,49152
s_lshl_b32 s79, s79, 2
s_add_u32 s79, s79, s65
Mavvs 92,220,84
LW 7
RT 214,241,51200
buffer_store_dword v6, v5, s[4:7], s79 offen sc1
Mavvs 96,192,80
buffer_load_dwordx4 v12, s[16:19], s74 offen lds
Mavvs 100,192,84
RT 216,242,49152
RT 218,242,51200
Mavvs 104,196,80
RT 220,243,49152
Mavvs 108,196,84
LW 7
RT 222,243,51200
Mavvs 112,200,80
buffer_load_dwordx4 v13, s[16:19], s74 offen offset:1024 lds
Mavvs 116,200,84
RT 192,244,49152
RT 194,244,51200
Mavvs 120,204,80
RT 196,245,49152
Mavvs 124,204,84
LW 7
RT 198,245,51200
Mavvs 0,208,88
buffer_load_dwordx4 v14, s[16:19], s74 offen offset:2048 lds
Mavvs 4,208,92
RT 200,246,49152
RT 202,246,51200
Mavvs 8,212,88
RT 204,247,49152
Mavvs 12,212,92
LW 7
RT 206,247,51200
Mavvs 16,216,88
buffer_load_dwordx4 v15, s[16:19], s74 offen offset:3072 lds
Mavvs 20,216,92
RT 208,240,49408
RT 210,240,51456
Mavvs 24,220,88
RT 212,241,49408
s_add_u32 m0, s53, 139264
Mavvs 28,220,92
LW 7
RT 214,241,51456
Mavvs 32,192,88
RT 216,242,49408
s_mov_b32 s74, 1490944
Mavvs 36,192,92
RT 218,242,51456
buffer_load_dwordx4 v28, s[20:23], s74 offen lds
Mavvs 40,196,88
RT 220,243,49408
Mavvs 44,196,92
LW 7
RT 222,243,51456
Mavvs 48,200,88
buffer_load_dwordx4 v29, s[20:23], s74 offen offset:1024 lds
Mavvs 52,200,92
RT 192,244,49408
RT 194,244,51456
Mavvs 56,204,88
RT 196,245,49408
Mavvs 60,204,92
LW 7
RT 198,245,51456
Mavvs 64,208,88
RT 200,246,49408
Mavvs 68,208,92
s_waitcnt vmcnt(7)
s_barrier
RT 202,246,51456
Mavvs 72,212,88
RT 204,247,49408
Mavvs 76,212,92
LW 7
RT 206,247,51456
Mavvs 80,216,88
RT 208,240,0
Mavvs 84,216,92
RT 210,240,2048
Mavvs 88,220,88
RT 212,241,0
Mavvs 92,220,92
LW 7
RT 214,241,2048
Mavvs 96,192,88
RT 216,242,0
Mavvs 100,192,92
RT 218,242,2048
Mavvs 104,196,88
RT 220,243,0
Mavvs 108,196,92
LW 7
RT 222,243,2048
Mavvs 112,200,88
RT 192,244,0
Mavvs 116,200,92
RT 194,244,2048
Mavvs 120,204,88
RT 196,245,0
Mavvs 124,204,92
LW 7
RT 198,245,2048
Mavvs 0,208,96
RT 200,246,0
Mavvs 4,208,100
RT 202,246,2048
Mavvs 8,212,96
RT 204,247,0
Mavvs 12,212,100
LW 7
RT 206,247,2048
Mavvs 16,216,96
RT 208,240,256
Mavvs 20,216,100
RT 210,240,2304
Mavvs 24,220,96
RT 212,241,256
Mavvs 28,220,100
LW 7
RT 214,241,2304
Mavvs 32,192,96
RT 216,242,256
Mavvs 36,192,100
RT 218,242,2304
Mavvs 40,196,96
RT 220,243,256
Mavvs 44,196,100
LW 7
RT 222,243,2304
Mavvs 48,200,96
RT 192,244,256
Mavvs 52,200,100
RT 194,244,2304
Mavvs 56,204,96
RT 196,245,256
Mavvs 60,204,100
LW 7
RT 198,245,2304
Mavvs 64,208,96
RT 200,246,256
Mavvs 68,208,100
s_waitcnt vmcnt(0)
s_barrier
RT 202,246,2304
Mavvs 72,212,96
RT 204,247,256
s_mov_b32 s70, s65
Mavvs 76,212,100
LW 7
RT 206,247,2304
Mavvs 80,216,96
RT 208,240,16384
s_lshl_b32 s80, s54, 16
Mavvs 84,216,100
RT 210,240,18432
s_lshl_b32 s81, s44, 14
Mavvs 88,220,96
RT 212,241,16384
s_add_u32 s80, s80, s81
Mavvs 92,220,100
LW 7
RT 214,241,18432
Mavvs 96,192,96
RT 216,242,16384
s_add_u32 s80, s80, 0x3800000
Mavvs 100,192,100
RT 218,242,18432
s_sub_u32 s68, s50, s51
Mavvs 104,196,96
RT 220,243,16384
s_cmp_eq_u32 s68, 0
s_cselect_b32 s80, 0x70000000, s80
Mavvs 108,196,100
LW 7
RT 222,243,18432
Mavvs 112,200,96
RT 192,244,16384
v_mov_b32_e64 v8, s55
Mavvs 116,200,100
RT 194,244,18432
v_mov_b32_e64 v9, s55
Mavvs 120,204,96
RT 196,245,16384
Mavvs 124,204,100
LW 7
RT 198,245,18432
Mavvs 0,208,104
RT 200,246,16384
Mavvs 4,208,108
RT 202,246,18432
Mavvs 8,212,104
RT 204,247,16384
Mavvs 12,212,108
LW 7
RT 206,247,18432
Mavvs 16,216,104
RT 208,240,16640
Mavvs 20,216,108
RT 210,240,18688
Mavvs 24,220,104
RT 212,241,16640
Mavvs 28,220,108
LW 7
RT 214,241,18688
Mavvs 32,192,104
RT 216,242,16640
Mavvs 36,192,108
RT 218,242,18688
Mavvs 40,196,104
RT 220,243,16640
Mavvs 44,196,108
LW 7
RT 222,243,18688
Mavvs 48,200,104
RT 192,244,16640
Mavvs 52,200,108
RT 194,244,18688
Mavvs 56,204,104
RT 196,245,16640
Mavvs 60,204,108
LW 7
RT 198,245,18688
Mavvs 64,208,104
RT 200,246,16640
AR 224,0
Mavvs 68,208,108
RT 202,246,18688
AR 225,1
Mavvs 72,212,104
RT 204,247,16640
AR 226,2
Mavvs 76,212,108
LW 7
RT 206,247,18688
Mavvs 80,216,104
RT 208,248,16384
AR 227,3
Mavvs 84,216,108
RT 210,248,17408
AR 228,8
Mavvs 88,220,104
RT 212,249,16384
AR 229,9
AR 230,10
Mavvs 92,220,108
LW 7
RT 214,249,17408
AR 231,11
Mavvs 96,192,104
RT 216,250,16384
v_mul_f32 v224, s55, v224
v_mul_f32_e64 v225, s55, v225
Mavvs 100,192,108
RT 218,250,17408
v_mul_f32_e64 v226, s55, v226
Mavvs 104,196,104
RT 220,251,16384
v_mul_f32 v227, s55, v227
v_mul_f32 v228, s55, v228
Mavvs 108,196,108
LW 7
RT 222,251,17408
v_mul_f32 v229, s55, v229
v_mul_f32_e64 v230, s55, v230
Mavvs 112,200,104
RT 192,252,16384
v_mul_f32_e64 v231, s55, v231
CV 128,224,225
Mavvs 116,200,108
RT 194,252,17408
CV 129,226,227
CV 130,228,229
Mavvs 120,204,104
RT 196,253,16384
CV 131,230,231
buffer_store_dwordx4 v[128:131], v4, s[4:7], s80 offen offset:0 sc1
Mavvs 124,204,108
LW 7
RT 198,253,17408
Mavvs 128,208,80
RT 200,248,24576
AR 232,4
Mavvs 132,208,84
RT 202,248,25600
AR 233,5
AR 234,6
Mavvs 136,212,80
RT 204,249,24576
AR 235,7
AR 236,12
Mavvs 140,212,84
LW 7
RT 206,249,25600
AR 237,13
Mavvs 144,216,80
RT 208,250,24576
AR 238,14
AR 239,15
Mavvs 148,216,84
RT 210,250,25600
v_mul_f32 v232, s55, v232
v_mul_f32 v233, s55, v233
Mavvs 152,220,80
RT 212,251,24576
v_mul_f32 v234, s55, v234
v_mul_f32 v235, s55, v235
Mavvs 156,220,84
LW 7
RT 214,251,25600
v_mul_f32 v236, s55, v236
v_mul_f32_e64 v237, s55, v237
Mavvs 160,192,80
RT 216,252,24576
v_mul_f32 v238, s55, v238
v_mul_f32 v239, s55, v239
Mavvs 164,192,84
RT 218,252,25600
CV 132,232,233
Mavvs 168,196,80
RT 220,253,24576
CV 133,234,235
CV 134,236,237
Mavvs 172,196,84
LW 7
RT 222,253,25600
CV 135,238,239
buffer_store_dwordx4 v[132:135], v4, s[4:7], s80 offen offset:1024 sc1
Mavvs 128,200,88
RT 192,248,32768
AR 224,16
Mavvs 132,200,92
RT 194,248,33792
AR 225,17
Mavvs 136,204,88
RT 196,249,32768
AR 226,18
AR 227,19
Mavvs 140,204,92
LW 7
RT 198,249,33792
AR 228,24
Mavvs 144,208,88
RT 200,250,32768
AR 229,25
AR 230,26
Mavvs 148,208,92
RT 202,250,33792
AR 231,27
v_mul_f32_e64 v224, s55, v224
Mavvs 152,212,88
RT 204,251,32768
v_mul_f32 v225, s55, v225
v_mul_f32 v226, s55, v226
Mavvs 156,212,92
LW 7
RT 206,251,33792
v_mul_f32 v227, s55, v227
Mavvs 160,216,88
RT 208,252,32768
v_mul_f32 v228, s55, v228
v_mul_f32 v229, s55, v229
Mavvs 164,216,92
RT 210,252,33792
v_mul_f32 v230, s55, v230
v_mul_f32 v231, s55, v231
Mavvs 168,220,88
RT 212,253,32768
CV 136,224,225
CV 137,226,227
Mavvs 172,220,92
LW 7
RT 214,253,33792
CV 138,228,229
CV 139,230,231
Mavvs 128,192,96
buffer_store_dwordx4 v[136:139], v4, s[4:7], s80 offen offset:2048 sc1
Mavvs 132,192,100
RT 216,248,40960
RT 218,248,41984
Mavvs 136,196,96
RT 220,249,40960
AR 232,20
AR 233,21
Mavvs 140,196,100
LW 7
RT 222,249,41984
AR 234,22
AR 235,23
Mavvs 144,200,96
RT 192,250,40960
AR 236,28
AR 237,29
Mavvs 148,200,100
RT 194,250,41984
AR 238,30
AR 239,31
Mavvs 152,204,96
RT 196,251,40960
v_mul_f32 v232, s55, v232
v_mul_f32 v233, s55, v233
Mavvs 156,204,100
LW 7
RT 198,251,41984
v_mul_f32 v234, s55, v234
Mavvs 160,208,96
RT 200,252,40960
v_mul_f32 v235, s55, v235
v_mul_f32 v236, s55, v236
Mavvs 164,208,100
RT 202,252,41984
v_mul_f32 v237, s55, v237
v_mul_f32 v238, s55, v238
Mavvs 168,212,96
RT 204,253,40960
v_mul_f32_e64 v239, s55, v239
CV 140,232,233
Mavvs 172,212,100
LW 7
RT 206,253,41984
CV 141,234,235
Mavvs 128,216,104
CV 142,236,237
CV 143,238,239
Mavvs 132,216,108
buffer_store_dwordx4 v[140:143], v4, s[4:7], s80 offen offset:3072 sc1
Mavvs 136,220,104
s_add_u32 s80, s80, 4096
AR 224,32
AR 225,33
Mavvs 140,220,108
LW 4
AR 226,34
AR 227,35
Mavvs 144,192,104
AR 228,40
AR 229,41
Mavvs 148,192,108
AR 230,42
AR 231,43
Mavvs 152,196,104
v_mul_f32 v224, s55, v224
v_mul_f32 v225, s55, v225
Mavvs 156,196,108
LW 0
v_mul_f32 v226, s55, v226
v_mul_f32_e64 v227, s55, v227
Mavvs 160,200,104
v_mul_f32 v228, s55, v228
v_mul_f32 v229, s55, v229
Mavvs 164,200,108
v_mul_f32 v230, s55, v230
v_mul_f32 v231, s55, v231
Mavvs 168,204,104
CV 144,224,225
CV 145,226,227
Mavvs 172,204,108
CV 146,228,229
CV 147,230,231
buffer_store_dwordx4 v[144:147], v4, s[4:7], s80 offen offset:0 sc1
s_nop 3
s_nop 0
buffer_load_dword v7, v30, s[4:7], s70 offen sc1
AR 232,36
AR 233,37
AR 234,38
AR 235,39
AR 236,44
AR 237,45
AR 238,46
AR 239,47
v_pk_mul_f32 v[232:233], v[232:233], v[8:9]
v_pk_mul_f32 v[234:235], v[234:235], v[8:9]
v_pk_mul_f32 v[236:237], v[236:237], v[8:9]
v_pk_mul_f32 v[238:239], v[238:239], v[8:9]
CV 148,232,233
CV 149,234,235
CV 150,236,237
CV 151,238,239
buffer_store_dwordx4 v[148:151], v4, s[4:7], s80 offen offset:1024 sc1
AR 224,48
AR 225,49
AR 226,50
AR 227,51
AR 228,56
AR 229,57
AR 230,58
AR 231,59
v_pk_mul_f32 v[224:225], v[224:225], v[8:9]
v_pk_mul_f32 v[226:227], v[226:227], v[8:9]
v_pk_mul_f32 v[228:229], v[228:229], v[8:9]
v_pk_mul_f32 v[230:231], v[230:231], v[8:9]
CV 152,224,225
CV 153,226,227
CV 154,228,229
CV 155,230,231
buffer_store_dwordx4 v[152:155], v4, s[4:7], s80 offen offset:2048 sc1
AR 232,52
AR 233,53
AR 234,54
AR 235,55
AR 236,60
AR 237,61
AR 238,62
AR 239,63
v_pk_mul_f32 v[232:233], v[232:233], v[8:9]
v_pk_mul_f32 v[234:235], v[234:235], v[8:9]
v_pk_mul_f32 v[236:237], v[236:237], v[8:9]
v_pk_mul_f32 v[238:239], v[238:239], v[8:9]
CV 156,232,233
CV 157,234,235
CV 158,236,237
CV 159,238,239
buffer_store_dwordx4 v[156:159], v4, s[4:7], s80 offen offset:3072 sc1
s_add_u32 s80, s80, 4096
AR 224,64
AR 225,65
AR 226,66
AR 227,67
AR 228,72
AR 229,73
AR 230,74
AR 231,75
v_pk_mul_f32 v[224:225], v[224:225], v[8:9]
v_pk_mul_f32 v[226:227], v[226:227], v[8:9]
v_pk_mul_f32 v[228:229], v[228:229], v[8:9]
v_pk_mul_f32 v[230:231], v[230:231], v[8:9]
CV 160,224,225
CV 161,226,227
CV 162,228,229
CV 163,230,231
buffer_store_dwordx4 v[160:163], v4, s[4:7], s80 offen offset:0 sc1
AR 232,68
AR 233,69
AR 234,70
AR 235,71
AR 236,76
AR 237,77
AR 238,78
AR 239,79
v_pk_mul_f32 v[232:233], v[232:233], v[8:9]
v_pk_mul_f32 v[234:235], v[234:235], v[8:9]
v_pk_mul_f32 v[236:237], v[236:237], v[8:9]
v_pk_mul_f32 v[238:239], v[238:239], v[8:9]
CV 164,232,233
CV 165,234,235
CV 166,236,237
CV 167,238,239
buffer_store_dwordx4 v[164:167], v4, s[4:7], s80 offen offset:1024 sc1
AR 224,80
AR 225,81
AR 226,82
AR 227,83
AR 228,88
AR 229,89
AR 230,90
AR 231,91
v_pk_mul_f32 v[224:225], v[224:225], v[8:9]
v_pk_mul_f32 v[226:227], v[226:227], v[8:9]
v_pk_mul_f32 v[228:229], v[228:229], v[8:9]
v_pk_mul_f32 v[230:231], v[230:231], v[8:9]
CV 168,224,225
CV 169,226,227
CV 170,228,229
CV 171,230,231
buffer_store_dwordx4 v[168:171], v4, s[4:7], s80 offen offset:2048 sc1
AR 232,84
AR 233,85
AR 234,86
AR 235,87
AR 236,92
AR 237,93
AR 238,94
AR 239,95
v_pk_mul_f32 v[232:233], v[232:233], v[8:9]
v_pk_mul_f32 v[234:235], v[234:235], v[8:9]
v_pk_mul_f32 v[236:237], v[236:237], v[8:9]
v_pk_mul_f32 v[238:239], v[238:239], v[8:9]
CV 172,232,233
CV 173,234,235
CV 174,236,237
CV 175,238,239
buffer_store_dwordx4 v[172:175], v4, s[4:7], s80 offen offset:3072 sc1
s_add_u32 s80, s80, 4096
AR 224,96
AR 225,97
AR 226,98
AR 227,99
AR 228,104
AR 229,105
AR 230,106
AR 231,107
v_pk_mul_f32 v[224:225], v[224:225], v[8:9]
v_pk_mul_f32 v[226:227], v[226:227], v[8:9]
v_pk_mul_f32 v[228:229], v[228:229], v[8:9]
v_pk_mul_f32 v[230:231], v[230:231], v[8:9]
CV 176,224,225
CV 177,226,227
CV 178,228,229
CV 179,230,231
buffer_store_dwordx4 v[176:179], v4, s[4:7], s80 offen offset:0 sc1
AR 232,100
AR 233,101
AR 234,102
AR 235,103
AR 236,108
AR 237,109
AR 238,110
AR 239,111
v_pk_mul_f32 v[232:233], v[232:233], v[8:9]
v_pk_mul_f32 v[234:235], v[234:235], v[8:9]
v_pk_mul_f32 v[236:237], v[236:237], v[8:9]
v_pk_mul_f32 v[238:239], v[238:239], v[8:9]
CV 180,232,233
CV 181,234,235
CV 182,236,237
CV 183,238,239
buffer_store_dwordx4 v[180:183], v4, s[4:7], s80 offen offset:1024 sc1
AR 224,112
AR 225,113
AR 226,114
AR 227,115
AR 228,120
AR 229,121
AR 230,122
AR 231,123
v_pk_mul_f32 v[224:225], v[224:225], v[8:9]
v_pk_mul_f32 v[226:227], v[226:227], v[8:9]
v_pk_mul_f32 v[228:229], v[228:229], v[8:9]
v_pk_mul_f32 v[230:231], v[230:231], v[8:9]
CV 184,224,225
CV 185,226,227
CV 186,228,229
CV 187,230,231
buffer_store_dwordx4 v[184:187], v4, s[4:7], s80 offen offset:2048 sc1
AR 232,116
AR 233,117
AR 234,118
AR 235,119
AR 236,124
AR 237,125
AR 238,126
AR 239,127
v_pk_mul_f32 v[232:233], v[232:233], v[8:9]
v_pk_mul_f32 v[234:235], v[234:235], v[8:9]
v_pk_mul_f32 v[236:237], v[236:237], v[8:9]
v_pk_mul_f32 v[238:239], v[238:239], v[8:9]
CV 188,232,233
CV 189,234,235
CV 190,236,237
CV 191,238,239
buffer_store_dwordx4 v[188:191], v4, s[4:7], s80 offen offset:3072 sc1
s_branch EV_22
.text
.globl parallel_sum__compressed_kv_cla__dense_activation_squared_relu__prompt_kernel
.p2align 8
.type parallel_sum__compressed_kv_cla__dense_activation_squared_relu__prompt_kernel,@function
parallel_sum__compressed_kv_cla__dense_activation_squared_relu__prompt_kernel:
s_cmp_lt_u32 s2, 256
s_cbranch_scc1 GO_2
s_endpgm
GO_2:
s_load_dwordx16 s[72:87], s[0:1], 0
s_load_dwordx8 s[88:95], s[0:1], 64
s_load_dwordx4 s[96:99], s[0:1], 96
s_getpc_b64 s[66:67]
PC_3:
s_sub_u32 s66, s66, PC_3-M_CODE_START
s_subb_u32 s67, s67, 0
s_lshr_b32 s4, s2, 3
s_and_b32 s4, s4, 7
s_mul_i32 s4, s4, 18432
v_min_u32 v200, 143, v0
v_lshlrev_b32 v200, 7, v200
v_add_u32 v200, s4, v200
v_min_u32 v200, M_CODE_END-M_CODE_START-4, v200
global_load_dword v31, v200, s[66:67]
v_and_b32 v1, 63, v0
v_lshrrev_b32 v2, 6, v0
v_lshlrev_b32_e64 v4, 4, v1
v_readfirstlane_b32 s44, v2
s_and_b32 s4, s2, 7
s_lshr_b32 s5, s2, 3
s_and_b32 s6, s5, 1
s_lshl_b32 s4, s4, 1
s_add_u32 s45, s4, s6
s_lshr_b32 s5, s5, 1
s_and_b32 s46, s5, 1
s_lshr_b32 s47, s5, 1
s_lshl_b32 s52, s44, 12
s_lshl_b32 s53, s44, 11
s_lshl_b32 s54, s45, 3
s_add_u32 s54, s54, s47
s_lshl_b32 s65, s45, 12
s_add_u32 s65, s65, 0x6100000
s_mov_b32 s4, 0xe12161a
s_mov_b32 s5, 0x60a
s_lshl_b32 s6, s47, 3
s_lshr_b64 s[4:5], s[4:5], s6
s_and_b32 s50, s4, 0xff
s_sub_u32 s49, 15, s47
s_cmp_eq_u32 s46, 0
s_cselect_b32 s48, s49, s47
s_mul_i32 s51, s46, s50
s_mov_b32 s55, 0x3eb8aa3b
s_mov_b32 s100, 0x3e800000
s_mov_b32 s101, 0x3e000000
s_cmp_eq_u32 s46, 0
s_cselect_b32 s100, s100, s101
s_mov_b32 s56, 0x41800000
v_mov_b32 v3, 0x7fffff00
v_cmp_eq_u32 vcc, 0, v0
v_mov_b32 v6, 0
v_lshlrev_b32_e64 v2, 2, v0
v_cndmask_b32 v5, v3, 0, vcc
v_cmp_gt_u32 vcc, 16, v0
s_nop 1
v_cndmask_b32 v30, v3, v2, vcc
s_lshl_b32 s4, s47, 3
s_add_u32 s4, s4, s44
s_lshl_b32 s4, s4, 16
v_lshrrev_b32 v2, 3, v1
v_lshlrev_b32 v2, 11, v2
v_and_b32 v3, 7, v1
v_lshrrev_b32 v200, 4, v1
v_xor_b32 v3, v3, v200
v_add_u32 v2, s4, v2
v_xor_b32_e64 v201, 0, v3
v_lshl_add_u32 v201, v201, 4, v2
v_add_u32 v8, 0, v201
v_xor_b32 v201, 4, v3
v_lshl_add_u32 v201, v201, 4, v2
v_add_u32 v9, 15360, v201
v_xor_b32_e64 v201, 0, v3
v_lshl_add_u32 v201, v201, 4, v2
v_add_u32 v10, 30720, v201
v_xor_b32_e64 v201, 4, v3
v_lshl_add_u32 v201, v201, 4, v2
v_add_u32 v11, 46080, v201
s_lshl_b32 s4, s44, 16
s_lshl_b32 s5, s45, 9
s_add_u32 s4, s4, s5
s_and_b32 s5, s44, 1
s_lshl_b32 s5, s5, 2
v_lshrrev_b32 v200, 5, v1
v_and_b32 v201, 31, v1
v_lshrrev_b32 v202, 1, v201
v_xor_b32 v202, s5, v202
v_and_b32 v203, 1, v201
v_add_u32 v2, 0, v200
v_xor_b32 v2, v202, v2
v_lshl_add_u32 v2, v2, 1, v203
v_lshlrev_b32_e64 v2, 4, v2
v_lshl_add_u32 v2, v200, 13, v2
v_add_u32 v2, 0, v2
v_add_u32 v12, s4, v2
v_add_u32 v2, 2, v200
v_xor_b32 v2, v202, v2
v_lshl_add_u32 v2, v2, 1, v203
v_lshlrev_b32_e64 v2, 4, v2
v_lshl_add_u32 v2, v200, 13, v2
v_add_u32 v2, 15360, v2
v_add_u32 v13, s4, v2
v_add_u32 v2, 0, v200
v_xor_b32_e64 v2, v202, v2
v_lshl_add_u32 v2, v2, 1, v203
v_lshlrev_b32_e64 v2, 4, v2
v_lshl_add_u32 v2, v200, 13, v2
v_add_u32 v2, 30720, v2
v_add_u32 v14, s4, v2
v_add_u32 v2, 2, v200
v_xor_b32_e64 v2, v202, v2
v_lshl_add_u32 v2, v2, 1, v203
v_lshlrev_b32_e64 v2, 4, v2
v_lshl_add_u32 v2, v200, 13, v2
v_add_u32 v2, 46080, v2
v_add_u32_e64 v15, s4, v2
s_mov_b32 s57, -128
s_mov_b32 s58, -262144
s_add_u32 s59, s52, 65536
s_lshl_b32 s4, s2, 3
s_lshl_b32 s5, s44, 1
s_add_u32 s68, s4, s5
s_mul_i32 s69, s68, 896
s_and_b32 s4, s44, 1
s_lshr_b32 s5, s44, 1
s_lshl_b32 s6, s4, 14
s_add_u32 s6, s6, 65536
v_and_b32 v201, 15, v1
v_lshrrev_b32 v200, 4, v1
v_lshrrev_b32 v2, 1, v201
v_add_u32 v3, 0, v200
v_xor_b32 v3, v3, v2
v_lshlrev_b32 v3, 4, v3
v_lshl_add_u32 v3, v201, 7, v3
v_add_u32 v16, s6, v3
v_mov_b32 v18, v16
v_add_u32 v3, 4, v200
v_xor_b32 v3, v3, v2
v_lshlrev_b32_e64 v3, 4, v3
v_lshl_add_u32 v3, v201, 7, v3
v_add_u32 v17, s6, v3
v_mov_b32 v19, v17
v_bfe_u32 v3, v1, 2, 2
v_lshlrev_b32_e64 v202, 12, v200
v_lshl_add_u32 v202, v3, 9, v202
v_and_b32_e64 v2, 3, v1
v_lshl_add_u32 v202, v2, 3, v202
s_lshl_b32 s6, s5, 8
v_add_u32 v202, s6, v202
v_and_b32_e64 v2, 1, v200
v_lshl_or_b32 v3, v2, 2, v3
v_xor_b32_e64 v2, 0, v3
v_lshl_add_u32 v20, v2, 5, v202
v_xor_b32_e64 v2, 1, v3
v_lshl_add_u32 v21, v2, 5, v202
v_xor_b32_e64 v2, 2, v3
v_lshl_add_u32 v22, v2, 5, v202
v_xor_b32_e64 v2, 3, v3
v_lshl_add_u32 v23, v2, 5, v202
v_xor_b32_e64 v2, 4, v3
v_lshl_add_u32 v24, v2, 5, v202
v_xor_b32_e64 v2, 5, v3
v_lshl_add_u32 v25, v2, 5, v202
v_xor_b32_e64 v2, 6, v3
v_lshl_add_u32 v26, v2, 5, v202
v_xor_b32_e64 v2, 7, v3
v_lshl_add_u32 v27, v2, 5, v202
s_mov_b32 s60, 0
v_cmp_gt_u32 vcc, 56, v1
v_lshrrev_b32_e64 v200, 3, v1
v_bfe_u32 v201, v1, 2, 1
v_and_b32 v202, 3, v1
v_lshlrev_b32 v202, 4, v202
v_mul_u32_u24 v2, 896, v201
v_lshl_add_u32 v2, v200, 6, v2
v_add_u32_e64 v2, v2, v202
v_mov_b32 v3, 0x7fffff00
v_cndmask_b32 v192, v3, v2, vcc
v_lshlrev_b32 v2, 10, v200
v_lshl_add_u32 v2, v201, 6, v2
v_add_u32_e64 v2, v2, v202
v_cndmask_b32 v193, v3, v2, vcc
LW 0
s_mov_b32 s4, s98
s_mov_b32 s5, s99
s_mov_b32 s6, 0x10000000
s_mov_b32 s7, 0x00020000
s_mov_b32 s8, s74
s_mov_b32 s9, s75
s_mov_b32 s10, 0x400000
s_mov_b32 s11, 0x00020000
s_mov_b32 s36, s72
s_mov_b32 s37, s73
s_mov_b32 s38, 0x1c0000
s_mov_b32 s39, 0x00020000
s_cmp_eq_u32 s46, 0
s_cselect_b32 s78, s78, s80
s_cselect_b32 s79, s79, s81
s_mov_b32 s12, s78
s_mov_b32 s13, s79
s_mov_b32 s14, 0x800000
s_mov_b32 s15, 0x00020000
s_mov_b32 s16, s76
s_mov_b32 s17, s77
s_mov_b32 s18, 0x380000
s_mov_b32 s19, 0x00020000
s_mov_b32 s20, s86
s_mov_b32 s21, s87
s_mov_b32 s22, 0x188000
s_mov_b32 s23, 0x00020000
s_mov_b32 s24, s82
s_mov_b32 s25, s83
s_mov_b32 s26, 0x380000
s_mov_b32 s27, 0x00020000
s_mov_b32 s28, s90
s_mov_b32 s29, s91
s_mov_b32 s30, 0x188000
s_mov_b32 s31, 0x00020000
s_mov_b32 s32, s88
s_mov_b32 s33, s89
s_mov_b32 s34, 0xe00
s_mov_b32 s35, 0x00020000
s_mov_b32 s40, s96
s_mov_b32 s41, s97
s_mov_b32 s42, 0x100
s_mov_b32 s43, 0x00020000
s_lshr_b32 s72, s45, 2
s_mul_i32 s98, s72, 448
s_and_b32 s72, s45, 3
s_lshl_b32 s73, s72, 7
s_add_u32 s98, s98, s73
s_cmp_eq_u32 s72, 3
s_cselect_b32 s73, 32, 0
s_sub_u32 s98, s98, s73
s_lshr_b32 s99, s72, 1
s_cmp_lg_u32 s2, 0
s_cbranch_scc1 NON_4
s_memrealtime s[72:73]
LW 0
s_or_b32 s74, s72, 1
v_mov_b32 v2, s74
buffer_store_dword v2, v5, s[40:43], 0 offen sc1
NON_4:
s_add_u32 m0, s52, 0
s_nop 0
s_add_u32 s58, s58, 262144
buffer_load_dwordx4 v12, s[12:15], s58 offen lds
buffer_load_dwordx4 v13, s[12:15], s58 offen offset:1024 lds
buffer_load_dwordx4 v14, s[12:15], s58 offen offset:2048 lds
buffer_load_dwordx4 v15, s[12:15], s58 offen offset:3072 lds
s_mov_b32 m0, s59
s_nop 0
s_add_u32 s57, s57, 128
buffer_load_dwordx4 v8, s[8:11], s57 offen lds
buffer_load_dwordx4 v9, s[8:11], s57 offen offset:1024 lds
buffer_load_dwordx4 v10, s[8:11], s57 offen offset:2048 lds
buffer_load_dwordx4 v11, s[8:11], s57 offen offset:3072 lds
s_add_u32 m0, s59, 16384
s_add_u32 s73, s57, 262144
buffer_load_dwordx4 v8, s[8:11], s73 offen lds
buffer_load_dwordx4 v9, s[8:11], s73 offen offset:1024 lds
buffer_load_dwordx4 v10, s[8:11], s73 offen offset:2048 lds
buffer_load_dwordx4 v11, s[8:11], s73 offen offset:3072 lds
s_add_u32 s59, s59, 32768
s_cmp_ge_u32 s59, 163840
s_cselect_b32 s72, 98304, 0
s_sub_u32 s59, s59, s72
s_nop 0
s_add_u32 m0, s52, 16384
s_add_u32 s58, s58, 262144
buffer_load_dwordx4 v12, s[12:15], s58 offen lds
buffer_load_dwordx4 v13, s[12:15], s58 offen offset:1024 lds
buffer_load_dwordx4 v14, s[12:15], s58 offen offset:2048 lds
buffer_load_dwordx4 v15, s[12:15], s58 offen offset:3072 lds
s_mov_b32 m0, s59
s_nop 0
s_add_u32 s57, s57, 128
buffer_load_dwordx4 v8, s[8:11], s57 offen lds
buffer_load_dwordx4 v9, s[8:11], s57 offen offset:1024 lds
buffer_load_dwordx4 v10, s[8:11], s57 offen offset:2048 lds
buffer_load_dwordx4 v11, s[8:11], s57 offen offset:3072 lds
s_add_u32 m0, s52, 32768
s_add_u32 s58, s58, 262144
buffer_load_dwordx4 v12, s[12:15], s58 offen lds
buffer_load_dwordx4 v13, s[12:15], s58 offen offset:1024 lds
buffer_load_dwordx4 v14, s[12:15], s58 offen offset:2048 lds
buffer_load_dwordx4 v15, s[12:15], s58 offen offset:3072 lds
s_add_u32 m0, s59, 16384
s_add_u32 s73, s57, 262144
buffer_load_dwordx4 v8, s[8:11], s73 offen lds
buffer_load_dwordx4 v9, s[8:11], s73 offen offset:1024 lds
buffer_load_dwordx4 v10, s[8:11], s73 offen offset:2048 lds
buffer_load_dwordx4 v11, s[8:11], s73 offen offset:3072 lds
s_add_u32 s59, s59, 32768
s_cmp_ge_u32 s59, 163840
s_cselect_b32 s72, 98304, 0
s_sub_u32 s59, s59, s72
s_nop 0
buffer_load_dwordx4 v[160:163], v192, s[36:39], s69 offen
buffer_load_dwordx4 v[164:167], v192, s[36:39], s69 offen offset:448
s_waitcnt vmcnt(18)
s_barrier
RT 64,20,0
RT 66,20,2048
R4 32,18,0
R4 36,18,2048
R4 40,18,4096
R4 44,18,6144
R4 48,18,8192
R4 52,18,10240
R4 56,18,12288
R4 60,18,14336
RT 68,21,0
RT 70,21,2048
RT 72,22,0
RT 74,22,2048
RT 76,23,0
RT 78,23,2048
RT 80,24,0
RT 82,24,2048
RT 84,25,0
RT 86,25,2048
RT 88,26,0
RT 90,26,2048
RT 92,27,0
RT 94,27,2048
s_cmp_eq_u32 s46, 1
s_cbranch_scc1 AV_5
s_waitcnt vmcnt(14) lgkmcnt(0)
s_barrier
Mavvz 0,64,32
RT 128,20,16384
RT 130,20,18432
Mavvz 4,68,32
R4 96,19,0
s_and_b32 s81, s44, 1
Mavvz 8,64,36
s_lshl_b32 s81, s81, 2
s_mul_i32 s80, s44, 28672
s_lshl_b32 s82, s98, 1
Mavvz 12,68,36
R4 100,19,2048
s_add_u32 s80, s80, s82
Mavvz 16,64,40
v_lshrrev_b32 v200, 4, v1
v_and_b32 v201, 15, v1
Mavvz 20,68,40
R4 104,19,4096
v_lshrrev_b32_e64 v202, 1, v201
Mavvz 24,64,44
v_xor_b32 v202, s81, v202
v_xor_b32 v202, v200, v202
Mavvz 28,68,44
R4 108,19,6144
v_and_b32_e64 v203, 1, v201
Mavvz 32,64,48
v_lshl_add_u32 v2, v202, 1, v203
v_lshlrev_b32_e64 v2, 4, v2
Mavvz 36,68,48
R4 112,19,8192
v_mul_u32_u24 v3, 3584, v200
Mavvz 40,64,52
v_add_u32 v2, v2, v3
v_add_u32 v28, s80, v2
Mavvz 44,68,52
R4 116,19,10240
v_add_u32 v29, 13312, v28
Mavvz 48,64,56
s_lshl_b32 s80, s44, 1
s_sub_u32 s3, 7, s80
v_bfe_u32 v201, v1, 2, 2
Mavvz 52,68,56
R4 120,19,12288
v_lshl_add_u32 v202, v200, 3, v201
Mavvz 56,64,60
R4 124,19,14336
v_and_b32_e64 v203, 3, v1
Mavvz 60,68,60
v_lshlrev_b32_e64 v203, 3, v203
Mavvz 64,72,32
RT 132,21,16384
v_and_b32_e64 v2, 1, v200
Mavvz 68,76,32
v_lshl_or_b32 v201, v2, 2, v201
v_lshl_add_u32 v204, v202, 9, v203
Mavvz 72,72,36
RT 134,21,18432
v_lshl_add_u32 v205, v202, 8, v203
Mavvz 76,76,36
v_add_u32 v205, 98304, v205
Mavvz 80,72,40
RT 136,22,16384
v_xor_b32_e64 v2, 0, v201
Mavvz 84,76,40
v_lshl_add_u32 v240, v2, 5, v204
v_lshl_add_u32 v248, v2, 5, v205
Mavvz 88,72,44
RT 138,22,18432
v_xor_b32_e64 v2, 1, v201
Mavvz 92,76,44
v_lshl_add_u32 v241, v2, 5, v204
Mavvz 96,72,48
RT 140,23,16384
s_add_u32 m0, s52, 49152
Mavvz 100,76,48
s_add_u32 s58, s58, 262144
v_lshl_add_u32 v249, v2, 5, v205
v_xor_b32_e64 v2, 2, v201
Mavvz 104,72,52
RT 142,23,18432
v_lshl_add_u32 v242, v2, 5, v204
Mavvz 108,76,52
buffer_load_dwordx4 v12, s[12:15], s58 offen lds
Mavvz 112,72,56
RT 144,24,16384
v_lshl_add_u32 v250, v2, 5, v205
Mavvz 116,76,56
RT 146,24,18432
v_xor_b32_e64 v2, 3, v201
Mavvz 120,72,60
buffer_load_dwordx4 v13, s[12:15], s58 offen offset:1024 lds
Mavvz 124,76,60
RT 148,25,16384
v_lshl_add_u32 v243, v2, 5, v204
Mavvz 128,80,32
v_lshl_add_u32 v251, v2, 5, v205
v_xor_b32_e64 v2, 4, v201
Mavvz 132,84,32
RT 150,25,18432
v_lshl_add_u32 v244, v2, 5, v204
Mavvz 136,80,36
buffer_load_dwordx4 v14, s[12:15], s58 offen offset:2048 lds
Mavvz 140,84,36
RT 152,26,16384
v_lshl_add_u32 v252, v2, 5, v205
Mavvz 144,80,40
v_xor_b32_e64 v2, 5, v201
v_lshl_add_u32 v245, v2, 5, v204
Mavvz 148,84,40
RT 154,26,18432
v_lshl_add_u32 v253, v2, 5, v205
Mavvz 152,80,44
buffer_load_dwordx4 v15, s[12:15], s58 offen offset:3072 lds
Mavvz 156,84,44
RT 156,27,16384
v_xor_b32_e64 v2, 6, v201
Mavvz 160,80,48
v_lshl_add_u32 v246, v2, 5, v204
v_lshl_add_u32 v254, v2, 5, v205
v_xor_b32_e64 v2, 7, v201
v_lshl_add_u32 v247, v2, 5, v204
v_lshl_add_u32 v255, v2, 5, v205
Mavvz 164,84,48
RT 158,27,18432
s_mov_b32 m0, s59
Mavvz 168,80,52
s_add_u32 s57, s57, 128
Mavvz 172,84,52
Mavvz 176,80,56
buffer_load_dwordx4 v8, s[8:11], s57 offen lds
Mavvz 180,84,56
Mavvz 184,80,60
Mavvz 188,84,60
Mavvz 192,88,32
buffer_load_dwordx4 v9, s[8:11], s57 offen offset:1024 lds
Mavvz 196,92,32
Mavvz 200,88,36
Mavvz 204,92,36
Mavvz 208,88,40
buffer_load_dwordx4 v10, s[8:11], s57 offen offset:2048 lds
Mavvz 212,92,40
Mavvz 216,88,44
Mavvz 220,92,44
Mavvz 224,88,48
buffer_load_dwordx4 v11, s[8:11], s57 offen offset:3072 lds
Mavvz 228,92,48
Mavvz 232,88,52
Mavvz 236,92,52
Mavvz 240,88,56
Mavvz 244,92,56
Mavvz 248,88,60
Mavvz 252,92,60
s_waitcnt vmcnt(10) lgkmcnt(0)
s_barrier
Mavvs 0,128,96
s_add_u32 s60, s60, 32768
s_cmp_ge_u32 s60, 98304
s_cselect_b32 s60, 0, s60
Mavvs 4,132,96
v_add_u32_e64 v18, s60, v16
Mavvs 8,128,100
s_add_u32 m0, s52, 0
s_add_u32 s58, s58, 262144
v_add_u32 v19, s60, v17
Mavvs 12,132,100
RT 64,20,32768
Mavvs 16,128,104
buffer_load_dwordx4 v12, s[12:15], s58 offen lds
Mavvs 20,132,104
RT 66,20,34816
s_waitcnt vmcnt(9)
Mavvs 24,128,108
R4 32,18,0
s_mov_b32 s84, 0xf0f0f0f0
Mavvs 28,132,108
buffer_load_dwordx4 v13, s[12:15], s58 offen offset:1024 lds
Mavvs 32,128,112
R4 36,18,2048
s_mov_b32 s85, 0xf0f0f0f0
Mavvs 36,132,112
v_lshlrev_b32 v168, 16, v160
v_and_b32 v169, 0xffff0000, v160
Mavvs 40,128,116
R4 40,18,4096
v_lshlrev_b32_e64 v170, 16, v161
Mavvs 44,132,116
R4 44,18,6144
v_and_b32 v171, 0xffff0000, v161
Mavvs 48,128,120
buffer_load_dwordx4 v14, s[12:15], s58 offen offset:2048 lds
Mavvs 52,132,120
R4 48,18,8192
v_lshlrev_b32_e64 v172, 16, v162
v_and_b32 v173, 0xffff0000, v162
Mavvs 56,128,124
buffer_load_dwordx4 v15, s[12:15], s58 offen offset:3072 lds
Mavvs 60,132,124
R4 52,18,10240
v_lshlrev_b32_e64 v174, 16, v163
Mavvs 64,136,96
R4 56,18,12288
v_and_b32 v175, 0xffff0000, v163
v_lshlrev_b32_e64 v176, 16, v164
Mavvs 68,140,96
s_add_u32 m0, s59, 16384
v_and_b32 v177, 0xffff0000, v164
v_lshlrev_b32_e64 v178, 16, v165
Mavvs 72,136,100
R4 60,18,14336
v_and_b32 v179, 0xffff0000, v165
v_lshlrev_b32_e64 v180, 16, v166
Mavvs 76,140,100
RT 68,21,32768
s_add_u32 s73, s57, 262144
v_and_b32 v181, 0xffff0000, v166
Mavvs 80,136,104
buffer_load_dwordx4 v8, s[8:11], s73 offen lds
Mavvs 84,140,104
RT 70,21,34816
v_lshlrev_b32_e64 v182, 16, v167
Mavvs 88,136,108
v_and_b32 v183, 0xffff0000, v167
v_add_f32_e64 v184, v168, v169
Mavvs 92,140,108
RT 72,22,32768
v_add_f32_e64 v184, v184, v170
Mavvs 96,136,112
RT 74,22,34816
v_add_f32 v184, v184, v171
v_add_f32 v184, v184, v172
Mavvs 100,140,112
buffer_load_dwordx4 v9, s[8:11], s73 offen offset:1024 lds
Mavvs 104,136,116
RT 76,23,32768
v_add_f32_e64 v184, v184, v173
Mavvs 108,140,116
v_add_f32 v184, v184, v174
v_add_f32 v184, v184, v175
Mavvs 112,136,120
RT 78,23,34816
v_add_f32_e64 v184, v184, v176
Mavvs 116,140,120
RT 80,24,32768
v_add_f32 v184, v184, v177
v_add_f32 v184, v184, v178
Mavvs 120,136,124
buffer_load_dwordx4 v10, s[8:11], s73 offen offset:2048 lds
Mavvs 124,140,124
RT 82,24,34816
v_add_f32 v184, v184, v179
v_add_f32 v184, v184, v180
v_add_f32_e64 v184, v184, v181
Mavvs 128,144,96
buffer_load_dwordx4 v11, s[8:11], s73 offen offset:3072 lds
Mavvs 132,148,96
RT 84,25,32768
v_add_f32_e64 v184, v184, v182
Mavvs 136,144,100
RT 86,25,34816
v_add_f32_e64 v184, v184, v183
Mavvs 140,148,100
s_add_u32 s59, s59, 32768
s_nop 1
v_add_f32 v184, v184, v184 quad_perm:[1,0,3,2] row_mask:0xf bank_mask:0xf
Mavvs 144,144,104
RT 88,26,32768
s_nop 1
Mavvs 148,148,104
s_cmp_ge_u32 s59, 163840
s_cselect_b32 s72, 98304, 0
v_add_f32 v184, v184, v184 quad_perm:[2,3,0,1] row_mask:0xf bank_mask:0xf
Mavvs 152,144,108
RT 90,26,34816
s_nop 1
v_add_f32 v184, v184, v184 row_ror:8 row_mask:0xf bank_mask:0xf
Mavvs 156,148,108
RT 92,27,32768
s_sub_u32 s59, s59, s72
Mavvs 160,144,112
s_nop 1
v_readlane_b32 s86, v184, 0
v_readlane_b32 s87, v184, 16
Mavvs 164,148,112
RT 94,27,34816
s_add_u32 m0, s52, 16384
Mavvs 168,144,116
s_add_u32 s58, s58, 262144
v_readlane_b32 s88, v184, 32
v_readlane_b32 s89, v184, 48
Mavvs 172,148,116
buffer_load_dwordx4 v12, s[12:15], s58 offen lds
Mavvs 176,144,120
v_readlane_b32 s90, v184, 4
v_readlane_b32 s91, v184, 20
Mavvs 180,148,120
v_readlane_b32 s92, v184, 36
v_readlane_b32 s93, v184, 52
Mavvs 184,144,124
s_nop 1
v_mov_b32 v184, s86
v_mov_b32 v187, s90
Mavvs 188,148,124
buffer_load_dwordx4 v13, s[12:15], s58 offen offset:1024 lds
Mavvs 192,152,96
v_add_f32 v184, s87, v184
v_add_f32 v187, s91, v187
Mavvs 196,156,96
v_add_f32 v184, s88, v184
v_add_f32 v187, s92, v187
Mavvs 200,152,100
v_add_f32 v184, s89, v184
v_add_f32 v187, s93, v187
Mavvs 204,156,100
buffer_load_dwordx4 v14, s[12:15], s58 offen offset:2048 lds
Mavvs 208,152,104
v_cndmask_b32 v184, v184, v187, s[84:85]
v_mul_f32 v184, 0x3b124925, v184
Mavvs 212,156,104
v_mov_b32 v185, 0
v_sub_f32 v186, v168, v184
Mavvs 216,152,108
v_fmac_f32 v185, v186, v186
v_sub_f32 v186, v169, v184
Mavvs 220,156,108
buffer_load_dwordx4 v15, s[12:15], s58 offen offset:3072 lds
Mavvs 224,152,112
v_fmac_f32 v185, v186, v186
v_sub_f32 v186, v170, v184
Mavvs 228,156,112
v_fmac_f32 v185, v186, v186
v_sub_f32 v186, v171, v184
Mavvs 232,152,116
v_fmac_f32 v185, v186, v186
v_sub_f32 v186, v172, v184
Mavvs 236,156,116
v_fmac_f32 v185, v186, v186
v_sub_f32 v186, v173, v184
Mavvs 240,152,120
v_fmac_f32 v185, v186, v186
v_sub_f32 v186, v174, v184
Mavvs 244,156,120
v_fmac_f32_e64 v185, v186, v186
Mavvs 248,152,124
Mavvs 252,156,124
s_waitcnt vmcnt(12) lgkmcnt(0)
s_barrier
Mavvs 0,64,32
RT 128,20,49152
RT 130,20,51200
Mavvs 4,68,32
R4 96,19,0
v_sub_f32_e64 v186, v175, v184
Mavvs 8,64,36
s_mov_b32 m0, s59
s_add_u32 s57, s57, 128
v_fmac_f32 v185, v186, v186
Mavvs 12,68,36
R4 100,19,2048
v_sub_f32_e64 v186, v176, v184
Mavvs 16,64,40
buffer_load_dwordx4 v8, s[8:11], s57 offen lds
Mavvs 20,68,40
R4 104,19,4096
v_fmac_f32_e64 v185, v186, v186
Mavvs 24,64,44
buffer_load_dwordx4 v9, s[8:11], s57 offen offset:1024 lds
Mavvs 28,68,44
R4 108,19,6144
v_sub_f32_e64 v186, v177, v184
Mavvs 32,64,48
v_fmac_f32 v185, v186, v186
v_sub_f32 v186, v178, v184
Mavvs 36,68,48
R4 112,19,8192
v_fmac_f32 v185, v186, v186
v_sub_f32 v186, v179, v184
Mavvs 40,64,52
buffer_load_dwordx4 v10, s[8:11], s57 offen offset:2048 lds
Mavvs 44,68,52
R4 116,19,10240
v_fmac_f32_e64 v185, v186, v186
Mavvs 48,64,56
v_sub_f32 v186, v180, v184
v_fmac_f32 v185, v186, v186
Mavvs 52,68,56
R4 120,19,12288
v_sub_f32_e64 v186, v181, v184
Mavvs 56,64,60
R4 124,19,14336
v_fmac_f32 v185, v186, v186
v_sub_f32 v186, v182, v184
Mavvs 60,68,60
buffer_load_dwordx4 v11, s[8:11], s57 offen offset:3072 lds
Mavvs 64,72,32
RT 132,21,49152
v_fmac_f32_e64 v185, v186, v186
Mavvs 68,76,32
s_add_u32 m0, s52, 32768
v_sub_f32 v186, v183, v184
v_fmac_f32 v185, v186, v186
Mavvs 72,72,36
RT 134,21,51200
v_cndmask_b32 v185, 0, v185, vcc
Mavvs 76,76,36
s_add_u32 s58, s58, 262144
s_nop 1
v_add_f32 v185, v185, v185 quad_perm:[1,0,3,2] row_mask:0xf bank_mask:0xf
Mavvs 80,72,40
RT 136,22,49152
s_nop 1
Mavvs 84,76,40
buffer_load_dwordx4 v12, s[12:15], s58 offen lds
Mavvs 88,72,44
RT 138,22,51200
v_add_f32 v185, v185, v185 quad_perm:[2,3,0,1] row_mask:0xf bank_mask:0xf
Mavvs 92,76,44
s_nop 1
v_add_f32 v185, v185, v185 row_ror:8 row_mask:0xf bank_mask:0xf
s_nop 1
Mavvs 96,72,48
RT 140,23,49152
v_readlane_b32 s86, v185, 0
Mavvs 100,76,48
buffer_load_dwordx4 v13, s[12:15], s58 offen offset:1024 lds
Mavvs 104,72,52
RT 142,23,51200
v_readlane_b32 s87, v185, 16
Mavvs 108,76,52
v_readlane_b32 s88, v185, 32
v_readlane_b32 s89, v185, 48
Mavvs 112,72,56
RT 144,24,49152
v_readlane_b32 s90, v185, 4
Mavvs 116,76,56
RT 146,24,51200
v_readlane_b32 s91, v185, 20
v_readlane_b32 s92, v185, 36
Mavvs 120,72,60
buffer_load_dwordx4 v14, s[12:15], s58 offen offset:2048 lds
Mavvs 124,76,60
RT 148,25,49152
v_readlane_b32 s93, v185, 52
s_nop 1
Mavvs 128,80,32
buffer_load_dwordx4 v15, s[12:15], s58 offen offset:3072 lds
Mavvs 132,84,32
RT 150,25,51200
v_mov_b32_e64 v185, s86
Mavvs 136,80,36
v_mov_b32 v187, s90
v_add_f32 v185, s87, v185
Mavvs 140,84,36
RT 152,26,49152
s_add_u32 m0, s59, 16384
Mavvs 144,80,40
v_add_f32 v187, s91, v187
v_add_f32 v185, s88, v185
Mavvs 148,84,40
RT 154,26,51200
s_add_u32 s73, s57, 262144
v_add_f32 v187, s92, v187
v_add_f32 v185, s89, v185
Mavvs 152,80,44
buffer_load_dwordx4 v8, s[8:11], s73 offen lds
Mavvs 156,84,44
RT 156,27,49152
v_add_f32_e64 v187, s93, v187
Mavvs 160,80,48
v_cndmask_b32 v185, v185, v187, s[84:85]
v_mul_f32 v185, 0x3b124925, v185
Mavvs 164,84,48
RT 158,27,51200
CV 184,184,184
v_and_b32 v184, 0xffff0000, v184
Mavvs 168,80,52
buffer_load_dwordx4 v9, s[8:11], s73 offen offset:1024 lds
Mavvs 172,84,52
CV 185,185,185
v_and_b32 v185, 0xffff0000, v185
Mavvs 176,80,56
v_add_f32 v185, 0x3727c5ac, v185
CV 185,185,185
Mavvs 180,84,56
v_and_b32 v185, 0xffff0000, v185
v_sqrt_f32_e64 v185, v185
Mavvs 184,80,60
buffer_load_dwordx4 v10, s[8:11], s73 offen offset:2048 lds
Mavvs 188,84,60
s_nop 0
CV 185,185,185
v_and_b32 v185, 0xffff0000, v185
Mavvs 192,88,32
v_rcp_f32 v186, v185
Mavvs 196,92,32
s_nop 0
v_fma_f32 v187, -v185, v186, 1.0
v_fmac_f32 v186, v187, v186
Mavvs 200,88,36
buffer_load_dwordx4 v11, s[8:11], s73 offen offset:3072 lds
Mavvs 204,92,36
v_sub_f32 v168, v168, v184
v_sub_f32 v169, v169, v184
Mavvs 208,88,40
v_sub_f32 v170, v170, v184
v_sub_f32 v171, v171, v184
Mavvs 212,92,40
s_add_u32 s59, s59, 32768
v_sub_f32 v172, v172, v184
v_sub_f32 v173, v173, v184
Mavvs 216,88,44
v_sub_f32_e64 v174, v174, v184
Mavvs 220,92,44
s_cmp_ge_u32 s59, 163840
s_cselect_b32 s72, 98304, 0
v_sub_f32_e64 v175, v175, v184
Mavvs 224,88,48
v_sub_f32 v176, v176, v184
v_sub_f32 v177, v177, v184
Mavvs 228,92,48
s_sub_u32 s59, s59, s72
v_sub_f32 v178, v178, v184
Mavvs 232,88,52
v_sub_f32_e64 v179, v179, v184
Mavvs 236,92,52
v_sub_f32_e64 v180, v180, v184
Mavvs 240,88,56
v_sub_f32_e64 v181, v181, v184
Mavvs 244,92,56
v_sub_f32_e64 v182, v182, v184
Mavvs 248,88,60
Mavvs 252,92,60
s_waitcnt vmcnt(16) lgkmcnt(0)
s_barrier
Mavvs 0,128,96
s_add_u32 s60, s60, 32768
s_cmp_ge_u32 s60, 98304
s_cselect_b32 s60, 0, s60
Mavvs 4,132,96
v_add_u32 v18, s60, v16
v_sub_f32_e64 v183, v183, v184
Mavvs 8,128,100
s_add_u32 m0, s52, 49152
s_add_u32 s58, s58, 262144
v_add_u32_e64 v19, s60, v17
Mavvs 12,132,100
RT 64,20,0
CV 208,168,169
Mavvs 16,128,104
buffer_load_dwordx4 v12, s[12:15], s58 offen lds
Mavvs 20,132,104
RT 66,20,2048
CV 209,170,171
Mavvs 24,128,108
R4 32,18,0
CV 210,172,173
CV 211,174,175
Mavvs 28,132,108
CV 212,176,177
CV 213,178,179
Mavvs 32,128,112
R4 36,18,2048
CV 214,180,181
Mavvs 36,132,112
CV 215,182,183
v_lshlrev_b32_e64 v168, 16, v208
v_and_b32 v169, 0xffff0000, v208
Mavvs 40,128,116
buffer_load_dwordx4 v13, s[12:15], s58 offen offset:1024 lds
Mavvs 44,132,116
R4 40,18,4096
R4 44,18,6144
Mavvs 48,128,120
v_lshlrev_b32_e64 v170, 16, v209
v_and_b32 v171, 0xffff0000, v209
Mavvs 52,132,120
R4 48,18,8192
v_lshlrev_b32_e64 v172, 16, v210
Mavvs 56,128,124
v_and_b32 v173, 0xffff0000, v210
v_lshlrev_b32_e64 v174, 16, v211
Mavvs 60,132,124
R4 52,18,10240
v_and_b32 v175, 0xffff0000, v211
v_lshlrev_b32_e64 v176, 16, v212
Mavvs 64,136,96
buffer_load_dwordx4 v14, s[12:15], s58 offen offset:2048 lds
Mavvs 68,140,96
R4 56,18,12288
v_and_b32 v177, 0xffff0000, v212
Mavvs 72,136,100
R4 60,18,14336
v_lshlrev_b32_e64 v178, 16, v213
v_and_b32 v179, 0xffff0000, v213
Mavvs 76,140,100
RT 68,21,0
v_lshlrev_b32_e64 v180, 16, v214
Mavvs 80,136,104
v_and_b32 v181, 0xffff0000, v214
v_lshlrev_b32_e64 v182, 16, v215
Mavvs 84,140,104
RT 70,21,2048
v_and_b32 v183, 0xffff0000, v215
v_mul_f32_e64 v168, v168, v186
Mavvs 88,136,108
buffer_load_dwordx4 v15, s[12:15], s58 offen offset:3072 lds
Mavvs 92,140,108
RT 72,22,0
v_mul_f32_e64 v169, v169, v186
Mavvs 96,136,112
RT 74,22,2048
v_mul_f32 v170, v170, v186
v_mul_f32 v171, v171, v186
Mavvs 100,140,112
v_mul_f32 v172, v172, v186
v_mul_f32 v173, v173, v186
Mavvs 104,136,116
RT 76,23,0
v_mul_f32_e64 v174, v174, v186
Mavvs 108,140,116
v_mul_f32 v175, v175, v186
v_mul_f32 v176, v176, v186
Mavvs 112,136,120
s_mov_b32 m0, s59
RT 78,23,2048
Mavvs 116,140,120
RT 80,24,0
v_mul_f32 v177, v177, v186
v_mul_f32_e64 v178, v178, v186
Mavvs 120,136,124
s_add_u32 s57, s57, 128
v_mul_f32 v179, v179, v186
v_mul_f32 v180, v180, v186
Mavvs 124,140,124
RT 82,24,2048
v_mul_f32 v181, v181, v186
v_mul_f32 v182, v182, v186
Mavvs 128,144,96
buffer_load_dwordx4 v8, s[8:11], s57 offen lds
Mavvs 132,148,96
RT 84,25,0
v_mul_f32_e64 v183, v183, v186
Mavvs 136,144,100
RT 86,25,2048
CV 208,168,169
Mavvs 140,148,100
CV 209,170,171
CV 210,172,173
Mavvs 144,144,104
RT 88,26,0
CV 211,174,175
Mavvs 148,148,104
CV 212,176,177
CV 213,178,179
CV 214,180,181
CV 215,182,183
Mavvs 152,144,108
buffer_load_dwordx4 v9, s[8:11], s57 offen offset:1024 lds
Mavvs 156,148,108
RT 90,26,2048
RT 92,27,0
Mavvs 160,144,112
s_lshr_b32 s76, s68, 4
s_mul_i32 s76, s76, 14*1024
s_and_b32 s77, s68, 15
Mavvs 164,148,112
RT 94,27,2048
s_lshl_b32 s77, s77, 6
Mavvs 168,144,116
s_add_u32 s76, s76, s77
s_add_u32 s76, s76, 0x2000000
s_add_u32 s77, s76, 7168
Mavvs 172,148,116
buffer_store_dwordx4 v[208:211], v193, s[4:7], s76 offen sc1
Mavvs 176,144,120
buffer_load_dwordx4 v10, s[8:11], s57 offen offset:2048 lds
Mavvs 180,148,120
buffer_store_dwordx4 v[212:215], v193, s[4:7], s77 offen sc1
Mavvs 184,144,124
Mavvs 188,148,124
Mavvs 192,152,96
Mavvs 196,156,96
Mavvs 200,152,100
buffer_load_dwordx4 v11, s[8:11], s57 offen offset:3072 lds
Mavvs 204,156,100
Mavvs 208,152,104
Mavvs 212,156,104
Mavvs 216,152,108
Mavvs 220,156,108
Mavvs 224,152,112
Mavvs 228,156,112
Mavvs 232,152,116
Mavvs 236,156,116
Mavvs 240,152,120
Mavvs 244,156,120
Mavvs 248,152,124
Mavvs 252,156,124
s_mov_b32 s61, 1
AL_7:
s_waitcnt vmcnt(16) lgkmcnt(0)
s_barrier
Mavvs 0,64,32
RT 128,20,16384
RT 130,20,18432
Mavvs 4,68,32
R4 96,19,0
Mavvs 8,64,36
s_add_u32 m0, s52, 0
s_add_u32 s58, s58, 262144
Mavvs 12,68,36
buffer_load_dwordx4 v12, s[12:15], s58 offen lds
Mavvs 16,64,40
R4 100,19,2048
Mavvs 20,68,40
R4 104,19,4096
Mavvs 24,64,44
Mavvs 28,68,44
R4 108,19,6144
Mavvs 32,64,48
buffer_load_dwordx4 v13, s[12:15], s58 offen offset:1024 lds
Mavvs 36,68,48
R4 112,19,8192
Mavvs 40,64,52
Mavvs 44,68,52
R4 116,19,10240
Mavvs 48,64,56
Mavvs 52,68,56
R4 120,19,12288
Mavvs 56,64,60
buffer_load_dwordx4 v14, s[12:15], s58 offen offset:2048 lds
Mavvs 60,68,60
R4 124,19,14336
Mavvs 64,72,32
RT 132,21,16384
Mavvs 68,76,32
Mavvs 72,72,36
RT 134,21,18432
Mavvs 76,76,36
buffer_load_dwordx4 v15, s[12:15], s58 offen offset:3072 lds
Mavvs 80,72,40
RT 136,22,16384
Mavvs 84,76,40
Mavvs 88,72,44
RT 138,22,18432
Mavvs 92,76,44
Mavvs 96,72,48
s_add_u32 m0, s59, 16384
RT 140,23,16384
Mavvs 100,76,48
Mavvs 104,72,52
s_add_u32 s73, s57, 262144
RT 142,23,18432
Mavvs 108,76,52
Mavvs 112,72,56
buffer_load_dwordx4 v8, s[8:11], s73 offen lds
Mavvs 116,76,56
RT 144,24,16384
RT 146,24,18432
Mavvs 120,72,60
Mavvs 124,76,60
RT 148,25,16384
Mavvs 128,80,32
Mavvs 132,84,32
buffer_load_dwordx4 v9, s[8:11], s73 offen offset:1024 lds
Mavvs 136,80,36
RT 150,25,18432
Mavvs 140,84,36
RT 152,26,16384
Mavvs 144,80,40
Mavvs 148,84,40
RT 154,26,18432
Mavvs 152,80,44
Mavvs 156,84,44
buffer_load_dwordx4 v10, s[8:11], s73 offen offset:2048 lds
Mavvs 160,80,48
RT 156,27,16384
Mavvs 164,84,48
RT 158,27,18432
Mavvs 168,80,52
Mavvs 172,84,52
Mavvs 176,80,56
buffer_load_dwordx4 v11, s[8:11], s73 offen offset:3072 lds
Mavvs 180,84,56
Mavvs 184,80,60
Mavvs 188,84,60
Mavvs 192,88,32
Mavvs 196,92,32
s_add_u32 s59, s59, 32768
Mavvs 200,88,36
Mavvs 204,92,36
s_cmp_ge_u32 s59, 163840
s_cselect_b32 s72, 98304, 0
Mavvs 208,88,40
Mavvs 212,92,40
Mavvs 216,88,44
Mavvs 220,92,44
s_sub_u32 s59, s59, s72
Mavvs 224,88,48
Mavvs 228,92,48
Mavvs 232,88,52
Mavvs 236,92,52
Mavvs 240,88,56
Mavvs 244,92,56
Mavvs 248,88,60
Mavvs 252,92,60
s_waitcnt vmcnt(16) lgkmcnt(0)
s_barrier
Mavvs 0,128,96
s_add_u32 s60, s60, 32768
s_cmp_ge_u32 s60, 98304
s_cselect_b32 s60, 0, s60
Mavvs 4,132,96
v_add_u32_e64 v18, s60, v16
Mavvs 8,128,100
s_add_u32 m0, s52, 16384
s_add_u32 s58, s58, 262144
v_add_u32_e64 v19, s60, v17
Mavvs 12,132,100
RT 64,20,32768
Mavvs 16,128,104
buffer_load_dwordx4 v12, s[12:15], s58 offen lds
Mavvs 20,132,104
RT 66,20,34816
Mavvs 24,128,108
R4 32,18,0
Mavvs 28,132,108
Mavvs 32,128,112
R4 36,18,2048
Mavvs 36,132,112
Mavvs 40,128,116
buffer_load_dwordx4 v13, s[12:15], s58 offen offset:1024 lds
Mavvs 44,132,116
R4 40,18,4096
R4 44,18,6144
Mavvs 48,128,120
Mavvs 52,132,120
R4 48,18,8192
Mavvs 56,128,124
Mavvs 60,132,124
R4 52,18,10240
Mavvs 64,136,96
buffer_load_dwordx4 v14, s[12:15], s58 offen offset:2048 lds
Mavvs 68,140,96
R4 56,18,12288
Mavvs 72,136,100
R4 60,18,14336
Mavvs 76,140,100
RT 68,21,32768
Mavvs 80,136,104
Mavvs 84,140,104
RT 70,21,34816
Mavvs 88,136,108
buffer_load_dwordx4 v15, s[12:15], s58 offen offset:3072 lds
Mavvs 92,140,108
RT 72,22,32768
Mavvs 96,136,112
RT 74,22,34816
Mavvs 100,140,112
Mavvs 104,136,116
RT 76,23,32768
Mavvs 108,140,116
Mavvs 112,136,120
s_mov_b32 m0, s59
RT 78,23,34816
Mavvs 116,140,120
RT 80,24,32768
Mavvs 120,136,124
s_add_u32 s57, s57, 128
Mavvs 124,140,124
RT 82,24,34816
Mavvs 128,144,96
buffer_load_dwordx4 v8, s[8:11], s57 offen lds
Mavvs 132,148,96
RT 84,25,32768
Mavvs 136,144,100
RT 86,25,34816
Mavvs 140,148,100
Mavvs 144,144,104
RT 88,26,32768
Mavvs 148,148,104
Mavvs 152,144,108
buffer_load_dwordx4 v9, s[8:11], s57 offen offset:1024 lds
Mavvs 156,148,108
RT 90,26,34816
RT 92,27,32768
Mavvs 160,144,112
Mavvs 164,148,112
RT 94,27,34816
Mavvs 168,144,116
Mavvs 172,148,116
Mavvs 176,144,120
buffer_load_dwordx4 v10, s[8:11], s57 offen offset:2048 lds
Mavvs 180,148,120
Mavvs 184,144,124
Mavvs 188,148,124
Mavvs 192,152,96
Mavvs 196,156,96
Mavvs 200,152,100
buffer_load_dwordx4 v11, s[8:11], s57 offen offset:3072 lds
Mavvs 204,156,100
Mavvs 208,152,104
Mavvs 212,156,104
Mavvs 216,152,108
Mavvs 220,156,108
Mavvs 224,152,112
Mavvs 228,156,112
Mavvs 232,152,116
Mavvs 236,156,116
Mavvs 240,152,120
Mavvs 244,156,120
Mavvs 248,152,124
Mavvs 252,156,124
s_waitcnt vmcnt(16) lgkmcnt(0)
s_barrier
Mavvs 0,64,32
RT 128,20,49152
RT 130,20,51200
Mavvs 4,68,32
R4 96,19,0
Mavvs 8,64,36
s_add_u32 m0, s52, 32768
s_add_u32 s58, s58, 262144
Mavvs 12,68,36
buffer_load_dwordx4 v12, s[12:15], s58 offen lds
Mavvs 16,64,40
R4 100,19,2048
Mavvs 20,68,40
R4 104,19,4096
Mavvs 24,64,44
Mavvs 28,68,44
R4 108,19,6144
Mavvs 32,64,48
buffer_load_dwordx4 v13, s[12:15], s58 offen offset:1024 lds
Mavvs 36,68,48
R4 112,19,8192
Mavvs 40,64,52
Mavvs 44,68,52
R4 116,19,10240
Mavvs 48,64,56
Mavvs 52,68,56
R4 120,19,12288
Mavvs 56,64,60
buffer_load_dwordx4 v14, s[12:15], s58 offen offset:2048 lds
Mavvs 60,68,60
R4 124,19,14336
Mavvs 64,72,32
RT 132,21,49152
Mavvs 68,76,32
Mavvs 72,72,36
RT 134,21,51200
Mavvs 76,76,36
buffer_load_dwordx4 v15, s[12:15], s58 offen offset:3072 lds
Mavvs 80,72,40
RT 136,22,49152
Mavvs 84,76,40
Mavvs 88,72,44
RT 138,22,51200
Mavvs 92,76,44
Mavvs 96,72,48
s_add_u32 m0, s59, 16384
RT 140,23,49152
Mavvs 100,76,48
Mavvs 104,72,52
s_add_u32 s73, s57, 262144
RT 142,23,51200
Mavvs 108,76,52
Mavvs 112,72,56
buffer_load_dwordx4 v8, s[8:11], s73 offen lds
Mavvs 116,76,56
RT 144,24,49152
RT 146,24,51200
Mavvs 120,72,60
Mavvs 124,76,60
RT 148,25,49152
Mavvs 128,80,32
Mavvs 132,84,32
buffer_load_dwordx4 v9, s[8:11], s73 offen offset:1024 lds
Mavvs 136,80,36
RT 150,25,51200
Mavvs 140,84,36
RT 152,26,49152
Mavvs 144,80,40
Mavvs 148,84,40
RT 154,26,51200
Mavvs 152,80,44
Mavvs 156,84,44
buffer_load_dwordx4 v10, s[8:11], s73 offen offset:2048 lds
Mavvs 160,80,48
RT 156,27,49152
Mavvs 164,84,48
RT 158,27,51200
Mavvs 168,80,52
Mavvs 172,84,52
Mavvs 176,80,56
buffer_load_dwordx4 v11, s[8:11], s73 offen offset:3072 lds
Mavvs 180,84,56
Mavvs 184,80,60
Mavvs 188,84,60
Mavvs 192,88,32
Mavvs 196,92,32
s_add_u32 s59, s59, 32768
Mavvs 200,88,36
Mavvs 204,92,36
s_cmp_ge_u32 s59, 163840
s_cselect_b32 s72, 98304, 0
Mavvs 208,88,40
Mavvs 212,92,40
Mavvs 216,88,44
Mavvs 220,92,44
s_sub_u32 s59, s59, s72
Mavvs 224,88,48
Mavvs 228,92,48
Mavvs 232,88,52
Mavvs 236,92,52
Mavvs 240,88,56
Mavvs 244,92,56
Mavvs 248,88,60
Mavvs 252,92,60
s_waitcnt vmcnt(16) lgkmcnt(0)
s_barrier
Mavvs 0,128,96
s_add_u32 s60, s60, 32768
s_cmp_ge_u32 s60, 98304
s_cselect_b32 s60, 0, s60
Mavvs 4,132,96
v_add_u32 v18, s60, v16
Mavvs 8,128,100
s_add_u32 m0, s52, 49152
s_add_u32 s58, s58, 262144
v_add_u32_e64 v19, s60, v17
Mavvs 12,132,100
RT 64,20,0
Mavvs 16,128,104
buffer_load_dwordx4 v12, s[12:15], s58 offen lds
Mavvs 20,132,104
RT 66,20,2048
Mavvs 24,128,108
R4 32,18,0
Mavvs 28,132,108
Mavvs 32,128,112
R4 36,18,2048
Mavvs 36,132,112
Mavvs 40,128,116
buffer_load_dwordx4 v13, s[12:15], s58 offen offset:1024 lds
Mavvs 44,132,116
R4 40,18,4096
R4 44,18,6144
Mavvs 48,128,120
Mavvs 52,132,120
R4 48,18,8192
Mavvs 56,128,124
Mavvs 60,132,124
R4 52,18,10240
Mavvs 64,136,96
buffer_load_dwordx4 v14, s[12:15], s58 offen offset:2048 lds
Mavvs 68,140,96
R4 56,18,12288
Mavvs 72,136,100
R4 60,18,14336
Mavvs 76,140,100
RT 68,21,0
Mavvs 80,136,104
Mavvs 84,140,104
RT 70,21,2048
Mavvs 88,136,108
buffer_load_dwordx4 v15, s[12:15], s58 offen offset:3072 lds
Mavvs 92,140,108
RT 72,22,0
Mavvs 96,136,112
RT 74,22,2048
Mavvs 100,140,112
Mavvs 104,136,116
RT 76,23,0
Mavvs 108,140,116
Mavvs 112,136,120
s_mov_b32 m0, s59
RT 78,23,2048
Mavvs 116,140,120
RT 80,24,0
Mavvs 120,136,124
s_add_u32 s57, s57, 128
Mavvs 124,140,124
RT 82,24,2048
Mavvs 128,144,96
buffer_load_dwordx4 v8, s[8:11], s57 offen lds
Mavvs 132,148,96
RT 84,25,0
Mavvs 136,144,100
RT 86,25,2048
Mavvs 140,148,100
Mavvs 144,144,104
RT 88,26,0
Mavvs 148,148,104
Mavvs 152,144,108
buffer_load_dwordx4 v9, s[8:11], s57 offen offset:1024 lds
Mavvs 156,148,108
RT 90,26,2048
RT 92,27,0
Mavvs 160,144,112
Mavvs 164,148,112
RT 94,27,2048
Mavvs 168,144,116
Mavvs 172,148,116
Mavvs 176,144,120
buffer_load_dwordx4 v10, s[8:11], s57 offen offset:2048 lds
Mavvs 180,148,120
Mavvs 184,144,124
Mavvs 188,148,124
Mavvs 192,152,96
Mavvs 196,156,96
Mavvs 200,152,100
buffer_load_dwordx4 v11, s[8:11], s57 offen offset:3072 lds
Mavvs 204,156,100
Mavvs 208,152,104
Mavvs 212,156,104
Mavvs 216,152,108
Mavvs 220,156,108
Mavvs 224,152,112
Mavvs 228,156,112
Mavvs 232,152,116
Mavvs 236,156,116
Mavvs 240,152,120
Mavvs 244,156,120
Mavvs 248,152,124
Mavvs 252,156,124
s_add_u32 s61, s61, 1
s_cmp_lg_u32 s44, 0
s_cbranch_scc1 AM_9
s_cmp_lg_u32 s61, 2
s_cbranch_scc1 AM_8
v_mov_b32_e64 v2, 0
buffer_load_dword v6, v2, s[40:43], 0 offen
AM_8:
s_cmp_lg_u32 s61, 4
s_cbranch_scc1 AM_9
s_mov_b32 s77, 0
AM_10:
v_readfirstlane_b32 s76, v6
s_cmp_lg_u32 s76, 0
s_cbranch_scc1 AM_11
s_sleep 8
v_mov_b32 v2, 0
buffer_load_dword v6, v2, s[40:43], 0 offen sc1
s_waitcnt vmcnt(0)
s_add_u32 s77, s77, 1
s_cmp_lt_u32 s77, 20000
s_cbranch_scc1 AM_10
AM_11:
s_lshr_b32 s76, s2, 4
s_lshl_b32 s76, s76, 12
s_add_u32 s76, s76, 0x6110000
s_and_b32 s77, s2, 15
s_lshl_b32 s77, s77, 2
s_add_u32 s76, s76, s77
buffer_store_dword v6, v5, s[4:7], s76 offen sc1
s_cmp_lg_u32 s45, 0
s_cbranch_scc1 AM_9
s_lshl_b32 s76, s48, 12
s_add_u32 s76, s76, 0x6150000
v_mov_b32 v2, 0
buffer_store_dword v2, v5, s[4:7], s76 offen sc1
AM_9:
s_cmp_lt_u32 s61, 6
s_cbranch_scc1 AL_7
s_waitcnt vmcnt(16) lgkmcnt(0)
s_barrier
Mavvs 0,64,32
RT 128,20,16384
RT 130,20,18432
Mavvs 4,68,32
R4 96,19,0
Mavvs 8,64,36
s_add_u32 m0, s52, 0
s_add_u32 s58, s58, 262144
Mavvs 12,68,36
buffer_load_dwordx4 v12, s[12:15], s58 offen lds
Mavvs 16,64,40
R4 100,19,2048
Mavvs 20,68,40
R4 104,19,4096
Mavvs 24,64,44
Mavvs 28,68,44
R4 108,19,6144
Mavvs 32,64,48
buffer_load_dwordx4 v13, s[12:15], s58 offen offset:1024 lds
Mavvs 36,68,48
R4 112,19,8192
Mavvs 40,64,52
Mavvs 44,68,52
R4 116,19,10240
Mavvs 48,64,56
Mavvs 52,68,56
R4 120,19,12288
Mavvs 56,64,60
buffer_load_dwordx4 v14, s[12:15], s58 offen offset:2048 lds
Mavvs 60,68,60
R4 124,19,14336
Mavvs 64,72,32
RT 132,21,16384
Mavvs 68,76,32
Mavvs 72,72,36
RT 134,21,18432
Mavvs 76,76,36
buffer_load_dwordx4 v15, s[12:15], s58 offen offset:3072 lds
Mavvs 80,72,40
RT 136,22,16384
Mavvs 84,76,40
Mavvs 88,72,44
RT 138,22,18432
Mavvs 92,76,44
Mavvs 96,72,48
s_add_u32 m0, s59, 16384
RT 140,23,16384
Mavvs 100,76,48
Mavvs 104,72,52
s_add_u32 s73, s57, 262144
RT 142,23,18432
Mavvs 108,76,52
Mavvs 112,72,56
buffer_load_dwordx4 v8, s[8:11], s73 offen lds
Mavvs 116,76,56
RT 144,24,16384
RT 146,24,18432
Mavvs 120,72,60
Mavvs 124,76,60
RT 148,25,16384
Mavvs 128,80,32
Mavvs 132,84,32
buffer_load_dwordx4 v9, s[8:11], s73 offen offset:1024 lds
Mavvs 136,80,36
RT 150,25,18432
Mavvs 140,84,36
RT 152,26,16384
Mavvs 144,80,40
Mavvs 148,84,40
RT 154,26,18432
Mavvs 152,80,44
Mavvs 156,84,44
buffer_load_dwordx4 v10, s[8:11], s73 offen offset:2048 lds
Mavvs 160,80,48
RT 156,27,16384
Mavvs 164,84,48
RT 158,27,18432
Mavvs 168,80,52
Mavvs 172,84,52
Mavvs 176,80,56
buffer_load_dwordx4 v11, s[8:11], s73 offen offset:3072 lds
Mavvs 180,84,56
Mavvs 184,80,60
Mavvs 188,84,60
Mavvs 192,88,32
Mavvs 196,92,32
s_add_u32 s59, s59, 32768
Mavvs 200,88,36
Mavvs 204,92,36
s_cmp_ge_u32 s59, 163840
s_cselect_b32 s72, 98304, 0
Mavvs 208,88,40
Mavvs 212,92,40
Mavvs 216,88,44
Mavvs 220,92,44
s_sub_u32 s59, s59, s72
Mavvs 224,88,48
Mavvs 228,92,48
Mavvs 232,88,52
Mavvs 236,92,52
Mavvs 240,88,56
Mavvs 244,92,56
Mavvs 248,88,60
Mavvs 252,92,60
s_waitcnt vmcnt(16) lgkmcnt(0)
s_barrier
Mavvs 0,128,96
s_add_u32 s60, s60, 32768
s_cmp_ge_u32 s60, 98304
s_cselect_b32 s60, 0, s60
Mavvs 4,132,96
v_add_u32 v18, s60, v16
Mavvs 8,128,100
s_add_u32 m0, s52, 16384
s_add_u32 s58, s58, 262144
v_add_u32_e64 v19, s60, v17
Mavvs 12,132,100
RT 64,20,32768
Mavvs 16,128,104
buffer_load_dwordx4 v12, s[12:15], s58 offen lds
Mavvs 20,132,104
RT 66,20,34816
Mavvs 24,128,108
R4 32,18,0
Mavvs 28,132,108
Mavvs 32,128,112
R4 36,18,2048
Mavvs 36,132,112
Mavvs 40,128,116
buffer_load_dwordx4 v13, s[12:15], s58 offen offset:1024 lds
Mavvs 44,132,116
R4 40,18,4096
R4 44,18,6144
Mavvs 48,128,120
Mavvs 52,132,120
R4 48,18,8192
Mavvs 56,128,124
Mavvs 60,132,124
R4 52,18,10240
Mavvs 64,136,96
buffer_load_dwordx4 v14, s[12:15], s58 offen offset:2048 lds
Mavvs 68,140,96
R4 56,18,12288
Mavvs 72,136,100
R4 60,18,14336
Mavvs 76,140,100
RT 68,21,32768
Mavvs 80,136,104
Mavvs 84,140,104
RT 70,21,34816
Mavvs 88,136,108
buffer_load_dwordx4 v15, s[12:15], s58 offen offset:3072 lds
Mavvs 92,140,108
RT 72,22,32768
Mavvs 96,136,112
RT 74,22,34816
Mavvs 100,140,112
Mavvs 104,136,116
RT 76,23,32768
Mavvs 108,140,116
Mavvs 112,136,120
s_mov_b32 m0, s59
RT 78,23,34816
Mavvs 116,140,120
RT 80,24,32768
Mavvs 120,136,124
s_add_u32 s57, s57, 128
Mavvs 124,140,124
RT 82,24,34816
Mavvs 128,144,96
buffer_load_dwordx4 v8, s[8:11], s57 offen lds
Mavvs 132,148,96
RT 84,25,32768
Mavvs 136,144,100
RT 86,25,34816
Mavvs 140,148,100
Mavvs 144,144,104
RT 88,26,32768
Mavvs 148,148,104
Mavvs 152,144,108
buffer_load_dwordx4 v9, s[8:11], s57 offen offset:1024 lds
Mavvs 156,148,108
RT 90,26,34816
RT 92,27,32768
Mavvs 160,144,112
Mavvs 164,148,112
RT 94,27,34816
Mavvs 168,144,116
Mavvs 172,148,116
Mavvs 176,144,120
buffer_load_dwordx4 v10, s[8:11], s57 offen offset:2048 lds
Mavvs 180,148,120
Mavvs 184,144,124
s_mul_i32 s62, s45, 2097152
s_add_u32 s62, s62, 0x8000000
s_mul_i32 s76, s47, 262144
Mavvs 188,148,124
s_add_u32 s62, s62, s76
s_and_b32 s76, s44, 1
Mavvs 192,152,96
s_mul_i32 s76, s76, 131072
Mavvs 196,156,96
s_add_u32 s62, s62, s76
Mavvs 200,152,100
buffer_load_dwordx4 v11, s[8:11], s57 offen offset:3072 lds
Mavvs 204,156,100
s_lshr_b32 s76, s44, 1
s_lshl_b32 s76, s76, 12
Mavvs 208,152,104
s_add_u32 s62, s62, s76
Mavvs 212,156,104
s_mov_b32 s86, 8192
Mavvs 216,152,108
s_mov_b32 s87, 24576
Mavvs 220,156,108
s_mov_b32 s88, 24576
Mavvs 224,152,112
s_mov_b32 s89, -105472
Mavvs 228,156,112
s_lshl_b32 s76, s48, 3
Mavvs 232,152,116
s_add_u32 s76, s76, s44
Mavvs 236,156,116
s_mul_i32 s76, s76, 14336
Mavvs 240,152,120
s_add_u32 s71, s76, 0x2000000
Mavvs 244,156,120
Mavvs 248,152,124
Mavvs 252,156,124
s_waitcnt vmcnt(16) lgkmcnt(0)
s_barrier
Mavvs 0,64,32
RT 128,20,49152
RT 130,20,51200
Mavvs 4,68,32
R4 96,19,0
Mavvs 8,64,36
s_add_u32 m0, s52, 32768
s_add_u32 s58, s58, 262144
Mavvs 12,68,36
buffer_load_dwordx4 v12, s[12:15], s58 offen lds
Mavvs 16,64,40
R4 100,19,2048
Mavvs 20,68,40
R4 104,19,4096
s_lshl_b32 s70, s48, 12
Mavvs 24,64,44
s_add_u32 s70, s70, 0x6110000
Mavvs 28,68,44
R4 108,19,6144
Mavvs 32,64,48
buffer_load_dwordx4 v13, s[12:15], s58 offen offset:1024 lds
Mavvs 36,68,48
R4 112,19,8192
Mavvs 40,64,52
buffer_load_dword v7, v30, s[4:7], s70 offen sc1
Mavvs 44,68,52
R4 116,19,10240
Mavvs 48,64,56
Mavvs 52,68,56
R4 120,19,12288
Mavvs 56,64,60
buffer_load_dwordx4 v14, s[12:15], s58 offen offset:2048 lds
Mavvs 60,68,60
R4 124,19,14336
Mavvs 64,72,32
RT 132,21,49152
Mavvs 68,76,32
Mavvs 72,72,36
RT 134,21,51200
Mavvs 76,76,36
buffer_load_dwordx4 v15, s[12:15], s58 offen offset:3072 lds
Mavvs 80,72,40
RT 136,22,49152
Mavvs 84,76,40
Mavvs 88,72,44
RT 138,22,51200
Mavvs 92,76,44
Mavvs 96,72,48
s_add_u32 m0, s59, 16384
RT 140,23,49152
Mavvs 100,76,48
Mavvs 104,72,52
s_add_u32 s73, s57, 262144
RT 142,23,51200
Mavvs 108,76,52
Mavvs 112,72,56
buffer_load_dwordx4 v8, s[8:11], s73 offen lds
Mavvs 116,76,56
RT 144,24,49152
RT 146,24,51200
Mavvs 120,72,60
Mavvs 124,76,60
RT 148,25,49152
Mavvs 128,80,32
Mavvs 132,84,32
buffer_load_dwordx4 v9, s[8:11], s73 offen offset:1024 lds
Mavvs 136,80,36
RT 150,25,51200
Mavvs 140,84,36
RT 152,26,49152
Mavvs 144,80,40
Mavvs 148,84,40
RT 154,26,51200
Mavvs 152,80,44
Mavvs 156,84,44
buffer_load_dwordx4 v10, s[8:11], s73 offen offset:2048 lds
Mavvs 160,80,48
RT 156,27,49152
Mavvs 164,84,48
RT 158,27,51200
Mavvs 168,80,52
Mavvs 172,84,52
Mavvs 176,80,56
buffer_load_dwordx4 v11, s[8:11], s73 offen offset:3072 lds
Mavvs 180,84,56
Mavvs 184,80,60
Mavvs 188,84,60
Mavvs 192,88,32
Mavvs 196,92,32
s_add_u32 s59, s59, 32768
Mavvs 200,88,36
Mavvs 204,92,36
s_cmp_ge_u32 s59, 163840
s_cselect_b32 s72, 98304, 0
Mavvs 208,88,40
Mavvs 212,92,40
Mavvs 216,88,44
Mavvs 220,92,44
s_sub_u32 s59, s59, s72
Mavvs 224,88,48
Mavvs 228,92,48
Mavvs 232,88,52
Mavvs 236,92,52
Mavvs 240,88,56
Mavvs 244,92,56
Mavvs 248,88,60
Mavvs 252,92,60
s_waitcnt vmcnt(17) lgkmcnt(0)
s_barrier
Mavvs 0,128,96
s_add_u32 s60, s60, 32768
s_cmp_ge_u32 s60, 98304
s_cselect_b32 s60, 0, s60
Mavvs 4,132,96
v_add_u32_e64 v18, s60, v16
Mavvs 8,128,100
s_add_u32 m0, s52, 49152
v_add_u32_e64 v19, s60, v17
Mavvs 12,132,100
RT 64,20,0
Mavvs 16,128,104
s_add_u32 s58, s58, 262144
Mavvs 20,132,104
RT 66,20,2048
Mavvs 24,128,108
R4 32,18,0
Mavvs 28,132,108
Mavvs 32,128,112
buffer_load_dwordx4 v12, s[12:15], s58 offen lds
Mavvs 36,132,112
R4 36,18,2048
Mavvs 40,128,116
R4 40,18,4096
Mavvs 44,132,116
R4 44,18,6144
Mavvs 48,128,120
Mavvs 52,132,120
R4 48,18,8192
Mavvs 56,128,124
Mavvs 60,132,124
R4 52,18,10240
Mavvs 64,136,96
R4 56,18,12288
Mavvs 68,140,96
Mavvs 72,136,100
R4 60,18,14336
Mavvs 76,140,100
RT 68,21,0
Mavvs 80,136,104
buffer_load_dwordx4 v13, s[12:15], s58 offen offset:1024 lds
Mavvs 84,140,104
RT 70,21,2048
Mavvs 88,136,108
Mavvs 92,140,108
RT 72,22,0
Mavvs 96,136,112
RT 74,22,2048
Mavvs 100,140,112
Mavvs 104,136,116
RT 76,23,0
Mavvs 108,140,116
Mavvs 112,136,120
RT 78,23,2048
Mavvs 116,140,120
RT 80,24,0
Mavvs 120,136,124
Mavvs 124,140,124
RT 82,24,2048
Mavvs 128,144,96
buffer_load_dwordx4 v14, s[12:15], s58 offen offset:2048 lds
Mavvs 132,148,96
RT 84,25,0
Mavvs 136,144,100
RT 86,25,2048
Mavvs 140,148,100
Mavvs 144,144,104
RT 88,26,0
Mavvs 148,148,104
Mavvs 152,144,108
RT 90,26,2048
Mavvs 156,148,108
RT 92,27,0
Mavvs 160,144,112
Mavvs 164,148,112
RT 94,27,2048
Mavvs 168,144,116
Mavvs 172,148,116
Mavvs 176,144,120
buffer_load_dwordx4 v15, s[12:15], s58 offen offset:3072 lds
Mavvs 180,148,120
Mavvs 184,144,124
Mavvs 188,148,124
Mavvs 192,152,96
Mavvs 196,156,96
Mavvs 200,152,100
Mavvs 204,156,100
Mavvs 208,152,104
Mavvs 212,156,104
Mavvs 216,152,108
Mavvs 220,156,108
Mavvs 224,152,112
Mavvs 228,156,112
Mavvs 232,152,116
Mavvs 236,156,116
Mavvs 240,152,120
Mavvs 244,156,120
Mavvs 248,152,124
Mavvs 252,156,124
s_waitcnt vmcnt(13) lgkmcnt(0)
s_barrier
Mavvs 0,64,32
RT 128,20,16384
RT 130,20,18432
Mavvs 4,68,32
R4 96,19,0
s_mul_i32 s78, s3, 14336
Mavvs 8,64,36
v_and_b32 v10, 15, v1
v_lshlrev_b32 v10, 6, v10
Mavvs 12,68,36
R4 100,19,2048
v_and_b32_e64 v11, 48, v1
Mavvs 16,64,40
v_add_u32 v10, v10, v11
v_add_u32 v11, s78, v10
Mavvs 20,68,40
R4 104,19,4096
s_lshr_b32 s76, s2, 4
Mavvs 24,64,44
s_mul_i32 s76, s76, 28
s_mul_i32 s77, s44, 7
s_add_u32 s76, s76, s77
Mavvs 28,68,44
R4 108,19,6144
v_lshrrev_b32_e64 v200, 2, v1
Mavvs 32,64,48
v_min_u32 v200, 6, v200
v_add_u32 v200, s76, v200
Mavvs 36,68,48
R4 112,19,8192
v_and_b32_e64 v201, 3, v1
Mavvs 40,64,52
v_lshlrev_b32_e64 v201, 7, v201
v_lshl_add_u32 v202, v200, 13, v201
Mavvs 44,68,52
R4 116,19,10240
s_lshl_b32 s76, s45, 9
Mavvs 48,64,56
buffer_load_dword v31, v202, s[16:19], s76 offen
Mavvs 52,68,56
R4 120,19,12288
v_mul_u32_u24 v202, 3584, v200
Mavvs 56,64,60
R4 124,19,14336
v_add_u32 v202, v202, v201
Mavvs 60,68,60
s_lshl_b32 s76, s98, 1
s_and_b32 s76, s76, 0xffffff80
Mavvs 64,72,32
RT 132,21,16384
Mavvs 68,76,32
buffer_load_dword v31, v202, s[20:23], s76 offen
Mavvs 72,72,36
RT 134,21,18432
s_lshr_b32 s76, s2, 3
Mavvs 76,76,36
s_mul_i32 s76, s76, 4608
s_add_u32 s76, s76, 0
v_min_u32 v200, 35, v1
Mavvs 80,72,40
RT 136,22,16384
v_lshlrev_b32_e64 v200, 7, v200
Mavvs 84,76,40
v_add_u32_e64 v200, s76, v200
v_min_u32 v200, M_CODE_END-M_CODE_START-4, v200
Mavvs 88,72,44
RT 138,22,18432
Mavvs 92,76,44
global_load_dword v31, v200, s[66:67]
Mavvs 96,72,48
RT 140,23,16384
Mavvs 100,76,48
Mavvs 104,72,52
RT 142,23,18432
Mavvs 108,76,52
Mavvs 112,72,56
RT 144,24,16384
Mavvs 116,76,56
RT 146,24,18432
Mavvs 120,72,60
Mavvs 124,76,60
RT 148,25,16384
Mavvs 128,80,32
s_add_u32 m0, s52, 0
s_mov_b32 s74, 0
Mavvs 132,84,32
RT 150,25,18432
Mavvs 136,80,36
buffer_load_dwordx4 v12, s[16:19], s74 offen lds
Mavvs 140,84,36
RT 152,26,16384
Mavvs 144,80,40
Mavvs 148,84,40
RT 154,26,18432
Mavvs 152,80,44
buffer_load_dwordx4 v13, s[16:19], s74 offen offset:1024 lds
Mavvs 156,84,44
RT 156,27,16384
Mavvs 160,80,48
Mavvs 164,84,48
RT 158,27,18432
Mavvs 168,80,52
buffer_load_dwordx4 v14, s[16:19], s74 offen offset:2048 lds
Mavvs 172,84,52
Mavvs 176,80,56
Mavvs 180,84,56
buffer_load_dwordx4 v15, s[16:19], s74 offen offset:3072 lds
Mavvs 184,80,60
Mavvs 188,84,60
Mavvs 192,88,32
Mavvs 196,92,32
s_add_u32 m0, s53, 98304
Mavvs 200,88,36
Mavvs 204,92,36
s_mov_b32 s74, 0
Mavvs 208,88,40
buffer_load_dwordx4 v28, s[20:23], s74 offen lds
Mavvs 212,92,40
Mavvs 216,88,44
Mavvs 220,92,44
Mavvs 224,88,48
buffer_load_dwordx4 v29, s[20:23], s74 offen offset:1024 lds
Mavvs 228,92,48
Mavvs 232,88,52
Mavvs 236,92,52
Mavvs 240,88,56
Mavvs 244,92,56
Mavvs 248,88,60
Mavvs 252,92,60
s_waitcnt vmcnt(19)
s_cmp_lg_u32 s44, 0
s_cbranch_scc1 WOK_12
s_mov_b32 s73, 0
WSP_13:
v_cmp_eq_u32 vcc, v7, v6
s_and_b32 s72, vcc_lo, 0xffff
s_cmp_eq_u32 s72, 0xffff
s_cbranch_scc1 WOK_12
s_sleep 8
buffer_load_dword v7, v30, s[4:7], s70 offen sc1
s_waitcnt vmcnt(0)
s_add_u32 s73, s73, 1
s_cmp_lt_u32 s73, 20000
s_cbranch_scc1 WSP_13
WOK_12:
s_waitcnt vmcnt(13) lgkmcnt(0)
s_barrier
Mavvs 0,128,96
s_add_u32 s60, s60, 32768
s_cmp_ge_u32 s60, 98304
s_cselect_b32 s60, 0, s60
Mavvs 4,132,96
s_add_u32 s75, s71, 0
v_add_u32 v18, s60, v16
Mavvs 8,128,100
v_add_u32_e64 v19, s60, v17
Mavvs 12,132,100
RT 64,20,32768
Mavvs 16,128,104
buffer_load_dwordx4 v[160:163], v10, s[4:7], s75 offen offset:0 sc1
Mavvs 20,132,104
RT 66,20,34816
Mavvs 24,128,108
R4 32,18,0
Mavvs 28,132,108
buffer_load_dwordx4 v[164:167], v11, s[4:7], s75 offen offset:0 sc1
Mavvs 32,128,112
R4 36,18,2048
Mavvs 36,132,112
buffer_load_dwordx4 v[168:171], v10, s[4:7], s75 offen offset:1024 sc1
Mavvs 40,128,116
R4 40,18,4096
Mavvs 44,132,116
R4 44,18,6144
Mavvs 48,128,120
buffer_load_dwordx4 v[172:175], v11, s[4:7], s75 offen offset:1024 sc1
Mavvs 52,132,120
R4 48,18,8192
s_lshl_b32 s76, s98, 1
Mavvs 56,128,124
v_lshrrev_b32 v200, 4, v1
v_lshlrev_b32_e64 v200, 3, v200
Mavvs 60,132,124
R4 52,18,10240
Mavvs 64,136,96
R4 56,18,12288
Mavvs 68,140,96
buffer_load_dwordx2 v[224:225], v200, s[32:35], s76 offen offset:0
Mavvs 72,136,100
R4 60,18,14336
buffer_load_dwordx2 v[226:227], v200, s[32:35], s76 offen offset:32
Mavvs 76,140,100
RT 68,21,32768
Mavvs 80,136,104
buffer_load_dwordx2 v[228:229], v200, s[32:35], s76 offen offset:64
Mavvs 84,140,104
RT 70,21,34816
Mavvs 88,136,108
buffer_load_dwordx2 v[230:231], v200, s[32:35], s76 offen offset:96
Mavvs 92,140,108
RT 72,22,32768
Mavvs 96,136,112
RT 74,22,34816
Mavvs 100,140,112
buffer_load_dwordx2 v[232:233], v200, s[32:35], s76 offen offset:128
Mavvs 104,136,116
RT 76,23,32768
Mavvs 108,140,116
buffer_load_dwordx2 v[234:235], v200, s[32:35], s76 offen offset:160
Mavvs 112,136,120
RT 78,23,34816
Mavvs 116,140,120
RT 80,24,32768
Mavvs 120,136,124
buffer_load_dwordx2 v[236:237], v200, s[32:35], s76 offen offset:192
Mavvs 124,140,124
RT 82,24,34816
Mavvs 128,144,96
buffer_load_dwordx2 v[238:239], v200, s[32:35], s76 offen offset:224
Mavvs 132,148,96
RT 84,25,32768
s_add_u32 s75, s71, 2048
Mavvs 136,144,100
RT 86,25,34816
Mavvs 140,148,100
buffer_load_dwordx4 v[176:179], v10, s[4:7], s75 offen offset:0 sc1
Mavvs 144,144,104
RT 88,26,32768
Mavvs 148,148,104
buffer_load_dwordx4 v[180:183], v11, s[4:7], s75 offen offset:0 sc1
Mavvs 152,144,108
RT 90,26,34816
Mavvs 156,148,108
RT 92,27,32768
Mavvs 160,144,112
buffer_load_dwordx4 v[184:187], v10, s[4:7], s75 offen offset:1024 sc1
Mavvs 164,148,112
RT 94,27,34816
Mavvs 168,144,116
buffer_load_dwordx4 v[188:191], v11, s[4:7], s75 offen offset:1024 sc1
Mavvs 172,148,116
s_add_u32 m0, s52, 16384
s_mov_b32 s74, 262144
Mavvs 176,144,120
buffer_load_dwordx4 v12, s[16:19], s74 offen lds
Mavvs 180,148,120
buffer_load_dwordx4 v13, s[16:19], s74 offen offset:1024 lds
Mavvs 184,144,124
Mavvs 188,148,124
buffer_load_dwordx4 v14, s[16:19], s74 offen offset:2048 lds
Mavvs 192,152,96
Mavvs 196,156,96
Mavvs 200,152,100
buffer_load_dwordx4 v15, s[16:19], s74 offen offset:3072 lds
Mavvs 204,156,100
Mavvs 208,152,104
s_add_u32 m0, s53, 106496
Mavvs 212,156,104
s_mov_b32 s74, 114688
Mavvs 216,152,108
buffer_load_dwordx4 v28, s[20:23], s74 offen lds
Mavvs 220,156,108
Mavvs 224,152,112
buffer_load_dwordx4 v29, s[20:23], s74 offen offset:1024 lds
Mavvs 228,156,112
Mavvs 232,152,116
Mavvs 236,156,116
Mavvs 240,152,120
Mavvs 244,156,120
Mavvs 248,152,124
Mavvs 252,156,124
s_waitcnt vmcnt(31) lgkmcnt(0)
s_barrier
Mavvs 0,64,32
RT 128,20,49152
RT 130,20,51200
Mavvs 4,68,32
R4 96,19,0
s_add_u32 m0, s52, 32768
Mavvs 8,64,36
s_mov_b32 s74, 524288
Mavvs 12,68,36
R4 100,19,2048
Mavvs 16,64,40
buffer_load_dwordx4 v12, s[16:19], s74 offen lds
Mavvs 20,68,40
R4 104,19,4096
Mavvs 24,64,44
Mavvs 28,68,44
R4 108,19,6144
Mavvs 32,64,48
Mavvs 36,68,48
R4 112,19,8192
Mavvs 40,64,52
Mavvs 44,68,52
R4 116,19,10240
Mavvs 48,64,56
buffer_load_dwordx4 v13, s[16:19], s74 offen offset:1024 lds
Mavvs 52,68,56
R4 120,19,12288
Mavvs 56,64,60
R4 124,19,14336
Mavvs 60,68,60
Mavvs 64,72,32
RT 132,21,49152
Mavvs 68,76,32
Mavvs 72,72,36
RT 134,21,51200
Mavvs 76,76,36
Mavvs 80,72,40
RT 136,22,49152
Mavvs 84,76,40
buffer_load_dwordx4 v14, s[16:19], s74 offen offset:2048 lds
Mavvs 88,72,44
RT 138,22,51200
Mavvs 92,76,44
Mavvs 96,72,48
RT 140,23,49152
Mavvs 100,76,48
Mavvs 104,72,52
RT 142,23,51200
Mavvs 108,76,52
Mavvs 112,72,56
RT 144,24,49152
Mavvs 116,76,56
RT 146,24,51200
Mavvs 120,72,60
buffer_load_dwordx4 v15, s[16:19], s74 offen offset:3072 lds
Mavvs 124,76,60
RT 148,25,49152
Mavvs 128,80,32
Mavvs 132,84,32
RT 150,25,51200
Mavvs 136,80,36
Mavvs 140,84,36
RT 152,26,49152
Mavvs 144,80,40
s_add_u32 m0, s53, 114688
Mavvs 148,84,40
RT 154,26,51200
Mavvs 152,80,44
Mavvs 156,84,44
RT 156,27,49152
s_mov_b32 s74, 229376
Mavvs 160,80,48
Mavvs 164,84,48
RT 158,27,51200
Mavvs 168,80,52
buffer_load_dwordx4 v28, s[20:23], s74 offen lds
Mavvs 172,84,52
Mavvs 176,80,56
Mavvs 180,84,56
Mavvs 184,80,60
Mavvs 188,84,60
Mavvs 192,88,32
Mavvs 196,92,32
Mavvs 200,88,36
buffer_load_dwordx4 v29, s[20:23], s74 offen offset:1024 lds
Mavvs 204,92,36
Mavvs 208,88,40
Mavvs 212,92,40
Mavvs 216,88,44
Mavvs 220,92,44
Mavvs 224,88,48
Mavvs 228,92,48
Mavvs 232,88,52
Mavvs 236,92,52
Mavvs 240,88,56
Mavvs 244,92,56
Mavvs 248,88,60
Mavvs 252,92,60
LW 0
Mavvs 0,128,96
Mavvs 4,132,96
Mavvs 8,128,100
Mavvs 12,132,100
Mavvs 16,128,104
Mavvs 20,132,104
Mavvs 24,128,108
Mavvs 28,132,108
Mavvs 32,128,112
Mavvs 36,132,112
Mavvs 40,128,116
AR 208,0
AR 209,1
Mavvs 44,132,116
AR 210,2
AR 211,3
Mavvs 48,128,120
AR 212,4
AR 213,5
Mavvs 52,132,120
AR 214,6
AR 215,7
Mavvs 56,128,124
v_mul_f32 v208, s100, v208
v_mul_f32_e64 v209, s100, v209
Mavvs 60,132,124
v_mul_f32 v210, s100, v210
v_mul_f32 v211, s100, v211
Mavvs 64,136,96
v_mul_f32 v212, s100, v212
v_mul_f32 v213, s100, v213
Mavvs 68,140,96
v_mul_f32 v214, s100, v214
v_mul_f32 v215, s100, v215
Mavvs 72,136,100
CV 32,208,209
CV 33,210,211
Mavvs 76,140,100
CV 34,212,213
CV 35,214,215
buffer_store_dwordx4 v[32:35], v4, s[4:7], s62 offen sc1
Mavvs 80,136,104
s_add_u32 s62, s62, s86
AR 216,8
AR 217,9
Mavvs 84,140,104
AR 218,10
AR 219,11
AR 220,12
Mavvs 88,136,108
AR 221,13
AR 222,14
AR 223,15
Mavvs 92,140,108
v_mul_f32 v216, s100, v216
v_mul_f32 v217, s100, v217
v_mul_f32 v218, s100, v218
v_mul_f32_e64 v219, s100, v219
Mavvs 96,136,112
v_mul_f32 v220, s100, v220
v_mul_f32 v221, s100, v221
v_mul_f32_e64 v222, s100, v222
Mavvs 100,140,112
v_mul_f32_e64 v223, s100, v223
CV 36,216,217
CV 37,218,219
CV 38,220,221
Mavvs 104,136,116
CV 39,222,223
buffer_store_dwordx4 v[36:39], v4, s[4:7], s62 offen sc1
Mavvs 108,140,116
s_add_u32 s62, s62, s87
AR 208,16
AR 209,17
Mavvs 112,136,120
AR 210,18
AR 211,19
AR 212,20
AR 213,21
Mavvs 116,140,120
AR 214,22
AR 215,23
v_mul_f32 v208, s100, v208
Mavvs 120,136,124
v_mul_f32 v209, s100, v209
v_mul_f32 v210, s100, v210
v_mul_f32 v211, s100, v211
v_mul_f32 v212, s100, v212
Mavvs 124,140,124
v_mul_f32 v213, s100, v213
v_mul_f32 v214, s100, v214
v_mul_f32_e64 v215, s100, v215
Mavvs 128,144,96
CV 40,208,209
CV 41,210,211
CV 42,212,213
CV 43,214,215
Mavvs 132,148,96
buffer_store_dwordx4 v[40:43], v4, s[4:7], s62 offen sc1
Mavvs 136,144,100
s_add_u32 s62, s62, s86
AR 216,24
AR 217,25
AR 218,26
Mavvs 140,148,100
AR 219,27
AR 220,28
AR 221,29
Mavvs 144,144,104
AR 222,30
AR 223,31
v_mul_f32 v216, s100, v216
v_mul_f32_e64 v217, s100, v217
Mavvs 148,148,104
v_mul_f32 v218, s100, v218
v_mul_f32 v219, s100, v219
v_mul_f32_e64 v220, s100, v220
Mavvs 152,144,108
v_mul_f32 v221, s100, v221
v_mul_f32 v222, s100, v222
v_mul_f32_e64 v223, s100, v223
CV 44,216,217
Mavvs 156,148,108
CV 45,218,219
CV 46,220,221
CV 47,222,223
Mavvs 160,144,112
buffer_store_dwordx4 v[44:47], v4, s[4:7], s62 offen sc1
s_add_u32 s62, s62, s88
Mavvs 164,148,112
AR 208,32
AR 209,33
AR 210,34
AR 211,35
Mavvs 168,144,116
AR 212,36
AR 213,37
AR 214,38
Mavvs 172,148,116
AR 215,39
v_mul_f32 v208, s100, v208
v_mul_f32 v209, s100, v209
v_mul_f32 v210, s100, v210
Mavvs 176,144,120
v_mul_f32 v211, s100, v211
v_mul_f32 v212, s100, v212
v_mul_f32_e64 v213, s100, v213
Mavvs 180,148,120
v_mul_f32 v214, s100, v214
v_mul_f32 v215, s100, v215
CV 48,208,209
CV 49,210,211
Mavvs 184,144,124
CV 50,212,213
CV 51,214,215
buffer_store_dwordx4 v[48:51], v4, s[4:7], s62 offen sc1
Mavvs 188,148,124
s_add_u32 s62, s62, s86
AR 216,40
AR 217,41
Mavvs 192,152,96
AR 218,42
AR 219,43
Mavvs 196,156,96
AR 220,44
AR 221,45
AR 222,46
AR 223,47
Mavvs 200,152,100
v_mul_f32 v216, s100, v216
v_mul_f32 v217, s100, v217
v_mul_f32 v218, s100, v218
Mavvs 204,156,100
v_mul_f32 v219, s100, v219
v_mul_f32 v220, s100, v220
v_mul_f32 v221, s100, v221
v_mul_f32 v222, s100, v222
Mavvs 208,152,104
v_mul_f32_e64 v223, s100, v223
CV 52,216,217
CV 53,218,219
Mavvs 212,156,104
CV 54,220,221
CV 55,222,223
buffer_store_dwordx4 v[52:55], v4, s[4:7], s62 offen sc1
Mavvs 216,152,108
s_add_u32 s62, s62, s87
AR 208,48
AR 209,49
Mavvs 220,156,108
AR 210,50
AR 211,51
AR 212,52
Mavvs 224,152,112
AR 213,53
AR 214,54
AR 215,55
v_mul_f32 v208, s100, v208
Mavvs 228,156,112
v_mul_f32 v209, s100, v209
v_mul_f32 v210, s100, v210
v_mul_f32_e64 v211, s100, v211
Mavvs 232,152,116
v_mul_f32 v212, s100, v212
v_mul_f32 v213, s100, v213
v_mul_f32 v214, s100, v214
v_mul_f32 v215, s100, v215
Mavvs 236,156,116
CV 56,208,209
CV 57,210,211
CV 58,212,213
Mavvs 240,152,120
CV 59,214,215
buffer_store_dwordx4 v[56:59], v4, s[4:7], s62 offen sc1
Mavvs 244,156,120
s_add_u32 s62, s62, s86
AR 216,56
AR 217,57
Mavvs 248,152,124
AR 218,58
AR 219,59
AR 220,60
AR 221,61
Mavvs 252,156,124
AR 222,62
AR 223,63
v_mul_f32 v216, s100, v216
v_mul_f32 v217, s100, v217
v_mul_f32 v218, s100, v218
v_mul_f32 v219, s100, v219
v_mul_f32 v220, s100, v220
v_mul_f32 v221, s100, v221
v_mul_f32 v222, s100, v222
v_mul_f32_e64 v223, s100, v223
CV 60,216,217
CV 61,218,219
CV 62,220,221
CV 63,222,223
buffer_store_dwordx4 v[60:63], v4, s[4:7], s62 offen sc1
s_branch AJ_6
AV_5:
s_waitcnt vmcnt(14) lgkmcnt(0)
s_barrier
Mavvz 0,32,64
RT 128,20,16384
RT 130,20,18432
Mavvz 4,36,64
R4 96,19,0
s_and_b32 s81, s44, 1
Mavvz 8,40,64
s_lshl_b32 s81, s81, 2
s_mul_i32 s80, s44, 28672
s_lshl_b32 s82, s98, 1
Mavvz 12,44,64
R4 100,19,2048
s_add_u32 s80, s80, s82
Mavvz 16,48,64
v_lshrrev_b32 v200, 4, v1
v_and_b32_e64 v201, 15, v1
Mavvz 20,52,64
R4 104,19,4096
v_lshrrev_b32_e64 v202, 1, v201
Mavvz 24,56,64
v_xor_b32 v202, s81, v202
v_xor_b32 v202, v200, v202
Mavvz 28,60,64
R4 108,19,6144
v_and_b32_e64 v203, 1, v201
Mavvz 32,32,68
v_lshl_add_u32 v2, v202, 1, v203
v_lshlrev_b32_e64 v2, 4, v2
Mavvz 36,36,68
R4 112,19,8192
v_mul_u32_u24 v3, 3584, v200
Mavvz 40,40,68
v_add_u32 v2, v2, v3
v_add_u32 v28, s80, v2
Mavvz 44,44,68
R4 116,19,10240
v_add_u32 v29, 13312, v28
Mavvz 48,48,68
s_lshl_b32 s80, s44, 1
s_sub_u32 s3, 7, s80
v_bfe_u32 v201, v1, 2, 2
Mavvz 52,52,68
R4 120,19,12288
v_lshl_add_u32 v202, v200, 3, v201
Mavvz 56,56,68
R4 124,19,14336
v_and_b32_e64 v203, 3, v1
Mavvz 60,60,68
v_lshlrev_b32_e64 v203, 3, v203
Mavvz 64,32,72
RT 132,21,16384
v_and_b32_e64 v2, 1, v200
Mavvz 68,36,72
v_lshl_or_b32 v201, v2, 2, v201
v_lshl_add_u32 v204, v202, 9, v203
Mavvz 72,40,72
RT 134,21,18432
v_lshl_add_u32 v205, v202, 8, v203
Mavvz 76,44,72
v_add_u32 v205, 98304, v205
Mavvz 80,48,72
RT 136,22,16384
v_xor_b32_e64 v2, 0, v201
Mavvz 84,52,72
v_lshl_add_u32 v240, v2, 5, v204
v_lshl_add_u32 v248, v2, 5, v205
Mavvz 88,56,72
RT 138,22,18432
v_xor_b32_e64 v2, 1, v201
Mavvz 92,60,72
v_lshl_add_u32 v241, v2, 5, v204
Mavvz 96,32,76
RT 140,23,16384
s_add_u32 m0, s52, 49152
Mavvz 100,36,76
s_add_u32 s58, s58, 262144
v_lshl_add_u32 v249, v2, 5, v205
v_xor_b32_e64 v2, 2, v201
Mavvz 104,40,76
RT 142,23,18432
v_lshl_add_u32 v242, v2, 5, v204
Mavvz 108,44,76
buffer_load_dwordx4 v12, s[12:15], s58 offen lds
Mavvz 112,48,76
RT 144,24,16384
v_lshl_add_u32 v250, v2, 5, v205
Mavvz 116,52,76
RT 146,24,18432
v_xor_b32_e64 v2, 3, v201
Mavvz 120,56,76
buffer_load_dwordx4 v13, s[12:15], s58 offen offset:1024 lds
Mavvz 124,60,76
RT 148,25,16384
v_lshl_add_u32 v243, v2, 5, v204
Mavvz 128,32,80
v_lshl_add_u32 v251, v2, 5, v205
v_xor_b32_e64 v2, 4, v201
Mavvz 132,36,80
RT 150,25,18432
v_lshl_add_u32 v244, v2, 5, v204
Mavvz 136,40,80
buffer_load_dwordx4 v14, s[12:15], s58 offen offset:2048 lds
Mavvz 140,44,80
RT 152,26,16384
v_lshl_add_u32 v252, v2, 5, v205
Mavvz 144,48,80
v_xor_b32_e64 v2, 5, v201
v_lshl_add_u32 v245, v2, 5, v204
Mavvz 148,52,80
RT 154,26,18432
v_lshl_add_u32 v253, v2, 5, v205
Mavvz 152,56,80
buffer_load_dwordx4 v15, s[12:15], s58 offen offset:3072 lds
Mavvz 156,60,80
RT 156,27,16384
v_xor_b32_e64 v2, 6, v201
Mavvz 160,32,84
v_lshl_add_u32 v246, v2, 5, v204
v_lshl_add_u32 v254, v2, 5, v205
v_xor_b32_e64 v2, 7, v201
v_lshl_add_u32 v247, v2, 5, v204
v_lshl_add_u32 v255, v2, 5, v205
Mavvz 164,36,84
RT 158,27,18432
s_mov_b32 m0, s59
Mavvz 168,40,84
s_add_u32 s57, s57, 128
Mavvz 172,44,84
Mavvz 176,48,84
buffer_load_dwordx4 v8, s[8:11], s57 offen lds
Mavvz 180,52,84
Mavvz 184,56,84
Mavvz 188,60,84
Mavvz 192,32,88
buffer_load_dwordx4 v9, s[8:11], s57 offen offset:1024 lds
Mavvz 196,36,88
Mavvz 200,40,88
Mavvz 204,44,88
Mavvz 208,48,88
buffer_load_dwordx4 v10, s[8:11], s57 offen offset:2048 lds
Mavvz 212,52,88
Mavvz 216,56,88
Mavvz 220,60,88
Mavvz 224,32,92
buffer_load_dwordx4 v11, s[8:11], s57 offen offset:3072 lds
Mavvz 228,36,92
Mavvz 232,40,92
Mavvz 236,44,92
Mavvz 240,48,92
Mavvz 244,52,92
Mavvz 248,56,92
Mavvz 252,60,92
s_waitcnt vmcnt(10) lgkmcnt(0)
s_barrier
Mavvs 0,96,128
s_add_u32 s60, s60, 32768
s_cmp_ge_u32 s60, 98304
s_cselect_b32 s60, 0, s60
Mavvs 4,100,128
v_add_u32_e64 v18, s60, v16
Mavvs 8,104,128
s_add_u32 m0, s52, 0
s_add_u32 s58, s58, 262144
v_add_u32 v19, s60, v17
Mavvs 12,108,128
RT 64,20,32768
Mavvs 16,112,128
buffer_load_dwordx4 v12, s[12:15], s58 offen lds
Mavvs 20,116,128
RT 66,20,34816
s_waitcnt vmcnt(9)
Mavvs 24,120,128
R4 32,18,0
s_mov_b32 s84, 0xf0f0f0f0
Mavvs 28,124,128
buffer_load_dwordx4 v13, s[12:15], s58 offen offset:1024 lds
Mavvs 32,96,132
R4 36,18,2048
s_mov_b32 s85, 0xf0f0f0f0
Mavvs 36,100,132
v_lshlrev_b32 v168, 16, v160
v_and_b32 v169, 0xffff0000, v160
Mavvs 40,104,132
R4 40,18,4096
v_lshlrev_b32_e64 v170, 16, v161
Mavvs 44,108,132
R4 44,18,6144
v_and_b32 v171, 0xffff0000, v161
Mavvs 48,112,132
buffer_load_dwordx4 v14, s[12:15], s58 offen offset:2048 lds
Mavvs 52,116,132
R4 48,18,8192
v_lshlrev_b32_e64 v172, 16, v162
v_and_b32 v173, 0xffff0000, v162
Mavvs 56,120,132
buffer_load_dwordx4 v15, s[12:15], s58 offen offset:3072 lds
Mavvs 60,124,132
R4 52,18,10240
v_lshlrev_b32_e64 v174, 16, v163
Mavvs 64,96,136
R4 56,18,12288
v_and_b32 v175, 0xffff0000, v163
v_lshlrev_b32_e64 v176, 16, v164
Mavvs 68,100,136
s_add_u32 m0, s59, 16384
v_and_b32 v177, 0xffff0000, v164
v_lshlrev_b32_e64 v178, 16, v165
Mavvs 72,104,136
R4 60,18,14336
v_and_b32 v179, 0xffff0000, v165
v_lshlrev_b32_e64 v180, 16, v166
Mavvs 76,108,136
RT 68,21,32768
s_add_u32 s73, s57, 262144
v_and_b32 v181, 0xffff0000, v166
Mavvs 80,112,136
buffer_load_dwordx4 v8, s[8:11], s73 offen lds
Mavvs 84,116,136
RT 70,21,34816
v_lshlrev_b32_e64 v182, 16, v167
Mavvs 88,120,136
v_and_b32 v183, 0xffff0000, v167
v_add_f32_e64 v184, v168, v169
Mavvs 92,124,136
RT 72,22,32768
v_add_f32_e64 v184, v184, v170
Mavvs 96,96,140
RT 74,22,34816
v_add_f32 v184, v184, v171
v_add_f32 v184, v184, v172
Mavvs 100,100,140
buffer_load_dwordx4 v9, s[8:11], s73 offen offset:1024 lds
Mavvs 104,104,140
RT 76,23,32768
v_add_f32_e64 v184, v184, v173
Mavvs 108,108,140
v_add_f32 v184, v184, v174
v_add_f32 v184, v184, v175
Mavvs 112,112,140
RT 78,23,34816
v_add_f32_e64 v184, v184, v176
Mavvs 116,116,140
RT 80,24,32768
v_add_f32 v184, v184, v177
v_add_f32 v184, v184, v178
Mavvs 120,120,140
buffer_load_dwordx4 v10, s[8:11], s73 offen offset:2048 lds
Mavvs 124,124,140
RT 82,24,34816
v_add_f32 v184, v184, v179
v_add_f32 v184, v184, v180
v_add_f32_e64 v184, v184, v181
Mavvs 128,96,144
buffer_load_dwordx4 v11, s[8:11], s73 offen offset:3072 lds
Mavvs 132,100,144
RT 84,25,32768
v_add_f32_e64 v184, v184, v182
Mavvs 136,104,144
RT 86,25,34816
v_add_f32_e64 v184, v184, v183
Mavvs 140,108,144
s_add_u32 s59, s59, 32768
s_nop 1
v_add_f32 v184, v184, v184 quad_perm:[1,0,3,2] row_mask:0xf bank_mask:0xf
Mavvs 144,112,144
RT 88,26,32768
s_nop 1
Mavvs 148,116,144
s_cmp_ge_u32 s59, 163840
s_cselect_b32 s72, 98304, 0
v_add_f32 v184, v184, v184 quad_perm:[2,3,0,1] row_mask:0xf bank_mask:0xf
Mavvs 152,120,144
RT 90,26,34816
s_nop 1
v_add_f32 v184, v184, v184 row_ror:8 row_mask:0xf bank_mask:0xf
Mavvs 156,124,144
RT 92,27,32768
s_sub_u32 s59, s59, s72
Mavvs 160,96,148
s_nop 1
v_readlane_b32 s86, v184, 0
v_readlane_b32 s87, v184, 16
Mavvs 164,100,148
RT 94,27,34816
s_add_u32 m0, s52, 16384
Mavvs 168,104,148
s_add_u32 s58, s58, 262144
v_readlane_b32 s88, v184, 32
v_readlane_b32 s89, v184, 48
Mavvs 172,108,148
buffer_load_dwordx4 v12, s[12:15], s58 offen lds
Mavvs 176,112,148
v_readlane_b32 s90, v184, 4
v_readlane_b32 s91, v184, 20
Mavvs 180,116,148
v_readlane_b32 s92, v184, 36
v_readlane_b32 s93, v184, 52
Mavvs 184,120,148
s_nop 1
v_mov_b32 v184, s86
v_mov_b32 v187, s90
Mavvs 188,124,148
buffer_load_dwordx4 v13, s[12:15], s58 offen offset:1024 lds
Mavvs 192,96,152
v_add_f32 v184, s87, v184
v_add_f32 v187, s91, v187
Mavvs 196,100,152
v_add_f32 v184, s88, v184
v_add_f32 v187, s92, v187
Mavvs 200,104,152
v_add_f32 v184, s89, v184
v_add_f32 v187, s93, v187
Mavvs 204,108,152
buffer_load_dwordx4 v14, s[12:15], s58 offen offset:2048 lds
Mavvs 208,112,152
v_cndmask_b32 v184, v184, v187, s[84:85]
v_mul_f32 v184, 0x3b124925, v184
Mavvs 212,116,152
v_mov_b32 v185, 0
v_sub_f32 v186, v168, v184
Mavvs 216,120,152
v_fmac_f32 v185, v186, v186
v_sub_f32 v186, v169, v184
Mavvs 220,124,152
buffer_load_dwordx4 v15, s[12:15], s58 offen offset:3072 lds
Mavvs 224,96,156
v_fmac_f32 v185, v186, v186
v_sub_f32 v186, v170, v184
Mavvs 228,100,156
v_fmac_f32 v185, v186, v186
v_sub_f32 v186, v171, v184
Mavvs 232,104,156
v_fmac_f32 v185, v186, v186
v_sub_f32 v186, v172, v184
Mavvs 236,108,156
v_fmac_f32 v185, v186, v186
v_sub_f32 v186, v173, v184
Mavvs 240,112,156
v_fmac_f32 v185, v186, v186
v_sub_f32 v186, v174, v184
Mavvs 244,116,156
v_fmac_f32_e64 v185, v186, v186
Mavvs 248,120,156
Mavvs 252,124,156
s_waitcnt vmcnt(12) lgkmcnt(0)
s_barrier
Mavvs 0,32,64
RT 128,20,49152
RT 130,20,51200
Mavvs 4,36,64
R4 96,19,0
v_sub_f32_e64 v186, v175, v184
Mavvs 8,40,64
s_mov_b32 m0, s59
s_add_u32 s57, s57, 128
v_fmac_f32 v185, v186, v186
Mavvs 12,44,64
R4 100,19,2048
v_sub_f32_e64 v186, v176, v184
Mavvs 16,48,64
buffer_load_dwordx4 v8, s[8:11], s57 offen lds
Mavvs 20,52,64
R4 104,19,4096
v_fmac_f32_e64 v185, v186, v186
Mavvs 24,56,64
buffer_load_dwordx4 v9, s[8:11], s57 offen offset:1024 lds
Mavvs 28,60,64
R4 108,19,6144
v_sub_f32_e64 v186, v177, v184
Mavvs 32,32,68
v_fmac_f32 v185, v186, v186
v_sub_f32 v186, v178, v184
Mavvs 36,36,68
R4 112,19,8192
v_fmac_f32 v185, v186, v186
v_sub_f32 v186, v179, v184
Mavvs 40,40,68
buffer_load_dwordx4 v10, s[8:11], s57 offen offset:2048 lds
Mavvs 44,44,68
R4 116,19,10240
v_fmac_f32_e64 v185, v186, v186
Mavvs 48,48,68
v_sub_f32 v186, v180, v184
v_fmac_f32 v185, v186, v186
Mavvs 52,52,68
R4 120,19,12288
v_sub_f32_e64 v186, v181, v184
Mavvs 56,56,68
R4 124,19,14336
v_fmac_f32 v185, v186, v186
v_sub_f32 v186, v182, v184
Mavvs 60,60,68
buffer_load_dwordx4 v11, s[8:11], s57 offen offset:3072 lds
Mavvs 64,32,72
RT 132,21,49152
v_fmac_f32_e64 v185, v186, v186
Mavvs 68,36,72
s_add_u32 m0, s52, 32768
v_sub_f32 v186, v183, v184
v_fmac_f32 v185, v186, v186
Mavvs 72,40,72
RT 134,21,51200
v_cndmask_b32 v185, 0, v185, vcc
Mavvs 76,44,72
s_add_u32 s58, s58, 262144
s_nop 1
v_add_f32 v185, v185, v185 quad_perm:[1,0,3,2] row_mask:0xf bank_mask:0xf
Mavvs 80,48,72
RT 136,22,49152
s_nop 1
Mavvs 84,52,72
buffer_load_dwordx4 v12, s[12:15], s58 offen lds
Mavvs 88,56,72
RT 138,22,51200
v_add_f32 v185, v185, v185 quad_perm:[2,3,0,1] row_mask:0xf bank_mask:0xf
Mavvs 92,60,72
s_nop 1
v_add_f32 v185, v185, v185 row_ror:8 row_mask:0xf bank_mask:0xf
s_nop 1
Mavvs 96,32,76
RT 140,23,49152
v_readlane_b32 s86, v185, 0
Mavvs 100,36,76
buffer_load_dwordx4 v13, s[12:15], s58 offen offset:1024 lds
Mavvs 104,40,76
RT 142,23,51200
v_readlane_b32 s87, v185, 16
Mavvs 108,44,76
v_readlane_b32 s88, v185, 32
v_readlane_b32 s89, v185, 48
Mavvs 112,48,76
RT 144,24,49152
v_readlane_b32 s90, v185, 4
Mavvs 116,52,76
RT 146,24,51200
v_readlane_b32 s91, v185, 20
v_readlane_b32 s92, v185, 36
Mavvs 120,56,76
buffer_load_dwordx4 v14, s[12:15], s58 offen offset:2048 lds
Mavvs 124,60,76
RT 148,25,49152
v_readlane_b32 s93, v185, 52
s_nop 1
Mavvs 128,32,80
buffer_load_dwordx4 v15, s[12:15], s58 offen offset:3072 lds
Mavvs 132,36,80
RT 150,25,51200
v_mov_b32_e64 v185, s86
Mavvs 136,40,80
v_mov_b32 v187, s90
v_add_f32 v185, s87, v185
Mavvs 140,44,80
RT 152,26,49152
s_add_u32 m0, s59, 16384
Mavvs 144,48,80
v_add_f32 v187, s91, v187
v_add_f32 v185, s88, v185
Mavvs 148,52,80
RT 154,26,51200
s_add_u32 s73, s57, 262144
v_add_f32 v187, s92, v187
v_add_f32 v185, s89, v185
Mavvs 152,56,80
buffer_load_dwordx4 v8, s[8:11], s73 offen lds
Mavvs 156,60,80
RT 156,27,49152
v_add_f32_e64 v187, s93, v187
Mavvs 160,32,84
v_cndmask_b32 v185, v185, v187, s[84:85]
v_mul_f32 v185, 0x3b124925, v185
Mavvs 164,36,84
RT 158,27,51200
CV 184,184,184
v_and_b32 v184, 0xffff0000, v184
Mavvs 168,40,84
buffer_load_dwordx4 v9, s[8:11], s73 offen offset:1024 lds
Mavvs 172,44,84
CV 185,185,185
v_and_b32 v185, 0xffff0000, v185
Mavvs 176,48,84
v_add_f32 v185, 0x3727c5ac, v185
CV 185,185,185
Mavvs 180,52,84
v_and_b32 v185, 0xffff0000, v185
v_sqrt_f32_e64 v185, v185
Mavvs 184,56,84
buffer_load_dwordx4 v10, s[8:11], s73 offen offset:2048 lds
Mavvs 188,60,84
s_nop 0
CV 185,185,185
v_and_b32 v185, 0xffff0000, v185
Mavvs 192,32,88
v_rcp_f32 v186, v185
Mavvs 196,36,88
s_nop 0
v_fma_f32 v187, -v185, v186, 1.0
v_fmac_f32 v186, v187, v186
Mavvs 200,40,88
buffer_load_dwordx4 v11, s[8:11], s73 offen offset:3072 lds
Mavvs 204,44,88
v_sub_f32 v168, v168, v184
v_sub_f32 v169, v169, v184
Mavvs 208,48,88
v_sub_f32 v170, v170, v184
v_sub_f32 v171, v171, v184
Mavvs 212,52,88
s_add_u32 s59, s59, 32768
v_sub_f32 v172, v172, v184
v_sub_f32 v173, v173, v184
Mavvs 216,56,88
v_sub_f32_e64 v174, v174, v184
Mavvs 220,60,88
s_cmp_ge_u32 s59, 163840
s_cselect_b32 s72, 98304, 0
v_sub_f32_e64 v175, v175, v184
Mavvs 224,32,92
v_sub_f32 v176, v176, v184
v_sub_f32 v177, v177, v184
Mavvs 228,36,92
s_sub_u32 s59, s59, s72
v_sub_f32 v178, v178, v184
Mavvs 232,40,92
v_sub_f32_e64 v179, v179, v184
Mavvs 236,44,92
v_sub_f32_e64 v180, v180, v184
Mavvs 240,48,92
v_sub_f32_e64 v181, v181, v184
Mavvs 244,52,92
v_sub_f32_e64 v182, v182, v184
Mavvs 248,56,92
Mavvs 252,60,92
s_waitcnt vmcnt(16) lgkmcnt(0)
s_barrier
Mavvs 0,96,128
s_add_u32 s60, s60, 32768
s_cmp_ge_u32 s60, 98304
s_cselect_b32 s60, 0, s60
Mavvs 4,100,128
v_add_u32 v18, s60, v16
v_sub_f32_e64 v183, v183, v184
Mavvs 8,104,128
s_add_u32 m0, s52, 49152
s_add_u32 s58, s58, 262144
v_add_u32_e64 v19, s60, v17
Mavvs 12,108,128
RT 64,20,0
CV 208,168,169
Mavvs 16,112,128
buffer_load_dwordx4 v12, s[12:15], s58 offen lds
Mavvs 20,116,128
RT 66,20,2048
CV 209,170,171
Mavvs 24,120,128
R4 32,18,0
CV 210,172,173
CV 211,174,175
Mavvs 28,124,128
CV 212,176,177
CV 213,178,179
Mavvs 32,96,132
R4 36,18,2048
CV 214,180,181
Mavvs 36,100,132
CV 215,182,183
v_lshlrev_b32_e64 v168, 16, v208
v_and_b32 v169, 0xffff0000, v208
Mavvs 40,104,132
buffer_load_dwordx4 v13, s[12:15], s58 offen offset:1024 lds
Mavvs 44,108,132
R4 40,18,4096
R4 44,18,6144
Mavvs 48,112,132
v_lshlrev_b32_e64 v170, 16, v209
v_and_b32 v171, 0xffff0000, v209
Mavvs 52,116,132
R4 48,18,8192
v_lshlrev_b32_e64 v172, 16, v210
Mavvs 56,120,132
v_and_b32 v173, 0xffff0000, v210
v_lshlrev_b32_e64 v174, 16, v211
Mavvs 60,124,132
R4 52,18,10240
v_and_b32 v175, 0xffff0000, v211
v_lshlrev_b32_e64 v176, 16, v212
Mavvs 64,96,136
buffer_load_dwordx4 v14, s[12:15], s58 offen offset:2048 lds
Mavvs 68,100,136
R4 56,18,12288
v_and_b32 v177, 0xffff0000, v212
Mavvs 72,104,136
R4 60,18,14336
v_lshlrev_b32_e64 v178, 16, v213
v_and_b32 v179, 0xffff0000, v213
Mavvs 76,108,136
RT 68,21,0
v_lshlrev_b32_e64 v180, 16, v214
Mavvs 80,112,136
v_and_b32 v181, 0xffff0000, v214
v_lshlrev_b32_e64 v182, 16, v215
Mavvs 84,116,136
RT 70,21,2048
v_and_b32 v183, 0xffff0000, v215
v_mul_f32_e64 v168, v168, v186
Mavvs 88,120,136
buffer_load_dwordx4 v15, s[12:15], s58 offen offset:3072 lds
Mavvs 92,124,136
RT 72,22,0
v_mul_f32_e64 v169, v169, v186
Mavvs 96,96,140
RT 74,22,2048
v_mul_f32 v170, v170, v186
v_mul_f32 v171, v171, v186
Mavvs 100,100,140
v_mul_f32 v172, v172, v186
v_mul_f32 v173, v173, v186
Mavvs 104,104,140
RT 76,23,0
v_mul_f32_e64 v174, v174, v186
Mavvs 108,108,140
v_mul_f32 v175, v175, v186
v_mul_f32 v176, v176, v186
Mavvs 112,112,140
s_mov_b32 m0, s59
RT 78,23,2048
Mavvs 116,116,140
RT 80,24,0
v_mul_f32 v177, v177, v186
v_mul_f32_e64 v178, v178, v186
Mavvs 120,120,140
s_add_u32 s57, s57, 128
v_mul_f32 v179, v179, v186
v_mul_f32 v180, v180, v186
Mavvs 124,124,140
RT 82,24,2048
v_mul_f32 v181, v181, v186
v_mul_f32 v182, v182, v186
Mavvs 128,96,144
buffer_load_dwordx4 v8, s[8:11], s57 offen lds
Mavvs 132,100,144
RT 84,25,0
v_mul_f32_e64 v183, v183, v186
Mavvs 136,104,144
RT 86,25,2048
CV 208,168,169
Mavvs 140,108,144
CV 209,170,171
CV 210,172,173
Mavvs 144,112,144
RT 88,26,0
CV 211,174,175
Mavvs 148,116,144
CV 212,176,177
CV 213,178,179
CV 214,180,181
CV 215,182,183
Mavvs 152,120,144
buffer_load_dwordx4 v9, s[8:11], s57 offen offset:1024 lds
Mavvs 156,124,144
RT 90,26,2048
RT 92,27,0
Mavvs 160,96,148
s_lshr_b32 s76, s68, 4
s_mul_i32 s76, s76, 14*1024
s_and_b32 s77, s68, 15
Mavvs 164,100,148
RT 94,27,2048
s_lshl_b32 s77, s77, 6
Mavvs 168,104,148
s_add_u32 s76, s76, s77
s_add_u32 s76, s76, 0x2000000
s_add_u32 s77, s76, 7168
Mavvs 172,108,148
buffer_store_dwordx4 v[208:211], v193, s[4:7], s76 offen sc1
Mavvs 176,112,148
buffer_load_dwordx4 v10, s[8:11], s57 offen offset:2048 lds
Mavvs 180,116,148
buffer_store_dwordx4 v[212:215], v193, s[4:7], s77 offen sc1
Mavvs 184,120,148
Mavvs 188,124,148
Mavvs 192,96,152
Mavvs 196,100,152
Mavvs 200,104,152
buffer_load_dwordx4 v11, s[8:11], s57 offen offset:3072 lds
Mavvs 204,108,152
Mavvs 208,112,152
Mavvs 212,116,152
Mavvs 216,120,152
Mavvs 220,124,152
Mavvs 224,96,156
Mavvs 228,100,156
Mavvs 232,104,156
Mavvs 236,108,156
Mavvs 240,112,156
Mavvs 244,116,156
Mavvs 248,120,156
Mavvs 252,124,156
s_mov_b32 s61, 1
AL_14:
s_waitcnt vmcnt(16) lgkmcnt(0)
s_barrier
Mavvs 0,32,64
RT 128,20,16384
RT 130,20,18432
Mavvs 4,36,64
R4 96,19,0
Mavvs 8,40,64
s_add_u32 m0, s52, 0
s_add_u32 s58, s58, 262144
Mavvs 12,44,64
buffer_load_dwordx4 v12, s[12:15], s58 offen lds
Mavvs 16,48,64
R4 100,19,2048
Mavvs 20,52,64
R4 104,19,4096
Mavvs 24,56,64
Mavvs 28,60,64
R4 108,19,6144
Mavvs 32,32,68
buffer_load_dwordx4 v13, s[12:15], s58 offen offset:1024 lds
Mavvs 36,36,68
R4 112,19,8192
Mavvs 40,40,68
Mavvs 44,44,68
R4 116,19,10240
Mavvs 48,48,68
Mavvs 52,52,68
R4 120,19,12288
Mavvs 56,56,68
buffer_load_dwordx4 v14, s[12:15], s58 offen offset:2048 lds
Mavvs 60,60,68
R4 124,19,14336
Mavvs 64,32,72
RT 132,21,16384
Mavvs 68,36,72
Mavvs 72,40,72
RT 134,21,18432
Mavvs 76,44,72
buffer_load_dwordx4 v15, s[12:15], s58 offen offset:3072 lds
Mavvs 80,48,72
RT 136,22,16384
Mavvs 84,52,72
Mavvs 88,56,72
RT 138,22,18432
Mavvs 92,60,72
Mavvs 96,32,76
s_add_u32 m0, s59, 16384
RT 140,23,16384
Mavvs 100,36,76
Mavvs 104,40,76
s_add_u32 s73, s57, 262144
RT 142,23,18432
Mavvs 108,44,76
Mavvs 112,48,76
buffer_load_dwordx4 v8, s[8:11], s73 offen lds
Mavvs 116,52,76
RT 144,24,16384
RT 146,24,18432
Mavvs 120,56,76
Mavvs 124,60,76
RT 148,25,16384
Mavvs 128,32,80
Mavvs 132,36,80
buffer_load_dwordx4 v9, s[8:11], s73 offen offset:1024 lds
Mavvs 136,40,80
RT 150,25,18432
Mavvs 140,44,80
RT 152,26,16384
Mavvs 144,48,80
Mavvs 148,52,80
RT 154,26,18432
Mavvs 152,56,80
Mavvs 156,60,80
buffer_load_dwordx4 v10, s[8:11], s73 offen offset:2048 lds
Mavvs 160,32,84
RT 156,27,16384
Mavvs 164,36,84
RT 158,27,18432
Mavvs 168,40,84
Mavvs 172,44,84
Mavvs 176,48,84
buffer_load_dwordx4 v11, s[8:11], s73 offen offset:3072 lds
Mavvs 180,52,84
Mavvs 184,56,84
Mavvs 188,60,84
Mavvs 192,32,88
Mavvs 196,36,88
s_add_u32 s59, s59, 32768
Mavvs 200,40,88
Mavvs 204,44,88
s_cmp_ge_u32 s59, 163840
s_cselect_b32 s72, 98304, 0
Mavvs 208,48,88
Mavvs 212,52,88
Mavvs 216,56,88
Mavvs 220,60,88
s_sub_u32 s59, s59, s72
Mavvs 224,32,92
Mavvs 228,36,92
Mavvs 232,40,92
Mavvs 236,44,92
Mavvs 240,48,92
Mavvs 244,52,92
Mavvs 248,56,92
Mavvs 252,60,92
s_waitcnt vmcnt(16) lgkmcnt(0)
s_barrier
Mavvs 0,96,128
s_add_u32 s60, s60, 32768
s_cmp_ge_u32 s60, 98304
s_cselect_b32 s60, 0, s60
Mavvs 4,100,128
v_add_u32_e64 v18, s60, v16
Mavvs 8,104,128
s_add_u32 m0, s52, 16384
s_add_u32 s58, s58, 262144
v_add_u32_e64 v19, s60, v17
Mavvs 12,108,128
RT 64,20,32768
Mavvs 16,112,128
buffer_load_dwordx4 v12, s[12:15], s58 offen lds
Mavvs 20,116,128
RT 66,20,34816
Mavvs 24,120,128
R4 32,18,0
Mavvs 28,124,128
Mavvs 32,96,132
R4 36,18,2048
Mavvs 36,100,132
Mavvs 40,104,132
buffer_load_dwordx4 v13, s[12:15], s58 offen offset:1024 lds
Mavvs 44,108,132
R4 40,18,4096
R4 44,18,6144
Mavvs 48,112,132
Mavvs 52,116,132
R4 48,18,8192
Mavvs 56,120,132
Mavvs 60,124,132
R4 52,18,10240
Mavvs 64,96,136
buffer_load_dwordx4 v14, s[12:15], s58 offen offset:2048 lds
Mavvs 68,100,136
R4 56,18,12288
Mavvs 72,104,136
R4 60,18,14336
Mavvs 76,108,136
RT 68,21,32768
Mavvs 80,112,136
Mavvs 84,116,136
RT 70,21,34816
Mavvs 88,120,136
buffer_load_dwordx4 v15, s[12:15], s58 offen offset:3072 lds
Mavvs 92,124,136
RT 72,22,32768
Mavvs 96,96,140
RT 74,22,34816
Mavvs 100,100,140
Mavvs 104,104,140
RT 76,23,32768
Mavvs 108,108,140
Mavvs 112,112,140
s_mov_b32 m0, s59
RT 78,23,34816
Mavvs 116,116,140
RT 80,24,32768
Mavvs 120,120,140
s_add_u32 s57, s57, 128
Mavvs 124,124,140
RT 82,24,34816
Mavvs 128,96,144
buffer_load_dwordx4 v8, s[8:11], s57 offen lds
Mavvs 132,100,144
RT 84,25,32768
Mavvs 136,104,144
RT 86,25,34816
Mavvs 140,108,144
Mavvs 144,112,144
RT 88,26,32768
Mavvs 148,116,144
Mavvs 152,120,144
buffer_load_dwordx4 v9, s[8:11], s57 offen offset:1024 lds
Mavvs 156,124,144
RT 90,26,34816
RT 92,27,32768
Mavvs 160,96,148
Mavvs 164,100,148
RT 94,27,34816
Mavvs 168,104,148
Mavvs 172,108,148
Mavvs 176,112,148
buffer_load_dwordx4 v10, s[8:11], s57 offen offset:2048 lds
Mavvs 180,116,148
Mavvs 184,120,148
Mavvs 188,124,148
Mavvs 192,96,152
Mavvs 196,100,152
Mavvs 200,104,152
buffer_load_dwordx4 v11, s[8:11], s57 offen offset:3072 lds
Mavvs 204,108,152
Mavvs 208,112,152
Mavvs 212,116,152
Mavvs 216,120,152
Mavvs 220,124,152
Mavvs 224,96,156
Mavvs 228,100,156
Mavvs 232,104,156
Mavvs 236,108,156
Mavvs 240,112,156
Mavvs 244,116,156
Mavvs 248,120,156
Mavvs 252,124,156
s_waitcnt vmcnt(16) lgkmcnt(0)
s_barrier
Mavvs 0,32,64
RT 128,20,49152
RT 130,20,51200
Mavvs 4,36,64
R4 96,19,0
Mavvs 8,40,64
s_add_u32 m0, s52, 32768
s_add_u32 s58, s58, 262144
Mavvs 12,44,64
buffer_load_dwordx4 v12, s[12:15], s58 offen lds
Mavvs 16,48,64
R4 100,19,2048
Mavvs 20,52,64
R4 104,19,4096
Mavvs 24,56,64
Mavvs 28,60,64
R4 108,19,6144
Mavvs 32,32,68
buffer_load_dwordx4 v13, s[12:15], s58 offen offset:1024 lds
Mavvs 36,36,68
R4 112,19,8192
Mavvs 40,40,68
Mavvs 44,44,68
R4 116,19,10240
Mavvs 48,48,68
Mavvs 52,52,68
R4 120,19,12288
Mavvs 56,56,68
buffer_load_dwordx4 v14, s[12:15], s58 offen offset:2048 lds
Mavvs 60,60,68
R4 124,19,14336
Mavvs 64,32,72
RT 132,21,49152
Mavvs 68,36,72
Mavvs 72,40,72
RT 134,21,51200
Mavvs 76,44,72
buffer_load_dwordx4 v15, s[12:15], s58 offen offset:3072 lds
Mavvs 80,48,72
RT 136,22,49152
Mavvs 84,52,72
Mavvs 88,56,72
RT 138,22,51200
Mavvs 92,60,72
Mavvs 96,32,76
s_add_u32 m0, s59, 16384
RT 140,23,49152
Mavvs 100,36,76
Mavvs 104,40,76
s_add_u32 s73, s57, 262144
RT 142,23,51200
Mavvs 108,44,76
Mavvs 112,48,76
buffer_load_dwordx4 v8, s[8:11], s73 offen lds
Mavvs 116,52,76
RT 144,24,49152
RT 146,24,51200
Mavvs 120,56,76
Mavvs 124,60,76
RT 148,25,49152
Mavvs 128,32,80
Mavvs 132,36,80
buffer_load_dwordx4 v9, s[8:11], s73 offen offset:1024 lds
Mavvs 136,40,80
RT 150,25,51200
Mavvs 140,44,80
RT 152,26,49152
Mavvs 144,48,80
Mavvs 148,52,80
RT 154,26,51200
Mavvs 152,56,80
Mavvs 156,60,80
buffer_load_dwordx4 v10, s[8:11], s73 offen offset:2048 lds
Mavvs 160,32,84
RT 156,27,49152
Mavvs 164,36,84
RT 158,27,51200
Mavvs 168,40,84
Mavvs 172,44,84
Mavvs 176,48,84
buffer_load_dwordx4 v11, s[8:11], s73 offen offset:3072 lds
Mavvs 180,52,84
Mavvs 184,56,84
Mavvs 188,60,84
Mavvs 192,32,88
Mavvs 196,36,88
s_add_u32 s59, s59, 32768
Mavvs 200,40,88
Mavvs 204,44,88
s_cmp_ge_u32 s59, 163840
s_cselect_b32 s72, 98304, 0
Mavvs 208,48,88
Mavvs 212,52,88
Mavvs 216,56,88
Mavvs 220,60,88
s_sub_u32 s59, s59, s72
Mavvs 224,32,92
Mavvs 228,36,92
Mavvs 232,40,92
Mavvs 236,44,92
Mavvs 240,48,92
Mavvs 244,52,92
Mavvs 248,56,92
Mavvs 252,60,92
s_waitcnt vmcnt(16) lgkmcnt(0)
s_barrier
Mavvs 0,96,128
s_add_u32 s60, s60, 32768
s_cmp_ge_u32 s60, 98304
s_cselect_b32 s60, 0, s60
Mavvs 4,100,128
v_add_u32 v18, s60, v16
Mavvs 8,104,128
s_add_u32 m0, s52, 49152
s_add_u32 s58, s58, 262144
v_add_u32_e64 v19, s60, v17
Mavvs 12,108,128
RT 64,20,0
Mavvs 16,112,128
buffer_load_dwordx4 v12, s[12:15], s58 offen lds
Mavvs 20,116,128
RT 66,20,2048
Mavvs 24,120,128
R4 32,18,0
Mavvs 28,124,128
Mavvs 32,96,132
R4 36,18,2048
Mavvs 36,100,132
Mavvs 40,104,132
buffer_load_dwordx4 v13, s[12:15], s58 offen offset:1024 lds
Mavvs 44,108,132
R4 40,18,4096
R4 44,18,6144
Mavvs 48,112,132
Mavvs 52,116,132
R4 48,18,8192
Mavvs 56,120,132
Mavvs 60,124,132
R4 52,18,10240
Mavvs 64,96,136
buffer_load_dwordx4 v14, s[12:15], s58 offen offset:2048 lds
Mavvs 68,100,136
R4 56,18,12288
Mavvs 72,104,136
R4 60,18,14336
Mavvs 76,108,136
RT 68,21,0
Mavvs 80,112,136
Mavvs 84,116,136
RT 70,21,2048
Mavvs 88,120,136
buffer_load_dwordx4 v15, s[12:15], s58 offen offset:3072 lds
Mavvs 92,124,136
RT 72,22,0
Mavvs 96,96,140
RT 74,22,2048
Mavvs 100,100,140
Mavvs 104,104,140
RT 76,23,0
Mavvs 108,108,140
Mavvs 112,112,140
s_mov_b32 m0, s59
RT 78,23,2048
Mavvs 116,116,140
RT 80,24,0
Mavvs 120,120,140
s_add_u32 s57, s57, 128
Mavvs 124,124,140
RT 82,24,2048
Mavvs 128,96,144
buffer_load_dwordx4 v8, s[8:11], s57 offen lds
Mavvs 132,100,144
RT 84,25,0
Mavvs 136,104,144
RT 86,25,2048
Mavvs 140,108,144
Mavvs 144,112,144
RT 88,26,0
Mavvs 148,116,144
Mavvs 152,120,144
buffer_load_dwordx4 v9, s[8:11], s57 offen offset:1024 lds
Mavvs 156,124,144
RT 90,26,2048
RT 92,27,0
Mavvs 160,96,148
Mavvs 164,100,148
RT 94,27,2048
Mavvs 168,104,148
Mavvs 172,108,148
Mavvs 176,112,148
buffer_load_dwordx4 v10, s[8:11], s57 offen offset:2048 lds
Mavvs 180,116,148
Mavvs 184,120,148
Mavvs 188,124,148
Mavvs 192,96,152
Mavvs 196,100,152
Mavvs 200,104,152
buffer_load_dwordx4 v11, s[8:11], s57 offen offset:3072 lds
Mavvs 204,108,152
Mavvs 208,112,152
Mavvs 212,116,152
Mavvs 216,120,152
Mavvs 220,124,152
Mavvs 224,96,156
Mavvs 228,100,156
Mavvs 232,104,156
Mavvs 236,108,156
Mavvs 240,112,156
Mavvs 244,116,156
Mavvs 248,120,156
Mavvs 252,124,156
s_add_u32 s61, s61, 1
s_cmp_lg_u32 s44, 0
s_cbranch_scc1 AM_16
s_cmp_lg_u32 s61, 2
s_cbranch_scc1 AM_15
v_mov_b32_e64 v2, 0
buffer_load_dword v6, v2, s[40:43], 0 offen
AM_15:
s_cmp_lg_u32 s61, 4
s_cbranch_scc1 AM_16
s_mov_b32 s77, 0
AM_17:
v_readfirstlane_b32 s76, v6
s_cmp_lg_u32 s76, 0
s_cbranch_scc1 AM_18
s_sleep 8
v_mov_b32 v2, 0
buffer_load_dword v6, v2, s[40:43], 0 offen sc1
s_waitcnt vmcnt(0)
s_add_u32 s77, s77, 1
s_cmp_lt_u32 s77, 20000
s_cbranch_scc1 AM_17
AM_18:
s_lshr_b32 s76, s2, 4
s_lshl_b32 s76, s76, 12
s_add_u32 s76, s76, 0x6110000
s_and_b32 s77, s2, 15
s_lshl_b32 s77, s77, 2
s_add_u32 s76, s76, s77
buffer_store_dword v6, v5, s[4:7], s76 offen sc1
s_cmp_lg_u32 s45, 0
s_cbranch_scc1 AM_16
s_lshl_b32 s76, s48, 12
s_add_u32 s76, s76, 0x6150000
v_mov_b32 v2, 0
buffer_store_dword v2, v5, s[4:7], s76 offen sc1
AM_16:
s_cmp_lt_u32 s61, 6
s_cbranch_scc1 AL_14
s_waitcnt vmcnt(16) lgkmcnt(0)
s_barrier
Mavvs 0,32,64
RT 128,20,16384
RT 130,20,18432
Mavvs 4,36,64
R4 96,19,0
Mavvs 8,40,64
s_add_u32 m0, s52, 0
s_add_u32 s58, s58, 262144
Mavvs 12,44,64
buffer_load_dwordx4 v12, s[12:15], s58 offen lds
Mavvs 16,48,64
R4 100,19,2048
Mavvs 20,52,64
R4 104,19,4096
Mavvs 24,56,64
Mavvs 28,60,64
R4 108,19,6144
Mavvs 32,32,68
buffer_load_dwordx4 v13, s[12:15], s58 offen offset:1024 lds
Mavvs 36,36,68
R4 112,19,8192
Mavvs 40,40,68
Mavvs 44,44,68
R4 116,19,10240
Mavvs 48,48,68
Mavvs 52,52,68
R4 120,19,12288
Mavvs 56,56,68
buffer_load_dwordx4 v14, s[12:15], s58 offen offset:2048 lds
Mavvs 60,60,68
R4 124,19,14336
Mavvs 64,32,72
RT 132,21,16384
Mavvs 68,36,72
Mavvs 72,40,72
RT 134,21,18432
Mavvs 76,44,72
buffer_load_dwordx4 v15, s[12:15], s58 offen offset:3072 lds
Mavvs 80,48,72
RT 136,22,16384
Mavvs 84,52,72
Mavvs 88,56,72
RT 138,22,18432
Mavvs 92,60,72
Mavvs 96,32,76
s_add_u32 m0, s59, 16384
RT 140,23,16384
Mavvs 100,36,76
Mavvs 104,40,76
s_add_u32 s73, s57, 262144
RT 142,23,18432
Mavvs 108,44,76
Mavvs 112,48,76
buffer_load_dwordx4 v8, s[8:11], s73 offen lds
Mavvs 116,52,76
RT 144,24,16384
RT 146,24,18432
Mavvs 120,56,76
Mavvs 124,60,76
RT 148,25,16384
Mavvs 128,32,80
Mavvs 132,36,80
buffer_load_dwordx4 v9, s[8:11], s73 offen offset:1024 lds
Mavvs 136,40,80
RT 150,25,18432
Mavvs 140,44,80
RT 152,26,16384
Mavvs 144,48,80
Mavvs 148,52,80
RT 154,26,18432
Mavvs 152,56,80
Mavvs 156,60,80
buffer_load_dwordx4 v10, s[8:11], s73 offen offset:2048 lds
Mavvs 160,32,84
RT 156,27,16384
Mavvs 164,36,84
RT 158,27,18432
Mavvs 168,40,84
Mavvs 172,44,84
Mavvs 176,48,84
buffer_load_dwordx4 v11, s[8:11], s73 offen offset:3072 lds
Mavvs 180,52,84
Mavvs 184,56,84
Mavvs 188,60,84
Mavvs 192,32,88
Mavvs 196,36,88
s_add_u32 s59, s59, 32768
Mavvs 200,40,88
Mavvs 204,44,88
s_cmp_ge_u32 s59, 163840
s_cselect_b32 s72, 98304, 0
Mavvs 208,48,88
Mavvs 212,52,88
Mavvs 216,56,88
Mavvs 220,60,88
s_sub_u32 s59, s59, s72
Mavvs 224,32,92
Mavvs 228,36,92
Mavvs 232,40,92
Mavvs 236,44,92
Mavvs 240,48,92
Mavvs 244,52,92
Mavvs 248,56,92
Mavvs 252,60,92
s_waitcnt vmcnt(16) lgkmcnt(0)
s_barrier
Mavvs 0,96,128
s_add_u32 s60, s60, 32768
s_cmp_ge_u32 s60, 98304
s_cselect_b32 s60, 0, s60
Mavvs 4,100,128
v_add_u32 v18, s60, v16
Mavvs 8,104,128
s_add_u32 m0, s52, 16384
s_add_u32 s58, s58, 262144
v_add_u32_e64 v19, s60, v17
Mavvs 12,108,128
RT 64,20,32768
Mavvs 16,112,128
buffer_load_dwordx4 v12, s[12:15], s58 offen lds
Mavvs 20,116,128
RT 66,20,34816
Mavvs 24,120,128
R4 32,18,0
Mavvs 28,124,128
Mavvs 32,96,132
R4 36,18,2048
Mavvs 36,100,132
Mavvs 40,104,132
buffer_load_dwordx4 v13, s[12:15], s58 offen offset:1024 lds
Mavvs 44,108,132
R4 40,18,4096
R4 44,18,6144
Mavvs 48,112,132
Mavvs 52,116,132
R4 48,18,8192
Mavvs 56,120,132
Mavvs 60,124,132
R4 52,18,10240
Mavvs 64,96,136
buffer_load_dwordx4 v14, s[12:15], s58 offen offset:2048 lds
Mavvs 68,100,136
R4 56,18,12288
Mavvs 72,104,136
R4 60,18,14336
Mavvs 76,108,136
RT 68,21,32768
Mavvs 80,112,136
Mavvs 84,116,136
RT 70,21,34816
Mavvs 88,120,136
buffer_load_dwordx4 v15, s[12:15], s58 offen offset:3072 lds
Mavvs 92,124,136
RT 72,22,32768
Mavvs 96,96,140
RT 74,22,34816
Mavvs 100,100,140
Mavvs 104,104,140
RT 76,23,32768
Mavvs 108,108,140
Mavvs 112,112,140
s_mov_b32 m0, s59
RT 78,23,34816
Mavvs 116,116,140
RT 80,24,32768
Mavvs 120,120,140
s_add_u32 s57, s57, 128
Mavvs 124,124,140
RT 82,24,34816
Mavvs 128,96,144
buffer_load_dwordx4 v8, s[8:11], s57 offen lds
Mavvs 132,100,144
RT 84,25,32768
Mavvs 136,104,144
RT 86,25,34816
Mavvs 140,108,144
Mavvs 144,112,144
RT 88,26,32768
Mavvs 148,116,144
Mavvs 152,120,144
buffer_load_dwordx4 v9, s[8:11], s57 offen offset:1024 lds
Mavvs 156,124,144
RT 90,26,34816
RT 92,27,32768
Mavvs 160,96,148
Mavvs 164,100,148
RT 94,27,34816
Mavvs 168,104,148
Mavvs 172,108,148
Mavvs 176,112,148
buffer_load_dwordx4 v10, s[8:11], s57 offen offset:2048 lds
Mavvs 180,116,148
Mavvs 184,120,148
s_mul_i32 s62, s45, 2097152
s_add_u32 s62, s62, 0x8000000
s_mul_i32 s76, s47, 262144
Mavvs 188,124,148
s_add_u32 s62, s62, s76
s_and_b32 s76, s44, 1
Mavvs 192,96,152
s_mul_i32 s76, s76, 131072
Mavvs 196,100,152
s_add_u32 s62, s62, s76
Mavvs 200,104,152
buffer_load_dwordx4 v11, s[8:11], s57 offen offset:3072 lds
Mavvs 204,108,152
s_lshr_b32 s76, s44, 1
s_lshl_b32 s76, s76, 13
Mavvs 208,112,152
s_add_u32 s62, s62, s76
s_add_u32 s62, s62, 16384
Mavvs 212,116,152
s_mov_b32 s86, 32768
Mavvs 216,120,152
s_mov_b32 s87, 32768
Mavvs 220,124,152
s_mov_b32 s88, -97280
Mavvs 224,96,156
s_mov_b32 s89, -97280
Mavvs 228,100,156
s_lshl_b32 s76, s48, 3
Mavvs 232,104,156
s_add_u32 s76, s76, s44
Mavvs 236,108,156
s_mul_i32 s76, s76, 14336
Mavvs 240,112,156
s_add_u32 s71, s76, 0x2000000
Mavvs 244,116,156
Mavvs 248,120,156
Mavvs 252,124,156
s_waitcnt vmcnt(16) lgkmcnt(0)
s_barrier
Mavvs 0,32,64
RT 128,20,49152
RT 130,20,51200
Mavvs 4,36,64
R4 96,19,0
Mavvs 8,40,64
s_add_u32 m0, s52, 32768
s_add_u32 s58, s58, 262144
Mavvs 12,44,64
buffer_load_dwordx4 v12, s[12:15], s58 offen lds
Mavvs 16,48,64
R4 100,19,2048
Mavvs 20,52,64
R4 104,19,4096
s_lshl_b32 s70, s48, 12
Mavvs 24,56,64
s_add_u32 s70, s70, 0x6110000
Mavvs 28,60,64
R4 108,19,6144
Mavvs 32,32,68
buffer_load_dwordx4 v13, s[12:15], s58 offen offset:1024 lds
Mavvs 36,36,68
R4 112,19,8192
Mavvs 40,40,68
buffer_load_dword v7, v30, s[4:7], s70 offen sc1
Mavvs 44,44,68
R4 116,19,10240
Mavvs 48,48,68
Mavvs 52,52,68
R4 120,19,12288
Mavvs 56,56,68
buffer_load_dwordx4 v14, s[12:15], s58 offen offset:2048 lds
Mavvs 60,60,68
R4 124,19,14336
Mavvs 64,32,72
RT 132,21,49152
Mavvs 68,36,72
Mavvs 72,40,72
RT 134,21,51200
Mavvs 76,44,72
buffer_load_dwordx4 v15, s[12:15], s58 offen offset:3072 lds
Mavvs 80,48,72
RT 136,22,49152
Mavvs 84,52,72
Mavvs 88,56,72
RT 138,22,51200
Mavvs 92,60,72
Mavvs 96,32,76
s_add_u32 m0, s59, 16384
RT 140,23,49152
Mavvs 100,36,76
Mavvs 104,40,76
s_add_u32 s73, s57, 262144
RT 142,23,51200
Mavvs 108,44,76
Mavvs 112,48,76
buffer_load_dwordx4 v8, s[8:11], s73 offen lds
Mavvs 116,52,76
RT 144,24,49152
RT 146,24,51200
Mavvs 120,56,76
Mavvs 124,60,76
RT 148,25,49152
Mavvs 128,32,80
Mavvs 132,36,80
buffer_load_dwordx4 v9, s[8:11], s73 offen offset:1024 lds
Mavvs 136,40,80
RT 150,25,51200
Mavvs 140,44,80
RT 152,26,49152
Mavvs 144,48,80
Mavvs 148,52,80
RT 154,26,51200
Mavvs 152,56,80
Mavvs 156,60,80
buffer_load_dwordx4 v10, s[8:11], s73 offen offset:2048 lds
Mavvs 160,32,84
RT 156,27,49152
Mavvs 164,36,84
RT 158,27,51200
Mavvs 168,40,84
Mavvs 172,44,84
Mavvs 176,48,84
buffer_load_dwordx4 v11, s[8:11], s73 offen offset:3072 lds
Mavvs 180,52,84
Mavvs 184,56,84
Mavvs 188,60,84
Mavvs 192,32,88
Mavvs 196,36,88
s_add_u32 s59, s59, 32768
Mavvs 200,40,88
Mavvs 204,44,88
s_cmp_ge_u32 s59, 163840
s_cselect_b32 s72, 98304, 0
Mavvs 208,48,88
Mavvs 212,52,88
Mavvs 216,56,88
Mavvs 220,60,88
s_sub_u32 s59, s59, s72
Mavvs 224,32,92
Mavvs 228,36,92
Mavvs 232,40,92
Mavvs 236,44,92
Mavvs 240,48,92
Mavvs 244,52,92
Mavvs 248,56,92
Mavvs 252,60,92
s_waitcnt vmcnt(17) lgkmcnt(0)
s_barrier
Mavvs 0,96,128
s_add_u32 s60, s60, 32768
s_cmp_ge_u32 s60, 98304
s_cselect_b32 s60, 0, s60
Mavvs 4,100,128
v_add_u32_e64 v18, s60, v16
Mavvs 8,104,128
s_add_u32 m0, s52, 49152
v_add_u32_e64 v19, s60, v17
Mavvs 12,108,128
RT 64,20,0
Mavvs 16,112,128
s_add_u32 s58, s58, 262144
Mavvs 20,116,128
RT 66,20,2048
Mavvs 24,120,128
R4 32,18,0
Mavvs 28,124,128
Mavvs 32,96,132
buffer_load_dwordx4 v12, s[12:15], s58 offen lds
Mavvs 36,100,132
R4 36,18,2048
Mavvs 40,104,132
R4 40,18,4096
Mavvs 44,108,132
R4 44,18,6144
Mavvs 48,112,132
Mavvs 52,116,132
R4 48,18,8192
Mavvs 56,120,132
Mavvs 60,124,132
R4 52,18,10240
Mavvs 64,96,136
R4 56,18,12288
Mavvs 68,100,136
Mavvs 72,104,136
R4 60,18,14336
Mavvs 76,108,136
RT 68,21,0
Mavvs 80,112,136
buffer_load_dwordx4 v13, s[12:15], s58 offen offset:1024 lds
Mavvs 84,116,136
RT 70,21,2048
Mavvs 88,120,136
Mavvs 92,124,136
RT 72,22,0
Mavvs 96,96,140
RT 74,22,2048
Mavvs 100,100,140
Mavvs 104,104,140
RT 76,23,0
Mavvs 108,108,140
Mavvs 112,112,140
RT 78,23,2048
Mavvs 116,116,140
RT 80,24,0
Mavvs 120,120,140
Mavvs 124,124,140
RT 82,24,2048
Mavvs 128,96,144
buffer_load_dwordx4 v14, s[12:15], s58 offen offset:2048 lds
Mavvs 132,100,144
RT 84,25,0
Mavvs 136,104,144
RT 86,25,2048
Mavvs 140,108,144
Mavvs 144,112,144
RT 88,26,0
Mavvs 148,116,144
Mavvs 152,120,144
RT 90,26,2048
Mavvs 156,124,144
RT 92,27,0
Mavvs 160,96,148
Mavvs 164,100,148
RT 94,27,2048
Mavvs 168,104,148
Mavvs 172,108,148
Mavvs 176,112,148
buffer_load_dwordx4 v15, s[12:15], s58 offen offset:3072 lds
Mavvs 180,116,148
Mavvs 184,120,148
Mavvs 188,124,148
Mavvs 192,96,152
Mavvs 196,100,152
Mavvs 200,104,152
Mavvs 204,108,152
Mavvs 208,112,152
Mavvs 212,116,152
Mavvs 216,120,152
Mavvs 220,124,152
Mavvs 224,96,156
Mavvs 228,100,156
Mavvs 232,104,156
Mavvs 236,108,156
Mavvs 240,112,156
Mavvs 244,116,156
Mavvs 248,120,156
Mavvs 252,124,156
s_waitcnt vmcnt(13) lgkmcnt(0)
s_barrier
Mavvs 0,32,64
RT 128,20,16384
RT 130,20,18432
Mavvs 4,36,64
R4 96,19,0
s_mul_i32 s78, s3, 14336
Mavvs 8,40,64
v_and_b32 v10, 15, v1
v_lshlrev_b32 v10, 6, v10
Mavvs 12,44,64
R4 100,19,2048
v_and_b32_e64 v11, 48, v1
Mavvs 16,48,64
v_add_u32 v10, v10, v11
v_add_u32 v11, s78, v10
Mavvs 20,52,64
R4 104,19,4096
s_lshr_b32 s76, s2, 4
Mavvs 24,56,64
s_mul_i32 s76, s76, 28
s_mul_i32 s77, s44, 7
s_add_u32 s76, s76, s77
Mavvs 28,60,64
R4 108,19,6144
v_lshrrev_b32_e64 v200, 2, v1
Mavvs 32,32,68
v_min_u32 v200, 6, v200
v_add_u32 v200, s76, v200
Mavvs 36,36,68
R4 112,19,8192
v_and_b32_e64 v201, 3, v1
Mavvs 40,40,68
v_lshlrev_b32_e64 v201, 7, v201
v_lshl_add_u32 v202, v200, 13, v201
Mavvs 44,44,68
R4 116,19,10240
s_lshl_b32 s76, s45, 9
Mavvs 48,48,68
buffer_load_dword v31, v202, s[16:19], s76 offen
Mavvs 52,52,68
R4 120,19,12288
v_mul_u32_u24 v202, 3584, v200
Mavvs 56,56,68
R4 124,19,14336
v_add_u32 v202, v202, v201
Mavvs 60,60,68
s_lshl_b32 s76, s98, 1
s_and_b32 s76, s76, 0xffffff80
Mavvs 64,32,72
RT 132,21,16384
Mavvs 68,36,72
buffer_load_dword v31, v202, s[20:23], s76 offen
Mavvs 72,40,72
RT 134,21,18432
s_lshr_b32 s76, s2, 3
Mavvs 76,44,72
s_mul_i32 s76, s76, 4608
s_add_u32 s76, s76, 0
v_min_u32 v200, 35, v1
Mavvs 80,48,72
RT 136,22,16384
v_lshlrev_b32_e64 v200, 7, v200
Mavvs 84,52,72
v_add_u32_e64 v200, s76, v200
v_min_u32 v200, M_CODE_END-M_CODE_START-4, v200
Mavvs 88,56,72
RT 138,22,18432
Mavvs 92,60,72
global_load_dword v31, v200, s[66:67]
Mavvs 96,32,76
RT 140,23,16384
Mavvs 100,36,76
Mavvs 104,40,76
RT 142,23,18432
Mavvs 108,44,76
Mavvs 112,48,76
RT 144,24,16384
Mavvs 116,52,76
RT 146,24,18432
Mavvs 120,56,76
Mavvs 124,60,76
RT 148,25,16384
Mavvs 128,32,80
s_add_u32 m0, s52, 0
s_mov_b32 s74, 0
Mavvs 132,36,80
RT 150,25,18432
Mavvs 136,40,80
buffer_load_dwordx4 v12, s[16:19], s74 offen lds
Mavvs 140,44,80
RT 152,26,16384
Mavvs 144,48,80
Mavvs 148,52,80
RT 154,26,18432
Mavvs 152,56,80
buffer_load_dwordx4 v13, s[16:19], s74 offen offset:1024 lds
Mavvs 156,60,80
RT 156,27,16384
Mavvs 160,32,84
Mavvs 164,36,84
RT 158,27,18432
Mavvs 168,40,84
buffer_load_dwordx4 v14, s[16:19], s74 offen offset:2048 lds
Mavvs 172,44,84
Mavvs 176,48,84
Mavvs 180,52,84
buffer_load_dwordx4 v15, s[16:19], s74 offen offset:3072 lds
Mavvs 184,56,84
Mavvs 188,60,84
Mavvs 192,32,88
Mavvs 196,36,88
s_add_u32 m0, s53, 98304
Mavvs 200,40,88
Mavvs 204,44,88
s_mov_b32 s74, 0
Mavvs 208,48,88
buffer_load_dwordx4 v28, s[20:23], s74 offen lds
Mavvs 212,52,88
Mavvs 216,56,88
Mavvs 220,60,88
Mavvs 224,32,92
buffer_load_dwordx4 v29, s[20:23], s74 offen offset:1024 lds
Mavvs 228,36,92
Mavvs 232,40,92
Mavvs 236,44,92
Mavvs 240,48,92
Mavvs 244,52,92
Mavvs 248,56,92
Mavvs 252,60,92
s_waitcnt vmcnt(19)
s_cmp_lg_u32 s44, 0
s_cbranch_scc1 WOK_19
s_mov_b32 s73, 0
WSP_20:
v_cmp_eq_u32 vcc, v7, v6
s_and_b32 s72, vcc_lo, 0xffff
s_cmp_eq_u32 s72, 0xffff
s_cbranch_scc1 WOK_19
s_sleep 8
buffer_load_dword v7, v30, s[4:7], s70 offen sc1
s_waitcnt vmcnt(0)
s_add_u32 s73, s73, 1
s_cmp_lt_u32 s73, 20000
s_cbranch_scc1 WSP_20
WOK_19:
s_waitcnt vmcnt(13) lgkmcnt(0)
s_barrier
Mavvs 0,96,128
s_add_u32 s60, s60, 32768
s_cmp_ge_u32 s60, 98304
s_cselect_b32 s60, 0, s60
Mavvs 4,100,128
s_add_u32 s75, s71, 0
v_add_u32 v18, s60, v16
Mavvs 8,104,128
v_add_u32_e64 v19, s60, v17
Mavvs 12,108,128
RT 64,20,32768
Mavvs 16,112,128
buffer_load_dwordx4 v[160:163], v10, s[4:7], s75 offen offset:0 sc1
Mavvs 20,116,128
RT 66,20,34816
Mavvs 24,120,128
R4 32,18,0
Mavvs 28,124,128
buffer_load_dwordx4 v[164:167], v11, s[4:7], s75 offen offset:0 sc1
Mavvs 32,96,132
R4 36,18,2048
Mavvs 36,100,132
buffer_load_dwordx4 v[168:171], v10, s[4:7], s75 offen offset:1024 sc1
Mavvs 40,104,132
R4 40,18,4096
Mavvs 44,108,132
R4 44,18,6144
Mavvs 48,112,132
buffer_load_dwordx4 v[172:175], v11, s[4:7], s75 offen offset:1024 sc1
Mavvs 52,116,132
R4 48,18,8192
s_lshl_b32 s76, s98, 1
Mavvs 56,120,132
v_lshrrev_b32 v200, 4, v1
v_lshlrev_b32_e64 v200, 3, v200
Mavvs 60,124,132
R4 52,18,10240
Mavvs 64,96,136
R4 56,18,12288
Mavvs 68,100,136
buffer_load_dwordx2 v[224:225], v200, s[32:35], s76 offen offset:0
Mavvs 72,104,136
R4 60,18,14336
buffer_load_dwordx2 v[226:227], v200, s[32:35], s76 offen offset:32
Mavvs 76,108,136
RT 68,21,32768
Mavvs 80,112,136
buffer_load_dwordx2 v[228:229], v200, s[32:35], s76 offen offset:64
Mavvs 84,116,136
RT 70,21,34816
Mavvs 88,120,136
buffer_load_dwordx2 v[230:231], v200, s[32:35], s76 offen offset:96
Mavvs 92,124,136
RT 72,22,32768
Mavvs 96,96,140
RT 74,22,34816
Mavvs 100,100,140
buffer_load_dwordx2 v[232:233], v200, s[32:35], s76 offen offset:128
Mavvs 104,104,140
RT 76,23,32768
Mavvs 108,108,140
buffer_load_dwordx2 v[234:235], v200, s[32:35], s76 offen offset:160
Mavvs 112,112,140
RT 78,23,34816
Mavvs 116,116,140
RT 80,24,32768
Mavvs 120,120,140
buffer_load_dwordx2 v[236:237], v200, s[32:35], s76 offen offset:192
Mavvs 124,124,140
RT 82,24,34816
Mavvs 128,96,144
buffer_load_dwordx2 v[238:239], v200, s[32:35], s76 offen offset:224
Mavvs 132,100,144
RT 84,25,32768
s_add_u32 s75, s71, 2048
Mavvs 136,104,144
RT 86,25,34816
Mavvs 140,108,144
buffer_load_dwordx4 v[176:179], v10, s[4:7], s75 offen offset:0 sc1
Mavvs 144,112,144
RT 88,26,32768
Mavvs 148,116,144
buffer_load_dwordx4 v[180:183], v11, s[4:7], s75 offen offset:0 sc1
Mavvs 152,120,144
RT 90,26,34816
Mavvs 156,124,144
RT 92,27,32768
Mavvs 160,96,148
buffer_load_dwordx4 v[184:187], v10, s[4:7], s75 offen offset:1024 sc1
Mavvs 164,100,148
RT 94,27,34816
Mavvs 168,104,148
buffer_load_dwordx4 v[188:191], v11, s[4:7], s75 offen offset:1024 sc1
Mavvs 172,108,148
s_add_u32 m0, s52, 16384
s_mov_b32 s74, 262144
Mavvs 176,112,148
buffer_load_dwordx4 v12, s[16:19], s74 offen lds
Mavvs 180,116,148
buffer_load_dwordx4 v13, s[16:19], s74 offen offset:1024 lds
Mavvs 184,120,148
Mavvs 188,124,148
buffer_load_dwordx4 v14, s[16:19], s74 offen offset:2048 lds
Mavvs 192,96,152
Mavvs 196,100,152
Mavvs 200,104,152
buffer_load_dwordx4 v15, s[16:19], s74 offen offset:3072 lds
Mavvs 204,108,152
Mavvs 208,112,152
s_add_u32 m0, s53, 106496
Mavvs 212,116,152
s_mov_b32 s74, 114688
Mavvs 216,120,152
buffer_load_dwordx4 v28, s[20:23], s74 offen lds
Mavvs 220,124,152
Mavvs 224,96,156
buffer_load_dwordx4 v29, s[20:23], s74 offen offset:1024 lds
Mavvs 228,100,156
Mavvs 232,104,156
Mavvs 236,108,156
Mavvs 240,112,156
Mavvs 244,116,156
Mavvs 248,120,156
Mavvs 252,124,156
s_waitcnt vmcnt(31) lgkmcnt(0)
s_barrier
Mavvs 0,32,64
RT 128,20,49152
RT 130,20,51200
Mavvs 4,36,64
R4 96,19,0
s_add_u32 m0, s52, 32768
Mavvs 8,40,64
s_mov_b32 s74, 524288
Mavvs 12,44,64
R4 100,19,2048
Mavvs 16,48,64
buffer_load_dwordx4 v12, s[16:19], s74 offen lds
Mavvs 20,52,64
R4 104,19,4096
Mavvs 24,56,64
Mavvs 28,60,64
R4 108,19,6144
Mavvs 32,32,68
Mavvs 36,36,68
R4 112,19,8192
Mavvs 40,40,68
Mavvs 44,44,68
R4 116,19,10240
Mavvs 48,48,68
buffer_load_dwordx4 v13, s[16:19], s74 offen offset:1024 lds
Mavvs 52,52,68
R4 120,19,12288
Mavvs 56,56,68
R4 124,19,14336
Mavvs 60,60,68
Mavvs 64,32,72
RT 132,21,49152
Mavvs 68,36,72
Mavvs 72,40,72
RT 134,21,51200
Mavvs 76,44,72
Mavvs 80,48,72
RT 136,22,49152
Mavvs 84,52,72
buffer_load_dwordx4 v14, s[16:19], s74 offen offset:2048 lds
Mavvs 88,56,72
RT 138,22,51200
Mavvs 92,60,72
Mavvs 96,32,76
RT 140,23,49152
Mavvs 100,36,76
Mavvs 104,40,76
RT 142,23,51200
Mavvs 108,44,76
Mavvs 112,48,76
RT 144,24,49152
Mavvs 116,52,76
RT 146,24,51200
Mavvs 120,56,76
buffer_load_dwordx4 v15, s[16:19], s74 offen offset:3072 lds
Mavvs 124,60,76
RT 148,25,49152
Mavvs 128,32,80
Mavvs 132,36,80
RT 150,25,51200
Mavvs 136,40,80
Mavvs 140,44,80
RT 152,26,49152
Mavvs 144,48,80
s_add_u32 m0, s53, 114688
Mavvs 148,52,80
RT 154,26,51200
Mavvs 152,56,80
Mavvs 156,60,80
RT 156,27,49152
s_mov_b32 s74, 229376
Mavvs 160,32,84
Mavvs 164,36,84
RT 158,27,51200
Mavvs 168,40,84
buffer_load_dwordx4 v28, s[20:23], s74 offen lds
Mavvs 172,44,84
Mavvs 176,48,84
Mavvs 180,52,84
Mavvs 184,56,84
Mavvs 188,60,84
Mavvs 192,32,88
Mavvs 196,36,88
Mavvs 200,40,88
buffer_load_dwordx4 v29, s[20:23], s74 offen offset:1024 lds
Mavvs 204,44,88
Mavvs 208,48,88
Mavvs 212,52,88
Mavvs 216,56,88
Mavvs 220,60,88
Mavvs 224,32,92
Mavvs 228,36,92
Mavvs 232,40,92
Mavvs 236,44,92
Mavvs 240,48,92
Mavvs 244,52,92
Mavvs 248,56,92
Mavvs 252,60,92
LW 0
Mavvs 0,96,128
Mavvs 4,100,128
Mavvs 8,104,128
Mavvs 12,108,128
Mavvs 16,112,128
Mavvs 20,116,128
Mavvs 24,120,128
Mavvs 28,124,128
Mavvs 32,96,132
Mavvs 36,100,132
Mavvs 40,104,132
AR 208,0
AR 209,1
Mavvs 44,108,132
AR 210,2
AR 211,3
Mavvs 48,112,132
AR 212,4
AR 213,5
Mavvs 52,116,132
AR 214,6
AR 215,7
Mavvs 56,120,132
v_mul_f32 v208, s100, v208
v_mul_f32_e64 v209, s100, v209
Mavvs 60,124,132
v_mul_f32 v210, s100, v210
v_mul_f32 v211, s100, v211
Mavvs 64,96,136
v_mul_f32 v212, s100, v212
v_mul_f32 v213, s100, v213
Mavvs 68,100,136
v_mul_f32 v214, s100, v214
v_mul_f32 v215, s100, v215
Mavvs 72,104,136
CV 32,208,209
CV 33,210,211
Mavvs 76,108,136
CV 34,212,213
CV 35,214,215
buffer_store_dwordx4 v[32:35], v4, s[4:7], s62 offen sc1
Mavvs 80,112,136
s_add_u32 s62, s62, s86
AR 216,8
AR 217,9
Mavvs 84,116,136
AR 218,10
AR 219,11
AR 220,12
Mavvs 88,120,136
AR 221,13
AR 222,14
AR 223,15
Mavvs 92,124,136
v_mul_f32 v216, s100, v216
v_mul_f32 v217, s100, v217
v_mul_f32 v218, s100, v218
v_mul_f32_e64 v219, s100, v219
Mavvs 96,96,140
v_mul_f32 v220, s100, v220
v_mul_f32 v221, s100, v221
v_mul_f32_e64 v222, s100, v222
Mavvs 100,100,140
v_mul_f32_e64 v223, s100, v223
CV 36,216,217
CV 37,218,219
CV 38,220,221
Mavvs 104,104,140
CV 39,222,223
buffer_store_dwordx4 v[36:39], v4, s[4:7], s62 offen sc1
Mavvs 108,108,140
s_add_u32 s62, s62, s87
AR 208,16
AR 209,17
Mavvs 112,112,140
AR 210,18
AR 211,19
AR 212,20
AR 213,21
Mavvs 116,116,140
AR 214,22
AR 215,23
v_mul_f32 v208, s100, v208
Mavvs 120,120,140
v_mul_f32 v209, s100, v209
v_mul_f32 v210, s100, v210
v_mul_f32 v211, s100, v211
v_mul_f32 v212, s100, v212
Mavvs 124,124,140
v_mul_f32 v213, s100, v213
v_mul_f32 v214, s100, v214
v_mul_f32_e64 v215, s100, v215
Mavvs 128,96,144
CV 40,208,209
CV 41,210,211
CV 42,212,213
CV 43,214,215
Mavvs 132,100,144
buffer_store_dwordx4 v[40:43], v4, s[4:7], s62 offen sc1
Mavvs 136,104,144
s_add_u32 s62, s62, s86
AR 216,24
AR 217,25
AR 218,26
Mavvs 140,108,144
AR 219,27
AR 220,28
AR 221,29
Mavvs 144,112,144
AR 222,30
AR 223,31
v_mul_f32 v216, s100, v216
v_mul_f32_e64 v217, s100, v217
Mavvs 148,116,144
v_mul_f32 v218, s100, v218
v_mul_f32 v219, s100, v219
v_mul_f32_e64 v220, s100, v220
Mavvs 152,120,144
v_mul_f32 v221, s100, v221
v_mul_f32 v222, s100, v222
v_mul_f32_e64 v223, s100, v223
CV 44,216,217
Mavvs 156,124,144
CV 45,218,219
CV 46,220,221
CV 47,222,223
Mavvs 160,96,148
buffer_store_dwordx4 v[44:47], v4, s[4:7], s62 offen sc1
s_add_u32 s62, s62, s88
Mavvs 164,100,148
AR 208,32
AR 209,33
AR 210,34
AR 211,35
Mavvs 168,104,148
AR 212,36
AR 213,37
AR 214,38
Mavvs 172,108,148
AR 215,39
v_mul_f32 v208, s100, v208
v_mul_f32 v209, s100, v209
v_mul_f32 v210, s100, v210
Mavvs 176,112,148
v_mul_f32 v211, s100, v211
v_mul_f32 v212, s100, v212
v_mul_f32_e64 v213, s100, v213
Mavvs 180,116,148
v_mul_f32 v214, s100, v214
v_mul_f32 v215, s100, v215
CV 48,208,209
CV 49,210,211
Mavvs 184,120,148
CV 50,212,213
CV 51,214,215
buffer_store_dwordx4 v[48:51], v4, s[4:7], s62 offen sc1
Mavvs 188,124,148
s_add_u32 s62, s62, s86
AR 216,40
AR 217,41
Mavvs 192,96,152
AR 218,42
AR 219,43
Mavvs 196,100,152
AR 220,44
AR 221,45
AR 222,46
AR 223,47
Mavvs 200,104,152
v_mul_f32 v216, s100, v216
v_mul_f32 v217, s100, v217
v_mul_f32 v218, s100, v218
Mavvs 204,108,152
v_mul_f32 v219, s100, v219
v_mul_f32 v220, s100, v220
v_mul_f32 v221, s100, v221
v_mul_f32 v222, s100, v222
Mavvs 208,112,152
v_mul_f32_e64 v223, s100, v223
CV 52,216,217
CV 53,218,219
Mavvs 212,116,152
CV 54,220,221
CV 55,222,223
buffer_store_dwordx4 v[52:55], v4, s[4:7], s62 offen sc1
Mavvs 216,120,152
s_add_u32 s62, s62, s87
AR 208,48
AR 209,49
Mavvs 220,124,152
AR 210,50
AR 211,51
AR 212,52
Mavvs 224,96,156
AR 213,53
AR 214,54
AR 215,55
v_mul_f32 v208, s100, v208
Mavvs 228,100,156
v_mul_f32 v209, s100, v209
v_mul_f32 v210, s100, v210
v_mul_f32_e64 v211, s100, v211
Mavvs 232,104,156
v_mul_f32 v212, s100, v212
v_mul_f32 v213, s100, v213
v_mul_f32 v214, s100, v214
v_mul_f32 v215, s100, v215
Mavvs 236,108,156
CV 56,208,209
CV 57,210,211
CV 58,212,213
Mavvs 240,112,156
CV 59,214,215
buffer_store_dwordx4 v[56:59], v4, s[4:7], s62 offen sc1
Mavvs 244,116,156
s_add_u32 s62, s62, s86
AR 216,56
AR 217,57
Mavvs 248,120,156
AR 218,58
AR 219,59
AR 220,60
AR 221,61
Mavvs 252,124,156
AR 222,62
AR 223,63
v_mul_f32 v216, s100, v216
v_mul_f32 v217, s100, v217
v_mul_f32 v218, s100, v218
v_mul_f32 v219, s100, v219
v_mul_f32 v220, s100, v220
v_mul_f32 v221, s100, v221
v_mul_f32 v222, s100, v222
v_mul_f32_e64 v223, s100, v223
CV 60,216,217
CV 61,218,219
CV 62,220,221
CV 63,222,223
buffer_store_dwordx4 v[60:63], v4, s[4:7], s62 offen sc1
AJ_6:
s_cmp_lg_u32 s99, 0
s_cbranch_scc1 OD_21
s_nop 7
s_nop 0
AR 208,64
AR 209,65
AR 210,66
AR 211,67
AR 212,68
AR 213,69
AR 214,70
AR 215,71
v_mul_f32 v208, s100, v208
v_mul_f32 v209, s100, v209
v_mul_f32 v210, s100, v210
v_mul_f32 v211, s100, v211
v_mul_f32 v212, s100, v212
v_mul_f32 v213, s100, v213
v_mul_f32 v214, s100, v214
v_mul_f32 v215, s100, v215
CV 64,208,209
CV 65,210,211
CV 66,212,213
CV 67,214,215
s_add_u32 s62, s62, s89
s_nop 0
buffer_store_dwordx4 v[64:67], v4, s[4:7], s62 offen sc1
AR 216,72
AR 217,73
AR 218,74
AR 219,75
AR 220,76
AR 221,77
AR 222,78
AR 223,79
v_mul_f32 v216, s100, v216
v_mul_f32 v217, s100, v217
v_mul_f32 v218, s100, v218
v_mul_f32 v219, s100, v219
v_mul_f32 v220, s100, v220
v_mul_f32 v221, s100, v221
v_mul_f32 v222, s100, v222
v_mul_f32 v223, s100, v223
CV 68,216,217
CV 69,218,219
CV 70,220,221
CV 71,222,223
s_add_u32 s62, s62, s86
s_nop 0
buffer_store_dwordx4 v[68:71], v4, s[4:7], s62 offen sc1
AR 208,80
AR 209,81
AR 210,82
AR 211,83
AR 212,84
AR 213,85
AR 214,86
AR 215,87
v_mul_f32 v208, s100, v208
v_mul_f32 v209, s100, v209
v_mul_f32 v210, s100, v210
v_mul_f32 v211, s100, v211
v_mul_f32 v212, s100, v212
v_mul_f32 v213, s100, v213
v_mul_f32 v214, s100, v214
v_mul_f32 v215, s100, v215
CV 72,208,209
CV 73,210,211
CV 74,212,213
CV 75,214,215
s_add_u32 s62, s62, s87
s_nop 0
buffer_store_dwordx4 v[72:75], v4, s[4:7], s62 offen sc1
AR 216,88
AR 217,89
AR 218,90
AR 219,91
AR 220,92
AR 221,93
AR 222,94
AR 223,95
v_mul_f32 v216, s100, v216
v_mul_f32 v217, s100, v217
v_mul_f32 v218, s100, v218
v_mul_f32 v219, s100, v219
v_mul_f32 v220, s100, v220
v_mul_f32 v221, s100, v221
v_mul_f32 v222, s100, v222
v_mul_f32 v223, s100, v223
CV 76,216,217
CV 77,218,219
CV 78,220,221
CV 79,222,223
s_add_u32 s62, s62, s86
s_nop 0
buffer_store_dwordx4 v[76:79], v4, s[4:7], s62 offen sc1
AR 208,96
AR 209,97
AR 210,98
AR 211,99
AR 212,100
AR 213,101
AR 214,102
AR 215,103
v_mul_f32 v208, s100, v208
v_mul_f32 v209, s100, v209
v_mul_f32 v210, s100, v210
v_mul_f32 v211, s100, v211
v_mul_f32 v212, s100, v212
v_mul_f32 v213, s100, v213
v_mul_f32 v214, s100, v214
v_mul_f32 v215, s100, v215
CV 80,208,209
CV 81,210,211
CV 82,212,213
CV 83,214,215
s_add_u32 s62, s62, s88
s_nop 0
buffer_store_dwordx4 v[80:83], v4, s[4:7], s62 offen sc1
AR 216,104
AR 217,105
AR 218,106
AR 219,107
AR 220,108
AR 221,109
AR 222,110
AR 223,111
v_mul_f32 v216, s100, v216
v_mul_f32 v217, s100, v217
v_mul_f32 v218, s100, v218
v_mul_f32 v219, s100, v219
v_mul_f32 v220, s100, v220
v_mul_f32 v221, s100, v221
v_mul_f32 v222, s100, v222
v_mul_f32 v223, s100, v223
CV 84,216,217
CV 85,218,219
CV 86,220,221
CV 87,222,223
s_add_u32 s62, s62, s86
s_nop 0
buffer_store_dwordx4 v[84:87], v4, s[4:7], s62 offen sc1
AR 208,112
AR 209,113
AR 210,114
AR 211,115
AR 212,116
AR 213,117
AR 214,118
AR 215,119
v_mul_f32 v208, s100, v208
v_mul_f32 v209, s100, v209
v_mul_f32 v210, s100, v210
v_mul_f32 v211, s100, v211
v_mul_f32 v212, s100, v212
v_mul_f32 v213, s100, v213
v_mul_f32 v214, s100, v214
v_mul_f32 v215, s100, v215
CV 88,208,209
CV 89,210,211
CV 90,212,213
CV 91,214,215
AR 216,120
AR 217,121
AR 218,122
AR 219,123
AR 220,124
AR 221,125
AR 222,126
AR 223,127
v_mul_f32 v216, s100, v216
v_mul_f32 v217, s100, v217
v_mul_f32 v218, s100, v218
v_mul_f32 v219, s100, v219
v_mul_f32 v220, s100, v220
v_mul_f32 v221, s100, v221
v_mul_f32 v222, s100, v222
v_mul_f32 v223, s100, v223
CV 92,216,217
CV 93,218,219
CV 94,220,221
CV 95,222,223
s_waitcnt vmcnt(38)
s_barrier
RT 192,240,0
RT 194,240,2048
RT 196,241,0
RT 198,241,2048
RT 200,242,0
RT 202,242,2048
RT 204,243,0
RT 206,243,2048
RT 208,244,0
RT 210,244,2048
RT 212,245,0
RT 214,245,2048
LW 8
Mavvz 0,192,160
RT 216,246,0
s_add_u32 s75, s71, 4096
Mavvz 4,192,164
RT 218,246,2048
AR 16,128
Mavvz 8,196,160
RT 220,247,0
AR 17,129
AR 18,130
Mavvz 12,196,164
LW 7
RT 222,247,2048
AR 19,131
AR 20,132
AR 21,133
AR 22,134
AR 23,135
v_mul_f32_e64 v16, s100, v16
Mavvz 16,200,160
buffer_load_dwordx4 v[32:35], v10, s[4:7], s75 offen offset:0 sc1
Mavvz 20,200,164
RT 192,240,256
RT 194,240,2304
Mavvz 24,204,160
RT 196,241,256
v_mul_f32 v17, s100, v17
v_mul_f32 v18, s100, v18
v_mul_f32 v19, s100, v19
v_mul_f32 v20, s100, v20
Mavvz 28,204,164
LW 7
RT 198,241,2304
v_mul_f32 v21, s100, v21
v_mul_f32 v22, s100, v22
v_mul_f32 v23, s100, v23
CV 96,16,17
CV 97,18,19
CV 98,20,21
CV 99,22,23
AR 16,136
AR 17,137
AR 18,138
AR 19,139
AR 20,140
AR 21,141
Mavvz 32,208,160
buffer_load_dwordx4 v[36:39], v11, s[4:7], s75 offen offset:0 sc1
Mavvz 36,208,164
RT 200,242,256
RT 202,242,2304
Mavvz 40,212,160
RT 204,243,256
AR 22,142
AR 23,143
v_mul_f32 v16, s100, v16
v_mul_f32 v17, s100, v17
Mavvz 44,212,164
LW 7
RT 206,243,2304
v_mul_f32 v18, s100, v18
v_mul_f32 v19, s100, v19
v_mul_f32 v20, s100, v20
v_mul_f32 v21, s100, v21
v_mul_f32 v22, s100, v22
v_mul_f32_e64 v23, s100, v23
CV 100,16,17
CV 101,18,19
CV 102,20,21
CV 103,22,23
AR 16,144
AR 17,145
AR 18,146
AR 19,147
AR 20,148
AR 21,149
AR 22,150
AR 23,151
Mavvz 48,216,160
buffer_load_dwordx4 v[40:43], v10, s[4:7], s75 offen offset:1024 sc1
Mavvz 52,216,164
RT 208,244,256
RT 210,244,2304
Mavvz 56,220,160
RT 212,245,256
buffer_load_dwordx4 v[44:47], v11, s[4:7], s75 offen offset:1024 sc1
Mavvz 60,220,164
LW 7
RT 214,245,2304
v_mul_f32 v16, s100, v16
v_mul_f32 v17, s100, v17
v_mul_f32 v18, s100, v18
v_mul_f32_e64 v19, s100, v19
Mavvz 64,192,160
RT 216,246,256
s_add_u32 m0, s52, 49152
v_mul_f32 v20, s100, v20
v_mul_f32 v21, s100, v21
v_mul_f32 v22, s100, v22
v_mul_f32 v23, s100, v23
CV 104,16,17
CV 105,18,19
CV 106,20,21
CV 107,22,23
Mavvz 68,192,164
s_waitcnt vmcnt(24)
s_barrier
RT 218,246,2304
Mavvz 72,196,160
RT 220,247,256
s_mov_b32 s74, 786432
AR 16,152
AR 17,153
AR 18,154
AR 19,155
AR 20,156
Mavvz 76,196,164
LW 7
RT 222,247,2304
AR 21,157
AR 22,158
AR 23,159
v_mul_f32 v16, s100, v16
v_mul_f32 v17, s100, v17
v_mul_f32 v18, s100, v18
v_mul_f32 v19, s100, v19
v_mul_f32 v20, s100, v20
v_mul_f32 v21, s100, v21
v_mul_f32 v22, s100, v22
v_mul_f32_e64 v23, s100, v23
CV 108,16,17
CV 109,18,19
Mavvz 80,200,160
buffer_load_dwordx4 v12, s[16:19], s74 offen lds
Mavvz 84,200,164
RT 192,240,16384
RT 194,240,18432
Mavvz 88,204,160
RT 196,241,16384
CV 110,20,21
CV 111,22,23
AR 16,160
AR 17,161
Mavvz 92,204,164
LW 7
s_nop 0
RT 198,241,18432
AR 18,162
AR 19,163
AR 20,164
AR 21,165
AR 22,166
AR 23,167
v_mul_f32 v16, s100, v16
v_mul_f32 v17, s100, v17
v_mul_f32 v18, s100, v18
v_mul_f32 v19, s100, v19
v_mul_f32 v20, s100, v20
v_mul_f32 v21, s100, v21
v_mul_f32_e64 v22, s100, v22
Mavvz 96,208,160
buffer_load_dwordx4 v13, s[16:19], s74 offen offset:1024 lds
Mavvz 100,208,164
RT 200,242,16384
RT 202,242,18432
Mavvz 104,212,160
RT 204,243,16384
v_mul_f32_e64 v23, s100, v23
CV 112,16,17
CV 113,18,19
CV 114,20,21
Mavvz 108,212,164
LW 7
s_nop 0
RT 206,243,18432
CV 115,22,23
AR 16,168
AR 17,169
AR 18,170
AR 19,171
AR 20,172
AR 21,173
AR 22,174
AR 23,175
v_mul_f32 v16, s100, v16
v_mul_f32 v17, s100, v17
v_mul_f32 v18, s100, v18
v_mul_f32 v19, s100, v19
Mavvz 112,216,160
buffer_load_dwordx4 v14, s[16:19], s74 offen offset:2048 lds
Mavvz 116,216,164
RT 208,244,16384
RT 210,244,18432
Mavvz 120,220,160
RT 212,245,16384
v_mul_f32 v20, s100, v20
v_mul_f32 v21, s100, v21
v_mul_f32 v22, s100, v22
v_mul_f32 v23, s100, v23
Mavvz 124,220,164
LW 7
s_nop 0
RT 214,245,18432
CV 116,16,17
CV 117,18,19
CV 118,20,21
CV 119,22,23
AR 16,176
AR 17,177
AR 18,178
AR 19,179
AR 20,180
AR 21,181
AR 22,182
AR 23,183
v_mul_f32_e64 v16, s100, v16
Mavvs 0,192,168
buffer_load_dwordx4 v15, s[16:19], s74 offen offset:3072 lds
Mavvs 4,192,172
RT 216,246,16384
RT 218,246,18432
Mavvs 8,196,168
RT 220,247,16384
s_add_u32 m0, s53, 122880
v_mul_f32 v17, s100, v17
v_mul_f32 v18, s100, v18
v_mul_f32 v19, s100, v19
v_mul_f32 v20, s100, v20
Mavvs 12,196,172
LW 7
RT 222,247,18432
v_mul_f32 v21, s100, v21
v_mul_f32 v22, s100, v22
v_mul_f32 v23, s100, v23
CV 120,16,17
CV 121,18,19
Mavvs 16,200,168
RT 192,240,16640
s_mov_b32 s74, 344064
s_add_u32 s62, s62, s87
s_nop 0
buffer_store_dwordx4 v[88:91], v4, s[4:7], s62 offen sc1
CV 122,20,21
CV 123,22,23
AR 16,184
AR 17,185
AR 18,186
AR 19,187
AR 20,188
AR 21,189
Mavvs 20,200,172
RT 194,240,18688
buffer_load_dwordx4 v28, s[20:23], s74 offen lds
Mavvs 24,204,168
RT 196,241,16640
AR 22,190
AR 23,191
v_mul_f32 v16, s100, v16
v_mul_f32 v17, s100, v17
Mavvs 28,204,172
LW 7
RT 198,241,18688
s_add_u32 s62, s62, s86
v_mul_f32 v18, s100, v18
v_mul_f32 v19, s100, v19
v_mul_f32 v20, s100, v20
v_mul_f32 v21, s100, v21
v_mul_f32 v22, s100, v22
v_mul_f32 v23, s100, v23
CV 124,16,17
CV 125,18,19
CV 126,20,21
CV 127,22,23
s_waitcnt vmcnt(40)
v_lshlrev_b32 v2, 16, v224
v_and_b32 v3, 0xffff0000, v224
Mavvs 32,208,168
buffer_load_dwordx4 v29, s[20:23], s74 offen offset:1024 lds
Mavvs 36,208,172
RT 200,242,16640
RT 202,242,18688
buffer_store_dwordx4 v[92:95], v4, s[4:7], s62 offen sc1
Mavvs 40,212,168
RT 204,243,16640
AW 128,v2
AW 129,v3
AW 132,v2
AW 133,v3
v_lshlrev_b32_e64 v2, 16, v225
Mavvs 44,212,172
LW 7
RT 206,243,18688
v_and_b32 v3, 0xffff0000, v225
AW 130,v2
AW 131,v3
AW 134,v2
Mavvs 48,216,168
RT 208,244,16640
AW 135,v3
v_lshlrev_b32 v2, 16, v226
v_and_b32 v3, 0xffff0000, v226
AW 136,v2
Mavvs 52,216,172
RT 210,244,18688
s_add_u32 s62, s62, s89
AW 137,v3
AW 140,v2
AW 141,v3
v_lshlrev_b32 v2, 16, v227
Mavvs 56,220,168
RT 212,245,16640
v_and_b32 v3, 0xffff0000, v227
AW 138,v2
AW 139,v3
AW 142,v2
AW 143,v3
Mavvs 60,220,172
LW 7
RT 214,245,18688
buffer_store_dwordx4 v[96:99], v4, s[4:7], s62 offen sc1
v_lshlrev_b32 v2, 16, v228
v_and_b32 v3, 0xffff0000, v228
AW 144,v2
AW 145,v3
Mavvs 64,192,168
RT 216,246,16640
AW 148,v2
AW 149,v3
v_lshlrev_b32_e64 v2, 16, v229
v_and_b32 v3, 0xffff0000, v229
Mavvs 68,192,172
RT 218,246,18688
AW 146,v2
AW 147,v3
AW 150,v2
AW 151,v3
v_lshlrev_b32_e64 v2, 16, v230
Mavvs 72,196,168
RT 220,247,16640
v_and_b32 v3, 0xffff0000, v230
AW 152,v2
AW 153,v3
AW 156,v2
Mavvs 76,196,172
LW 7
RT 222,247,18688
s_add_u32 s62, s62, s86
AW 157,v3
v_lshlrev_b32_e64 v2, 16, v231
v_and_b32 v3, 0xffff0000, v231
AW 154,v2
Mavvs 80,200,168
RT 192,248,0
buffer_store_dwordx4 v[100:103], v4, s[4:7], s62 offen sc1
AW 155,v3
AW 158,v2
AW 159,v3
v_lshlrev_b32_e64 v2, 16, v232
Mavvs 84,200,172
RT 194,248,1024
v_and_b32 v3, 0xffff0000, v232
AW 160,v2
AW 161,v3
AW 164,v2
AW 165,v3
Mavvs 88,204,168
RT 196,249,0
v_lshlrev_b32_e64 v2, 16, v233
v_and_b32 v3, 0xffff0000, v233
AW 162,v2
AW 163,v3
Mavvs 92,204,172
LW 7
RT 198,249,1024
AW 166,v2
AW 167,v3
v_lshlrev_b32 v2, 16, v234
v_and_b32 v3, 0xffff0000, v234
Mavvs 96,208,168
RT 200,250,0
AW 168,v2
AW 169,v3
AW 172,v2
AW 173,v3
v_lshlrev_b32_e64 v2, 16, v235
Mavvs 100,208,172
RT 202,250,1024
v_and_b32 v3, 0xffff0000, v235
AW 170,v2
AW 171,v3
AW 174,v2
Mavvs 104,212,168
RT 204,251,0
AW 175,v3
v_lshlrev_b32_e64 v2, 16, v236
v_and_b32 v3, 0xffff0000, v236
AW 176,v2
Mavvs 108,212,172
LW 7
s_nop 0
RT 206,251,1024
AW 177,v3
AW 180,v2
AW 181,v3
v_lshlrev_b32_e64 v2, 16, v237
v_and_b32 v3, 0xffff0000, v237
AW 178,v2
AW 179,v3
AW 182,v2
AW 183,v3
v_lshlrev_b32_e64 v2, 16, v238
v_and_b32 v3, 0xffff0000, v238
AW 184,v2
AW 185,v3
AW 188,v2
AW 189,v3
v_lshlrev_b32_e64 v2, 16, v239
v_and_b32 v3, 0xffff0000, v239
AW 186,v2
AW 187,v3
AW 190,v2
AW 191,v3
Mavvs 112,216,168
RT 208,252,0
s_add_u32 s62, s62, s87
Mavvs 116,216,172
RT 210,252,1024
Mavvs 120,220,168
RT 212,253,0
Mavvs 124,220,172
LW 7
RT 214,253,1024
Mavvs 128,192,160
buffer_store_dwordx4 v[104:107], v4, s[4:7], s62 offen sc1
Mavvs 132,192,164
RT 216,254,0
RT 218,254,1024
Mavvs 136,196,160
RT 220,255,0
s_add_u32 s62, s62, s86
Mavvs 140,196,164
LW 7
RT 222,255,1024
Mavvs 144,200,160
buffer_store_dwordx4 v[108:111], v4, s[4:7], s62 offen sc1
Mavvs 148,200,164
RT 192,248,8192
RT 194,248,9216
Mavvs 152,204,160
RT 196,249,8192
s_add_u32 s62, s62, s88
Mavvs 156,204,164
LW 7
RT 198,249,9216
Mavvs 160,208,160
buffer_store_dwordx4 v[112:115], v4, s[4:7], s62 offen sc1
Mavvs 164,208,164
RT 200,250,8192
RT 202,250,9216
Mavvs 168,212,160
RT 204,251,8192
s_add_u32 s62, s62, s86
Mavvs 172,212,164
LW 7
RT 206,251,9216
Mavvs 176,216,160
buffer_store_dwordx4 v[116:119], v4, s[4:7], s62 offen sc1
Mavvs 180,216,164
RT 208,252,8192
RT 210,252,9216
Mavvs 184,220,160
RT 212,253,8192
Mavvs 188,220,164
LW 7
RT 214,253,9216
Mavvs 128,192,168
RT 216,254,8192
s_add_u32 s62, s62, s87
Mavvs 132,192,172
s_waitcnt vmcnt(32)
s_barrier
RT 218,254,9216
Mavvs 136,196,168
RT 220,255,8192
s_add_u32 m0, s52, 0
Mavvs 140,196,172
LW 7
RT 222,255,9216
Mavvs 144,200,168
RT 192,240,32768
s_mov_b32 s74, 1048576
Mavvs 148,200,172
RT 194,240,34816
buffer_store_dwordx4 v[120:123], v4, s[4:7], s62 offen sc1
Mavvs 152,204,168
RT 196,241,32768
s_add_u32 s62, s62, s86
Mavvs 156,204,172
LW 7
RT 198,241,34816
Mavvs 160,208,168
buffer_load_dwordx4 v12, s[16:19], s74 offen lds
Mavvs 164,208,172
RT 200,242,32768
RT 202,242,34816
Mavvs 168,212,168
RT 204,243,32768
buffer_store_dwordx4 v[124:127], v4, s[4:7], s62 offen sc1
Mavvs 172,212,172
LW 7
RT 206,243,34816
Mavvs 176,216,168
buffer_load_dwordx4 v13, s[16:19], s74 offen offset:1024 lds
Mavvs 180,216,172
RT 208,244,32768
RT 210,244,34816
Mavvs 184,220,168
RT 212,245,32768
s_add_u32 s62, s62, s89
Mavvs 188,220,172
LW 7
RT 214,245,34816
Mavvs 0,192,176
buffer_load_dwordx4 v14, s[16:19], s74 offen offset:2048 lds
Mavvs 4,192,180
RT 216,246,32768
RT 218,246,34816
Mavvs 8,196,176
RT 220,247,32768
AR 16,192
Mavvs 12,196,180
LW 7
RT 222,247,34816
Mavvs 16,200,176
RT 192,240,33024
AR 17,193
Mavvs 20,200,180
RT 194,240,35072
AR 18,194
Mavvs 24,204,176
RT 196,241,33024
AR 19,195
AR 20,196
Mavvs 28,204,180
LW 7
RT 198,241,35072
Mavvs 32,208,176
buffer_load_dwordx4 v15, s[16:19], s74 offen offset:3072 lds
Mavvs 36,208,180
RT 200,242,33024
RT 202,242,35072
Mavvs 40,212,176
RT 204,243,33024
AR 21,197
Mavvs 44,212,180
LW 7
RT 206,243,35072
Mavvs 48,216,176
RT 208,244,33024
AR 22,198
AR 23,199
Mavvs 52,216,180
RT 210,244,35072
s_add_u32 m0, s53, 131072
Mavvs 56,220,176
RT 212,245,33024
v_mul_f32 v16, s100, v16
v_mul_f32 v17, s100, v17
Mavvs 60,220,180
LW 7
RT 214,245,35072
Mavvs 64,192,176
RT 216,246,33024
s_mov_b32 s74, 458752
Mavvs 68,192,180
RT 218,246,35072
v_mul_f32 v18, s100, v18
Mavvs 72,196,176
RT 220,247,33024
v_mul_f32 v19, s100, v19
v_mul_f32 v20, s100, v20
Mavvs 76,196,180
LW 7
RT 222,247,35072
Mavvs 80,200,176
buffer_load_dwordx4 v28, s[20:23], s74 offen lds
Mavvs 84,200,180
RT 192,248,16384
RT 194,248,17408
Mavvs 88,204,176
RT 196,249,16384
v_mul_f32 v21, s100, v21
v_mul_f32_e64 v22, s100, v22
Mavvs 92,204,180
LW 7
RT 198,249,17408
v_mul_f32 v23, s100, v23
Mavvs 96,208,176
buffer_load_dwordx4 v29, s[20:23], s74 offen offset:1024 lds
Mavvs 100,208,180
RT 200,250,16384
RT 202,250,17408
Mavvs 104,212,176
RT 204,251,16384
CV 128,16,17
Mavvs 108,212,180
LW 7
RT 206,251,17408
Mavvs 112,216,176
RT 208,252,16384
CV 129,18,19
Mavvs 116,216,180
RT 210,252,17408
CV 130,20,21
Mavvs 120,220,176
RT 212,253,16384
CV 131,22,23
Mavvs 124,220,180
LW 7
RT 214,253,17408
Mavvs 128,192,176
RT 216,254,16384
buffer_store_dwordx4 v[128:131], v4, s[4:7], s62 offen sc1
Mavvs 132,192,180
s_waitcnt vmcnt(16)
s_barrier
RT 218,254,17408
Mavvs 136,196,176
RT 220,255,16384
s_add_u32 s75, s71, 6144
s_add_u32 s62, s62, s86
Mavvs 140,196,180
LW 7
RT 222,255,17408
Mavvs 144,200,176
buffer_load_dwordx4 v[48:51], v10, s[4:7], s75 offen offset:0 sc1
Mavvs 148,200,180
RT 192,240,49152
RT 194,240,51200
Mavvs 152,204,176
RT 196,241,49152
AR 16,200
AR 17,201
Mavvs 156,204,180
LW 7
RT 198,241,51200
AR 18,202
Mavvs 160,208,176
buffer_load_dwordx4 v[52:55], v11, s[4:7], s75 offen offset:0 sc1
Mavvs 164,208,180
RT 200,242,49152
RT 202,242,51200
Mavvs 168,212,176
RT 204,243,49152
AR 19,203
AR 20,204
Mavvs 172,212,180
LW 7
RT 206,243,51200
AR 21,205
Mavvs 176,216,176
buffer_load_dwordx4 v[56:59], v10, s[4:7], s75 offen offset:1024 sc1
Mavvs 180,216,180
RT 208,244,49152
RT 210,244,51200
Mavvs 184,220,176
RT 212,245,49152
AR 22,206
AR 23,207
Mavvs 188,220,180
LW 7
RT 214,245,51200
v_mul_f32 v16, s100, v16
Mavvs 0,192,184
buffer_load_dwordx4 v[60:63], v11, s[4:7], s75 offen offset:1024 sc1
Mavvs 4,192,188
RT 216,246,49152
RT 218,246,51200
Mavvs 8,196,184
RT 220,247,49152
s_add_u32 m0, s52, 16384
v_mul_f32_e64 v17, s100, v17
Mavvs 12,196,188
LW 7
RT 222,247,51200
v_mul_f32 v18, s100, v18
Mavvs 16,200,184
RT 192,240,49408
s_mov_b32 s74, 1310720
Mavvs 20,200,188
RT 194,240,51456
v_mul_f32_e64 v19, s100, v19
Mavvs 24,204,184
RT 196,241,49408
v_mul_f32 v20, s100, v20
v_mul_f32 v21, s100, v21
Mavvs 28,204,188
LW 7
RT 198,241,51456
Mavvs 32,208,184
buffer_load_dwordx4 v12, s[16:19], s74 offen lds
Mavvs 36,208,188
RT 200,242,49408
RT 202,242,51456
Mavvs 40,212,184
RT 204,243,49408
v_mul_f32 v22, s100, v22
v_mul_f32_e64 v23, s100, v23
Mavvs 44,212,188
LW 7
RT 206,243,51456
CV 132,16,17
Mavvs 48,216,184
buffer_load_dwordx4 v13, s[16:19], s74 offen offset:1024 lds
Mavvs 52,216,188
RT 208,244,49408
RT 210,244,51456
Mavvs 56,220,184
RT 212,245,49408
CV 133,18,19
CV 134,20,21
Mavvs 60,220,188
LW 7
RT 214,245,51456
CV 135,22,23
Mavvs 64,192,184
buffer_load_dwordx4 v14, s[16:19], s74 offen offset:2048 lds
Mavvs 68,192,188
RT 216,246,49408
RT 218,246,51456
Mavvs 72,196,184
RT 220,247,49408
buffer_store_dwordx4 v[132:135], v4, s[4:7], s62 offen sc1
Mavvs 76,196,188
LW 7
RT 222,247,51456
s_add_u32 s62, s62, s87
Mavvs 80,200,184
buffer_load_dwordx4 v15, s[16:19], s74 offen offset:3072 lds
Mavvs 84,200,188
RT 192,248,24576
RT 194,248,25600
Mavvs 88,204,184
RT 196,249,24576
s_add_u32 m0, s53, 139264
AR 16,208
Mavvs 92,204,188
LW 7
RT 198,249,25600
Mavvs 96,208,184
RT 200,250,24576
s_mov_b32 s74, 573440
Mavvs 100,208,188
RT 202,250,25600
AR 17,209
Mavvs 104,212,184
RT 204,251,24576
AR 18,210
AR 19,211
Mavvs 108,212,188
LW 7
RT 206,251,25600
AR 20,212
Mavvs 112,216,184
buffer_load_dwordx4 v28, s[20:23], s74 offen lds
Mavvs 116,216,188
RT 208,252,24576
RT 210,252,25600
Mavvs 120,220,184
RT 212,253,24576
buffer_load_dwordx4 v29, s[20:23], s74 offen offset:1024 lds
Mavvs 124,220,188
LW 7
RT 214,253,25600
Mavvs 128,192,184
RT 216,254,24576
AR 21,213
AR 22,214
Mavvs 132,192,188
s_waitcnt vmcnt(12)
s_barrier
RT 218,254,25600
Mavvs 136,196,184
RT 220,255,24576
s_add_u32 m0, s52, 32768
AR 23,215
Mavvs 140,196,188
LW 7
RT 222,255,25600
v_mul_f32_e64 v16, s100, v16
Mavvs 144,200,184
RT 192,240,0
s_mov_b32 s74, 1572864
Mavvs 148,200,188
RT 194,240,2048
v_mul_f32_e64 v17, s100, v17
Mavvs 152,204,184
RT 196,241,0
v_mul_f32 v18, s100, v18
v_mul_f32 v19, s100, v19
Mavvs 156,204,188
LW 7
RT 198,241,2048
Mavvs 160,208,184
buffer_load_dwordx4 v12, s[16:19], s74 offen lds
Mavvs 164,208,188
RT 200,242,0
RT 202,242,2048
Mavvs 168,212,184
RT 204,243,0
v_mul_f32 v20, s100, v20
v_mul_f32_e64 v21, s100, v21
Mavvs 172,212,188
LW 7
RT 206,243,2048
v_mul_f32 v22, s100, v22
Mavvs 176,216,184
buffer_load_dwordx4 v13, s[16:19], s74 offen offset:1024 lds
Mavvs 180,216,188
RT 208,244,0
RT 210,244,2048
Mavvs 184,220,184
RT 212,245,0
v_mul_f32_e64 v23, s100, v23
CV 136,16,17
Mavvs 188,220,188
LW 7
RT 214,245,2048
CV 137,18,19
Mavvs 0,192,32
buffer_load_dwordx4 v14, s[16:19], s74 offen offset:2048 lds
Mavvs 4,192,36
RT 216,246,0
RT 218,246,2048
Mavvs 8,196,32
RT 220,247,0
CV 138,20,21
Mavvs 12,196,36
LW 7
RT 222,247,2048
Mavvs 16,200,32
RT 192,240,256
CV 139,22,23
Mavvs 20,200,36
RT 194,240,2304
buffer_store_dwordx4 v[136:139], v4, s[4:7], s62 offen sc1
Mavvs 24,204,32
RT 196,241,256
s_add_u32 s62, s62, s86
Mavvs 28,204,36
LW 7
RT 198,241,2304
Mavvs 32,208,32
buffer_load_dwordx4 v15, s[16:19], s74 offen offset:3072 lds
Mavvs 36,208,36
RT 200,242,256
RT 202,242,2304
Mavvs 40,212,32
RT 204,243,256
AR 16,216
Mavvs 44,212,36
LW 7
RT 206,243,2304
Mavvs 48,216,32
RT 208,244,256
AR 17,217
Mavvs 52,216,36
RT 210,244,2304
s_add_u32 m0, s53, 147456
Mavvs 56,220,32
RT 212,245,256
AR 18,218
AR 19,219
Mavvs 60,220,36
LW 7
RT 214,245,2304
Mavvs 64,192,32
RT 216,246,256
s_mov_b32 s74, 688128
Mavvs 68,192,36
RT 218,246,2304
AR 20,220
Mavvs 72,196,32
RT 220,247,256
AR 21,221
AR 22,222
Mavvs 76,196,36
LW 7
RT 222,247,2304
AR 23,223
Mavvs 80,200,32
buffer_load_dwordx4 v28, s[20:23], s74 offen lds
Mavvs 84,200,36
RT 192,248,32768
RT 194,248,33792
Mavvs 88,204,32
RT 196,249,32768
v_mul_f32 v16, s100, v16
v_mul_f32_e64 v17, s100, v17
Mavvs 92,204,36
LW 7
RT 198,249,33792
Mavvs 96,208,32
buffer_load_dwordx4 v29, s[20:23], s74 offen offset:1024 lds
Mavvs 100,208,36
RT 200,250,32768
RT 202,250,33792
Mavvs 104,212,32
RT 204,251,32768
v_mul_f32 v18, s100, v18
v_mul_f32_e64 v19, s100, v19
Mavvs 108,212,36
LW 7
RT 206,251,33792
Mavvs 112,216,32
RT 208,252,32768
v_mul_f32 v20, s100, v20
Mavvs 116,216,36
RT 210,252,33792
v_mul_f32_e64 v21, s100, v21
Mavvs 120,220,32
RT 212,253,32768
v_mul_f32_e64 v22, s100, v22
Mavvs 124,220,36
LW 7
RT 214,253,33792
Mavvs 128,192,32
RT 216,254,32768
v_mul_f32 v23, s100, v23
CV 140,16,17
Mavvs 132,192,36
s_waitcnt vmcnt(7)
s_barrier
RT 218,254,33792
Mavvs 136,196,32
RT 220,255,32768
s_add_u32 s75, s71, 8192
CV 141,18,19
Mavvs 140,196,36
LW 7
RT 222,255,33792
CV 142,20,21
Mavvs 144,200,32
buffer_load_dwordx4 v[64:67], v10, s[4:7], s75 offen offset:0 sc1
Mavvs 148,200,36
RT 192,240,16384
RT 194,240,18432
Mavvs 152,204,32
RT 196,241,16384
CV 143,22,23
buffer_store_dwordx4 v[140:143], v4, s[4:7], s62 offen sc1
Mavvs 156,204,36
LW 7
RT 198,241,18432
Mavvs 160,208,32
buffer_load_dwordx4 v[68:71], v11, s[4:7], s75 offen offset:0 sc1
Mavvs 164,208,36
RT 200,242,16384
RT 202,242,18432
Mavvs 168,212,32
RT 204,243,16384
s_add_u32 s62, s62, s88
Mavvs 172,212,36
LW 7
RT 206,243,18432
Mavvs 176,216,32
buffer_load_dwordx4 v[72:75], v10, s[4:7], s75 offen offset:1024 sc1
Mavvs 180,216,36
RT 208,244,16384
RT 210,244,18432
Mavvs 184,220,32
RT 212,245,16384
AR 16,224
AR 17,225
Mavvs 188,220,36
LW 7
RT 214,245,18432
AR 18,226
Mavvs 0,192,40
buffer_load_dwordx4 v[76:79], v11, s[4:7], s75 offen offset:1024 sc1
Mavvs 4,192,44
RT 216,246,16384
RT 218,246,18432
Mavvs 8,196,40
RT 220,247,16384
s_add_u32 m0, s52, 49152
AR 19,227
Mavvs 12,196,44
LW 7
RT 222,247,18432
AR 20,228
Mavvs 16,200,40
RT 192,240,16640
s_mov_b32 s74, 1835008
Mavvs 20,200,44
RT 194,240,18688
AR 21,229
Mavvs 24,204,40
RT 196,241,16640
AR 22,230
AR 23,231
Mavvs 28,204,44
LW 7
RT 198,241,18688
Mavvs 32,208,40
buffer_load_dwordx4 v12, s[16:19], s74 offen lds
Mavvs 36,208,44
RT 200,242,16640
RT 202,242,18688
Mavvs 40,212,40
RT 204,243,16640
v_mul_f32 v16, s100, v16
v_mul_f32_e64 v17, s100, v17
Mavvs 44,212,44
LW 7
RT 206,243,18688
v_mul_f32 v18, s100, v18
Mavvs 48,216,40
buffer_load_dwordx4 v13, s[16:19], s74 offen offset:1024 lds
Mavvs 52,216,44
RT 208,244,16640
RT 210,244,18688
Mavvs 56,220,40
RT 212,245,16640
v_mul_f32 v19, s100, v19
v_mul_f32 v20, s100, v20
Mavvs 60,220,44
LW 7
RT 214,245,18688
v_mul_f32 v21, s100, v21
Mavvs 64,192,40
buffer_load_dwordx4 v14, s[16:19], s74 offen offset:2048 lds
Mavvs 68,192,44
RT 216,246,16640
RT 218,246,18688
Mavvs 72,196,40
RT 220,247,16640
v_mul_f32 v22, s100, v22
v_mul_f32 v23, s100, v23
Mavvs 76,196,44
LW 7
RT 222,247,18688
CV 144,16,17
Mavvs 80,200,40
buffer_load_dwordx4 v15, s[16:19], s74 offen offset:3072 lds
Mavvs 84,200,44
RT 192,248,40960
RT 194,248,41984
Mavvs 88,204,40
RT 196,249,40960
s_add_u32 m0, s53, 155648
CV 145,18,19
Mavvs 92,204,44
LW 7
RT 198,249,41984
CV 146,20,21
Mavvs 96,208,40
RT 200,250,40960
s_mov_b32 s74, 802816
Mavvs 100,208,44
RT 202,250,41984
CV 147,22,23
Mavvs 104,212,40
RT 204,251,40960
buffer_store_dwordx4 v[144:147], v4, s[4:7], s62 offen sc1
Mavvs 108,212,44
LW 7
RT 206,251,41984
s_add_u32 s62, s62, s86
Mavvs 112,216,40
buffer_load_dwordx4 v28, s[20:23], s74 offen lds
Mavvs 116,216,44
RT 208,252,40960
RT 210,252,41984
Mavvs 120,220,40
RT 212,253,40960
buffer_load_dwordx4 v29, s[20:23], s74 offen offset:1024 lds
Mavvs 124,220,44
LW 7
RT 214,253,41984
Mavvs 128,192,40
RT 216,254,40960
AR 16,232
AR 17,233
Mavvs 132,192,44
s_waitcnt vmcnt(12)
s_barrier
RT 218,254,41984
Mavvs 136,196,40
RT 220,255,40960
s_add_u32 m0, s52, 0
AR 18,234
Mavvs 140,196,44
LW 7
RT 222,255,41984
Mavvs 144,200,40
RT 192,240,32768
s_mov_b32 s74, 2097152
Mavvs 148,200,44
RT 194,240,34816
AR 19,235
Mavvs 152,204,40
RT 196,241,32768
AR 20,236
AR 21,237
Mavvs 156,204,44
LW 7
RT 198,241,34816
AR 22,238
Mavvs 160,208,40
buffer_load_dwordx4 v12, s[16:19], s74 offen lds
Mavvs 164,208,44
RT 200,242,32768
RT 202,242,34816
Mavvs 168,212,40
RT 204,243,32768
AR 23,239
v_mul_f32_e64 v16, s100, v16
Mavvs 172,212,44
LW 7
RT 206,243,34816
Mavvs 176,216,40
buffer_load_dwordx4 v13, s[16:19], s74 offen offset:1024 lds
Mavvs 180,216,44
RT 208,244,32768
RT 210,244,34816
Mavvs 184,220,40
RT 212,245,32768
v_mul_f32 v17, s100, v17
v_mul_f32_e64 v18, s100, v18
Mavvs 188,220,44
LW 7
RT 214,245,34816
v_mul_f32 v19, s100, v19
Mavvs 0,192,48
buffer_load_dwordx4 v14, s[16:19], s74 offen offset:2048 lds
Mavvs 4,192,52
RT 216,246,32768
RT 218,246,34816
Mavvs 8,196,48
RT 220,247,32768
v_mul_f32_e64 v20, s100, v20
Mavvs 12,196,52
LW 7
RT 222,247,34816
Mavvs 16,200,48
RT 192,240,33024
v_mul_f32 v21, s100, v21
Mavvs 20,200,52
RT 194,240,35072
v_mul_f32_e64 v22, s100, v22
Mavvs 24,204,48
RT 196,241,33024
v_mul_f32_e64 v23, s100, v23
CV 148,16,17
Mavvs 28,204,52
LW 7
RT 198,241,35072
CV 149,18,19
Mavvs 32,208,48
buffer_load_dwordx4 v15, s[16:19], s74 offen offset:3072 lds
Mavvs 36,208,52
RT 200,242,33024
RT 202,242,35072
Mavvs 40,212,48
RT 204,243,33024
CV 150,20,21
Mavvs 44,212,52
LW 7
RT 206,243,35072
Mavvs 48,216,48
RT 208,244,33024
CV 151,22,23
Mavvs 52,216,52
RT 210,244,35072
s_add_u32 m0, s53, 98304
Mavvs 56,220,48
RT 212,245,33024
buffer_store_dwordx4 v[148:151], v4, s[4:7], s62 offen sc1
Mavvs 60,220,52
LW 7
RT 214,245,35072
Mavvs 64,192,48
RT 216,246,33024
s_mov_b32 s74, 917504
Mavvs 68,192,52
RT 218,246,35072
s_add_u32 s62, s62, s87
Mavvs 72,196,48
RT 220,247,33024
AR 16,240
AR 17,241
Mavvs 76,196,52
LW 7
RT 222,247,35072
Mavvs 80,200,48
buffer_load_dwordx4 v28, s[20:23], s74 offen lds
Mavvs 84,200,52
RT 192,248,49152
RT 194,248,50176
Mavvs 88,204,48
RT 196,249,49152
AR 18,242
AR 19,243
Mavvs 92,204,52
LW 7
RT 198,249,50176
AR 20,244
Mavvs 96,208,48
buffer_load_dwordx4 v29, s[20:23], s74 offen offset:1024 lds
Mavvs 100,208,52
RT 200,250,49152
RT 202,250,50176
Mavvs 104,212,48
RT 204,251,49152
AR 21,245
Mavvs 108,212,52
LW 7
RT 206,251,50176
Mavvs 112,216,48
RT 208,252,49152
AR 22,246
Mavvs 116,216,52
RT 210,252,50176
AR 23,247
Mavvs 120,220,48
RT 212,253,49152
v_mul_f32 v16, s100, v16
Mavvs 124,220,52
LW 7
RT 214,253,50176
Mavvs 128,192,48
RT 216,254,49152
v_mul_f32 v17, s100, v17
v_mul_f32_e64 v18, s100, v18
Mavvs 132,192,52
s_waitcnt vmcnt(7)
s_barrier
RT 218,254,50176
Mavvs 136,196,48
RT 220,255,49152
s_add_u32 s75, s71, 10240
v_mul_f32_e64 v19, s100, v19
Mavvs 140,196,52
LW 7
RT 222,255,50176
v_mul_f32 v20, s100, v20
Mavvs 144,200,48
buffer_load_dwordx4 v[80:83], v10, s[4:7], s75 offen offset:0 sc1
Mavvs 148,200,52
RT 192,240,49152
RT 194,240,51200
Mavvs 152,204,48
RT 196,241,49152
v_mul_f32 v21, s100, v21
v_mul_f32 v22, s100, v22
Mavvs 156,204,52
LW 7
RT 198,241,51200
v_mul_f32 v23, s100, v23
Mavvs 160,208,48
buffer_load_dwordx4 v[84:87], v11, s[4:7], s75 offen offset:0 sc1
Mavvs 164,208,52
RT 200,242,49152
RT 202,242,51200
Mavvs 168,212,48
RT 204,243,49152
CV 152,16,17
CV 153,18,19
Mavvs 172,212,52
LW 7
RT 206,243,51200
Mavvs 176,216,48
buffer_load_dwordx4 v[88:91], v10, s[4:7], s75 offen offset:1024 sc1
Mavvs 180,216,52
RT 208,244,49152
RT 210,244,51200
Mavvs 184,220,48
RT 212,245,49152
CV 154,20,21
CV 155,22,23
Mavvs 188,220,52
LW 7
RT 214,245,51200
buffer_store_dwordx4 v[152:155], v4, s[4:7], s62 offen sc1
Mavvs 0,192,56
buffer_load_dwordx4 v[92:95], v11, s[4:7], s75 offen offset:1024 sc1
Mavvs 4,192,60
RT 216,246,49152
RT 218,246,51200
Mavvs 8,196,56
RT 220,247,49152
s_add_u32 m0, s52, 16384
Mavvs 12,196,60
LW 7
RT 222,247,51200
Mavvs 16,200,56
RT 192,240,49408
s_mov_b32 s74, 2359296
Mavvs 20,200,60
RT 194,240,51456
s_add_u32 s62, s62, s86
Mavvs 24,204,56
RT 196,241,49408
AR 16,248
AR 17,249
Mavvs 28,204,60
LW 7
RT 198,241,51456
AR 18,250
Mavvs 32,208,56
buffer_load_dwordx4 v12, s[16:19], s74 offen lds
Mavvs 36,208,60
RT 200,242,49408
RT 202,242,51456
Mavvs 40,212,56
RT 204,243,49408
AR 19,251
AR 20,252
Mavvs 44,212,60
LW 7
RT 206,243,51456
AR 21,253
Mavvs 48,216,56
buffer_load_dwordx4 v13, s[16:19], s74 offen offset:1024 lds
Mavvs 52,216,60
RT 208,244,49408
RT 210,244,51456
Mavvs 56,220,56
RT 212,245,49408
AR 22,254
AR 23,255
Mavvs 60,220,60
LW 7
RT 214,245,51456
Mavvs 64,192,56
buffer_load_dwordx4 v14, s[16:19], s74 offen offset:2048 lds
Mavvs 68,192,60
RT 216,246,49408
RT 218,246,51456
Mavvs 72,196,56
RT 220,247,49408
v_mul_f32 v16, s100, v16
v_mul_f32_e64 v17, s100, v17
Mavvs 76,196,60
LW 7
RT 222,247,51456
v_mul_f32 v18, s100, v18
Mavvs 80,200,56
buffer_load_dwordx4 v15, s[16:19], s74 offen offset:3072 lds
Mavvs 84,200,60
RT 192,248,57344
RT 194,248,58368
Mavvs 88,204,56
RT 196,249,57344
s_add_u32 m0, s53, 106496
v_mul_f32_e64 v19, s100, v19
Mavvs 92,204,60
LW 7
RT 198,249,58368
v_mul_f32 v20, s100, v20
Mavvs 96,208,56
RT 200,250,57344
s_mov_b32 s74, 1032192
Mavvs 100,208,60
RT 202,250,58368
v_mul_f32_e64 v21, s100, v21
Mavvs 104,212,56
RT 204,251,57344
v_mul_f32 v22, s100, v22
v_mul_f32 v23, s100, v23
Mavvs 108,212,60
LW 7
RT 206,251,58368
CV 156,16,17
Mavvs 112,216,56
buffer_load_dwordx4 v28, s[20:23], s74 offen lds
Mavvs 116,216,60
RT 208,252,57344
RT 210,252,58368
Mavvs 120,220,56
RT 212,253,57344
buffer_load_dwordx4 v29, s[20:23], s74 offen offset:1024 lds
Mavvs 124,220,60
LW 7
RT 214,253,58368
CV 157,18,19
Mavvs 128,192,56
RT 216,254,57344
CV 158,20,21
CV 159,22,23
Mavvs 132,192,60
s_waitcnt vmcnt(11)
s_barrier
RT 218,254,58368
Mavvs 136,196,56
RT 220,255,57344
s_add_u32 m0, s52, 32768
buffer_store_dwordx4 v[156:159], v4, s[4:7], s62 offen sc1
Mavvs 140,196,60
LW 7
RT 222,255,58368
Mavvs 144,200,56
RT 192,240,0
s_mov_b32 s74, 2621440
Mavvs 148,200,60
RT 194,240,2048
Mavvs 152,204,56
RT 196,241,0
Mavvs 156,204,60
LW 7
RT 198,241,2048
Mavvs 160,208,56
buffer_load_dwordx4 v12, s[16:19], s74 offen lds
Mavvs 164,208,60
RT 200,242,0
RT 202,242,2048
Mavvs 168,212,56
RT 204,243,0
Mavvs 172,212,60
LW 7
RT 206,243,2048
Mavvs 176,216,56
buffer_load_dwordx4 v13, s[16:19], s74 offen offset:1024 lds
Mavvs 180,216,60
RT 208,244,0
RT 210,244,2048
Mavvs 184,220,56
RT 212,245,0
Mavvs 188,220,60
LW 7
RT 214,245,2048
Mavvs 0,192,64
buffer_load_dwordx4 v14, s[16:19], s74 offen offset:2048 lds
Mavvs 4,192,68
RT 216,246,0
RT 218,246,2048
Mavvs 8,196,64
RT 220,247,0
Mavvs 12,196,68
LW 7
RT 222,247,2048
Mavvs 16,200,64
RT 192,240,256
Mavvs 20,200,68
RT 194,240,2304
Mavvs 24,204,64
RT 196,241,256
Mavvs 28,204,68
LW 7
RT 198,241,2304
Mavvs 32,208,64
buffer_load_dwordx4 v15, s[16:19], s74 offen offset:3072 lds
Mavvs 36,208,68
RT 200,242,256
RT 202,242,2304
Mavvs 40,212,64
RT 204,243,256
Mavvs 44,212,68
LW 7
RT 206,243,2304
Mavvs 48,216,64
RT 208,244,256
Mavvs 52,216,68
RT 210,244,2304
s_add_u32 m0, s53, 114688
Mavvs 56,220,64
RT 212,245,256
Mavvs 60,220,68
LW 7
RT 214,245,2304
Mavvs 64,192,64
RT 216,246,256
s_mov_b32 s74, 1146880
Mavvs 68,192,68
RT 218,246,2304
Mavvs 72,196,64
RT 220,247,256
Mavvs 76,196,68
LW 7
RT 222,247,2304
Mavvs 80,200,64
buffer_load_dwordx4 v28, s[20:23], s74 offen lds
Mavvs 84,200,68
RT 192,248,0
RT 194,248,1024
Mavvs 88,204,64
RT 196,249,0
Mavvs 92,204,68
LW 7
RT 198,249,1024
Mavvs 96,208,64
buffer_load_dwordx4 v29, s[20:23], s74 offen offset:1024 lds
Mavvs 100,208,68
RT 200,250,0
RT 202,250,1024
Mavvs 104,212,64
RT 204,251,0
Mavvs 108,212,68
LW 7
RT 206,251,1024
Mavvs 112,216,64
RT 208,252,0
Mavvs 116,216,68
RT 210,252,1024
Mavvs 120,220,64
RT 212,253,0
Mavvs 124,220,68
LW 7
RT 214,253,1024
Mavvs 128,192,64
RT 216,254,0
Mavvs 132,192,68
s_waitcnt vmcnt(7)
s_barrier
RT 218,254,1024
Mavvs 136,196,64
RT 220,255,0
s_add_u32 s75, s71, 12288
Mavvs 140,196,68
LW 7
RT 222,255,1024
Mavvs 144,200,64
buffer_load_dwordx4 v[96:99], v10, s[4:7], s75 offen offset:0 sc1
Mavvs 148,200,68
RT 192,240,16384
RT 194,240,18432
Mavvs 152,204,64
RT 196,241,16384
Mavvs 156,204,68
LW 7
RT 198,241,18432
Mavvs 160,208,64
buffer_load_dwordx4 v[100:103], v11, s[4:7], s75 offen offset:0 sc1
Mavvs 164,208,68
RT 200,242,16384
RT 202,242,18432
Mavvs 168,212,64
RT 204,243,16384
Mavvs 172,212,68
LW 7
RT 206,243,18432
Mavvs 176,216,64
buffer_load_dwordx4 v[104:107], v10, s[4:7], s75 offen offset:1024 sc1
Mavvs 180,216,68
RT 208,244,16384
RT 210,244,18432
Mavvs 184,220,64
RT 212,245,16384
Mavvs 188,220,68
LW 7
RT 214,245,18432
Mavvs 0,192,72
buffer_load_dwordx4 v[108:111], v11, s[4:7], s75 offen offset:1024 sc1
Mavvs 4,192,76
RT 216,246,16384
RT 218,246,18432
Mavvs 8,196,72
RT 220,247,16384
s_add_u32 m0, s52, 49152
Mavvs 12,196,76
LW 7
RT 222,247,18432
Mavvs 16,200,72
RT 192,240,16640
s_mov_b32 s74, 2883584
Mavvs 20,200,76
RT 194,240,18688
Mavvs 24,204,72
RT 196,241,16640
Mavvs 28,204,76
LW 7
RT 198,241,18688
Mavvs 32,208,72
buffer_load_dwordx4 v12, s[16:19], s74 offen lds
Mavvs 36,208,76
RT 200,242,16640
RT 202,242,18688
Mavvs 40,212,72
RT 204,243,16640
Mavvs 44,212,76
LW 7
RT 206,243,18688
Mavvs 48,216,72
buffer_load_dwordx4 v13, s[16:19], s74 offen offset:1024 lds
Mavvs 52,216,76
RT 208,244,16640
RT 210,244,18688
Mavvs 56,220,72
RT 212,245,16640
Mavvs 60,220,76
LW 7
RT 214,245,18688
Mavvs 64,192,72
buffer_load_dwordx4 v14, s[16:19], s74 offen offset:2048 lds
Mavvs 68,192,76
RT 216,246,16640
RT 218,246,18688
Mavvs 72,196,72
RT 220,247,16640
Mavvs 76,196,76
LW 7
RT 222,247,18688
Mavvs 80,200,72
buffer_load_dwordx4 v15, s[16:19], s74 offen offset:3072 lds
Mavvs 84,200,76
RT 192,248,8192
RT 194,248,9216
Mavvs 88,204,72
RT 196,249,8192
s_add_u32 m0, s53, 122880
Mavvs 92,204,76
LW 7
RT 198,249,9216
Mavvs 96,208,72
RT 200,250,8192
s_mov_b32 s74, 1261568
Mavvs 100,208,76
RT 202,250,9216
Mavvs 104,212,72
RT 204,251,8192
Mavvs 108,212,76
LW 7
RT 206,251,9216
Mavvs 112,216,72
buffer_load_dwordx4 v28, s[20:23], s74 offen lds
Mavvs 116,216,76
RT 208,252,8192
RT 210,252,9216
Mavvs 120,220,72
RT 212,253,8192
buffer_load_dwordx4 v29, s[20:23], s74 offen offset:1024 lds
Mavvs 124,220,76
LW 7
RT 214,253,9216
Mavvs 128,192,72
RT 216,254,8192
Mavvs 132,192,76
s_waitcnt vmcnt(10)
s_barrier
RT 218,254,9216
Mavvs 136,196,72
RT 220,255,8192
s_add_u32 m0, s52, 0
Mavvs 140,196,76
LW 7
RT 222,255,9216
Mavvs 144,200,72
RT 192,240,32768
s_mov_b32 s74, 3145728
Mavvs 148,200,76
RT 194,240,34816
Mavvs 152,204,72
RT 196,241,32768
Mavvs 156,204,76
LW 7
RT 198,241,34816
Mavvs 160,208,72
buffer_load_dwordx4 v12, s[16:19], s74 offen lds
Mavvs 164,208,76
RT 200,242,32768
RT 202,242,34816
Mavvs 168,212,72
RT 204,243,32768
Mavvs 172,212,76
LW 7
RT 206,243,34816
Mavvs 176,216,72
buffer_load_dwordx4 v13, s[16:19], s74 offen offset:1024 lds
Mavvs 180,216,76
RT 208,244,32768
RT 210,244,34816
Mavvs 184,220,72
RT 212,245,32768
Mavvs 188,220,76
LW 7
RT 214,245,34816
Mavvs 0,192,80
buffer_load_dwordx4 v14, s[16:19], s74 offen offset:2048 lds
Mavvs 4,192,84
RT 216,246,32768
RT 218,246,34816
Mavvs 8,196,80
RT 220,247,32768
Mavvs 12,196,84
LW 7
RT 222,247,34816
Mavvs 16,200,80
buffer_load_dwordx4 v15, s[16:19], s74 offen offset:3072 lds
Mavvs 20,200,84
RT 192,240,33024
RT 194,240,35072
Mavvs 24,204,80
RT 196,241,33024
s_add_u32 m0, s53, 131072
Mavvs 28,204,84
LW 7
RT 198,241,35072
Mavvs 32,208,80
RT 200,242,33024
s_mov_b32 s74, 1376256
Mavvs 36,208,84
RT 202,242,35072
buffer_load_dwordx4 v28, s[20:23], s74 offen lds
Mavvs 40,212,80
RT 204,243,33024
Mavvs 44,212,84
LW 7
RT 206,243,35072
Mavvs 48,216,80
buffer_load_dwordx4 v29, s[20:23], s74 offen offset:1024 lds
Mavvs 52,216,84
RT 208,244,33024
RT 210,244,35072
Mavvs 56,220,80
RT 212,245,33024
Mavvs 60,220,84
LW 7
RT 214,245,35072
Mavvs 64,192,80
RT 216,246,33024
Mavvs 68,192,84
s_waitcnt vmcnt(22)
s_waitcnt vmcnt(6)
s_barrier
RT 218,246,35072
Mavvs 72,196,80
RT 220,247,33024
s_add_u32 m0, s52, 16384
Mavvs 76,196,84
LW 7
RT 222,247,35072
Mavvs 80,200,80
RT 192,240,49152
s_mov_b32 s74, 3407872
Mavvs 84,200,84
RT 194,240,51200
s_lshr_b32 s79, s2, 4
Mavvs 88,204,80
RT 196,241,49152
s_lshl_b32 s79, s79, 2
s_add_u32 s79, s79, s65
Mavvs 92,204,84
LW 7
RT 198,241,51200
buffer_store_dword v6, v5, s[4:7], s79 offen sc1
Mavvs 96,208,80
buffer_load_dwordx4 v12, s[16:19], s74 offen lds
Mavvs 100,208,84
RT 200,242,49152
RT 202,242,51200
Mavvs 104,212,80
RT 204,243,49152
Mavvs 108,212,84
LW 7
RT 206,243,51200
Mavvs 112,216,80
buffer_load_dwordx4 v13, s[16:19], s74 offen offset:1024 lds
Mavvs 116,216,84
RT 208,244,49152
RT 210,244,51200
Mavvs 120,220,80
RT 212,245,49152
Mavvs 124,220,84
LW 7
RT 214,245,51200
Mavvs 0,192,88
buffer_load_dwordx4 v14, s[16:19], s74 offen offset:2048 lds
Mavvs 4,192,92
RT 216,246,49152
RT 218,246,51200
Mavvs 8,196,88
RT 220,247,49152
Mavvs 12,196,92
LW 7
RT 222,247,51200
Mavvs 16,200,88
buffer_load_dwordx4 v15, s[16:19], s74 offen offset:3072 lds
Mavvs 20,200,92
RT 192,240,49408
RT 194,240,51456
Mavvs 24,204,88
RT 196,241,49408
s_add_u32 m0, s53, 139264
Mavvs 28,204,92
LW 7
RT 198,241,51456
Mavvs 32,208,88
RT 200,242,49408
s_mov_b32 s74, 1490944
Mavvs 36,208,92
RT 202,242,51456
buffer_load_dwordx4 v28, s[20:23], s74 offen lds
Mavvs 40,212,88
RT 204,243,49408
Mavvs 44,212,92
LW 7
RT 206,243,51456
Mavvs 48,216,88
buffer_load_dwordx4 v29, s[20:23], s74 offen offset:1024 lds
Mavvs 52,216,92
RT 208,244,49408
RT 210,244,51456
Mavvs 56,220,88
RT 212,245,49408
Mavvs 60,220,92
LW 7
RT 214,245,51456
Mavvs 64,192,88
RT 216,246,49408
Mavvs 68,192,92
s_waitcnt vmcnt(7)
s_barrier
RT 218,246,51456
Mavvs 72,196,88
RT 220,247,49408
Mavvs 76,196,92
LW 7
RT 222,247,51456
Mavvs 80,200,88
RT 192,240,0
Mavvs 84,200,92
RT 194,240,2048
Mavvs 88,204,88
RT 196,241,0
Mavvs 92,204,92
LW 7
RT 198,241,2048
Mavvs 96,208,88
RT 200,242,0
Mavvs 100,208,92
RT 202,242,2048
Mavvs 104,212,88
RT 204,243,0
Mavvs 108,212,92
LW 7
RT 206,243,2048
Mavvs 112,216,88
RT 208,244,0
Mavvs 116,216,92
RT 210,244,2048
Mavvs 120,220,88
RT 212,245,0
Mavvs 124,220,92
LW 7
RT 214,245,2048
Mavvs 0,192,96
RT 216,246,0
Mavvs 4,192,100
RT 218,246,2048
Mavvs 8,196,96
RT 220,247,0
Mavvs 12,196,100
LW 7
RT 222,247,2048
Mavvs 16,200,96
RT 192,240,256
Mavvs 20,200,100
RT 194,240,2304
Mavvs 24,204,96
RT 196,241,256
Mavvs 28,204,100
LW 7
RT 198,241,2304
Mavvs 32,208,96
RT 200,242,256
Mavvs 36,208,100
RT 202,242,2304
Mavvs 40,212,96
RT 204,243,256
Mavvs 44,212,100
LW 7
RT 206,243,2304
Mavvs 48,216,96
RT 208,244,256
Mavvs 52,216,100
RT 210,244,2304
Mavvs 56,220,96
RT 212,245,256
Mavvs 60,220,100
LW 7
RT 214,245,2304
Mavvs 64,192,96
RT 216,246,256
Mavvs 68,192,100
s_waitcnt vmcnt(0)
s_barrier
RT 218,246,2304
Mavvs 72,196,96
RT 220,247,256
s_mov_b32 s70, s65
Mavvs 76,196,100
LW 7
RT 222,247,2304
Mavvs 80,200,96
RT 192,240,16384
s_lshl_b32 s80, s54, 16
Mavvs 84,200,100
RT 194,240,18432
s_lshl_b32 s81, s44, 14
Mavvs 88,204,96
RT 196,241,16384
s_add_u32 s80, s80, s81
Mavvs 92,204,100
LW 7
RT 198,241,18432
Mavvs 96,208,96
RT 200,242,16384
s_add_u32 s80, s80, 0x3800000
Mavvs 100,208,100
RT 202,242,18432
s_sub_u32 s68, s50, s51
Mavvs 104,212,96
RT 204,243,16384
s_cmp_eq_u32 s68, 0
s_cselect_b32 s80, 0x70000000, s80
Mavvs 108,212,100
LW 7
RT 206,243,18432
Mavvs 112,216,96
RT 208,244,16384
v_mov_b32_e64 v8, s55
Mavvs 116,216,100
RT 210,244,18432
v_mov_b32_e64 v9, s55
Mavvs 120,220,96
RT 212,245,16384
Mavvs 124,220,100
LW 7
RT 214,245,18432
Mavvs 0,192,104
RT 216,246,16384
Mavvs 4,192,108
RT 218,246,18432
Mavvs 8,196,104
RT 220,247,16384
Mavvs 12,196,108
LW 7
RT 222,247,18432
Mavvs 16,200,104
RT 192,240,16640
Mavvs 20,200,108
RT 194,240,18688
Mavvs 24,204,104
RT 196,241,16640
Mavvs 28,204,108
LW 7
RT 198,241,18688
Mavvs 32,208,104
RT 200,242,16640
Mavvs 36,208,108
RT 202,242,18688
Mavvs 40,212,104
RT 204,243,16640
Mavvs 44,212,108
LW 7
RT 206,243,18688
Mavvs 48,216,104
RT 208,244,16640
Mavvs 52,216,108
RT 210,244,18688
Mavvs 56,220,104
RT 212,245,16640
Mavvs 60,220,108
LW 7
RT 214,245,18688
Mavvs 64,192,104
RT 216,246,16640
AR 224,0
Mavvs 68,192,108
RT 218,246,18688
AR 225,1
Mavvs 72,196,104
RT 220,247,16640
AR 226,2
Mavvs 76,196,108
LW 7
RT 222,247,18688
Mavvs 80,200,104
RT 192,248,16384
AR 227,3
Mavvs 84,200,108
RT 194,248,17408
AR 228,8
Mavvs 88,204,104
RT 196,249,16384
AR 229,9
Mavvs 92,204,108
LW 7
RT 198,249,17408
Mavvs 96,208,104
RT 200,250,16384
AR 230,10
AR 231,11
Mavvs 100,208,108
RT 202,250,17408
v_mul_f32 v224, s55, v224
Mavvs 104,212,104
RT 204,251,16384
v_mul_f32 v225, s55, v225
v_mul_f32 v226, s55, v226
Mavvs 108,212,108
LW 7
RT 206,251,17408
v_mul_f32 v227, s55, v227
Mavvs 112,216,104
RT 208,252,16384
v_mul_f32 v228, s55, v228
v_mul_f32 v229, s55, v229
Mavvs 116,216,108
RT 210,252,17408
v_mul_f32_e64 v230, s55, v230
Mavvs 120,220,104
RT 212,253,16384
v_mul_f32_e64 v231, s55, v231
CV 128,224,225
Mavvs 124,220,108
LW 7
RT 214,253,17408
CV 129,226,227
Mavvs 128,192,80
RT 216,254,16384
CV 130,228,229
Mavvs 132,192,84
RT 218,254,17408
CV 131,230,231
buffer_store_dwordx4 v[128:131], v4, s[4:7], s80 offen offset:0 sc1
Mavvs 136,196,80
RT 220,255,16384
AR 232,4
Mavvs 140,196,84
LW 7
RT 222,255,17408
Mavvs 144,200,80
RT 192,248,24576
AR 233,5
Mavvs 148,200,84
RT 194,248,25600
AR 234,6
AR 235,7
Mavvs 152,204,80
RT 196,249,24576
AR 236,12
AR 237,13
Mavvs 156,204,84
LW 7
RT 198,249,25600
Mavvs 160,208,80
RT 200,250,24576
AR 238,14
AR 239,15
Mavvs 164,208,84
RT 202,250,25600
v_mul_f32 v232, s55, v232
Mavvs 168,212,80
RT 204,251,24576
v_mul_f32 v233, s55, v233
v_mul_f32 v234, s55, v234
Mavvs 172,212,84
LW 7
RT 206,251,25600
v_mul_f32 v235, s55, v235
Mavvs 176,216,80
RT 208,252,24576
v_mul_f32 v236, s55, v236
v_mul_f32 v237, s55, v237
Mavvs 180,216,84
RT 210,252,25600
v_mul_f32_e64 v238, s55, v238
Mavvs 184,220,80
RT 212,253,24576
v_mul_f32_e64 v239, s55, v239
CV 132,232,233
Mavvs 188,220,84
LW 7
RT 214,253,25600
CV 133,234,235
Mavvs 128,192,88
RT 216,254,24576
CV 134,236,237
CV 135,238,239
Mavvs 132,192,92
RT 218,254,25600
buffer_store_dwordx4 v[132:135], v4, s[4:7], s80 offen offset:1024 sc1
Mavvs 136,196,88
RT 220,255,24576
AR 224,16
Mavvs 140,196,92
LW 7
RT 222,255,25600
Mavvs 144,200,88
RT 192,248,32768
AR 225,17
Mavvs 148,200,92
RT 194,248,33792
AR 226,18
AR 227,19
Mavvs 152,204,88
RT 196,249,32768
AR 228,24
AR 229,25
Mavvs 156,204,92
LW 7
RT 198,249,33792
AR 230,26
Mavvs 160,208,88
RT 200,250,32768
AR 231,27
Mavvs 164,208,92
RT 202,250,33792
v_mul_f32 v224, s55, v224
v_mul_f32_e64 v225, s55, v225
Mavvs 168,212,88
RT 204,251,32768
v_mul_f32 v226, s55, v226
v_mul_f32 v227, s55, v227
Mavvs 172,212,92
LW 7
RT 206,251,33792
Mavvs 176,216,88
RT 208,252,32768
v_mul_f32 v228, s55, v228
v_mul_f32_e64 v229, s55, v229
Mavvs 180,216,92
RT 210,252,33792
v_mul_f32_e64 v230, s55, v230
Mavvs 184,220,88
RT 212,253,32768
v_mul_f32_e64 v231, s55, v231
CV 136,224,225
Mavvs 188,220,92
LW 7
RT 214,253,33792
CV 137,226,227
Mavvs 128,192,96
RT 216,254,32768
CV 138,228,229
CV 139,230,231
Mavvs 132,192,100
RT 218,254,33792
buffer_store_dwordx4 v[136:139], v4, s[4:7], s80 offen offset:2048 sc1
Mavvs 136,196,96
RT 220,255,32768
AR 232,20
Mavvs 140,196,100
LW 7
RT 222,255,33792
Mavvs 144,200,96
RT 192,248,40960
AR 233,21
AR 234,22
Mavvs 148,200,100
RT 194,248,41984
AR 235,23
Mavvs 152,204,96
RT 196,249,40960
AR 236,28
AR 237,29
Mavvs 156,204,100
LW 7
RT 198,249,41984
AR 238,30
Mavvs 160,208,96
RT 200,250,40960
AR 239,31
Mavvs 164,208,100
RT 202,250,41984
v_mul_f32 v232, s55, v232
v_mul_f32_e64 v233, s55, v233
Mavvs 168,212,96
RT 204,251,40960
v_mul_f32 v234, s55, v234
v_mul_f32 v235, s55, v235
Mavvs 172,212,100
LW 7
RT 206,251,41984
v_mul_f32 v236, s55, v236
Mavvs 176,216,96
RT 208,252,40960
v_mul_f32_e64 v237, s55, v237
Mavvs 180,216,100
RT 210,252,41984
v_mul_f32 v238, s55, v238
v_mul_f32 v239, s55, v239
Mavvs 184,220,96
RT 212,253,40960
CV 140,232,233
CV 141,234,235
Mavvs 188,220,100
LW 7
RT 214,253,41984
Mavvs 128,192,104
RT 216,254,40960
CV 142,236,237
CV 143,238,239
Mavvs 132,192,108
RT 218,254,41984
buffer_store_dwordx4 v[140:143], v4, s[4:7], s80 offen offset:3072 sc1
Mavvs 136,196,104
RT 220,255,40960
s_add_u32 s80, s80, 4096
Mavvs 140,196,108
LW 7
RT 222,255,41984
Mavvs 144,200,104
AR 224,32
AR 225,33
Mavvs 148,200,108
AR 226,34
AR 227,35
Mavvs 152,204,104
AR 228,40
AR 229,41
Mavvs 156,204,108
LW 4
AR 230,42
AR 231,43
Mavvs 160,208,104
v_mul_f32 v224, s55, v224
v_mul_f32_e64 v225, s55, v225
Mavvs 164,208,108
v_mul_f32 v226, s55, v226
v_mul_f32 v227, s55, v227
Mavvs 168,212,104
v_mul_f32 v228, s55, v228
v_mul_f32 v229, s55, v229
Mavvs 172,212,108
LW 0
v_mul_f32 v230, s55, v230
v_mul_f32_e64 v231, s55, v231
Mavvs 176,216,104
CV 144,224,225
CV 145,226,227
Mavvs 180,216,108
CV 146,228,229
CV 147,230,231
Mavvs 184,220,104
buffer_store_dwordx4 v[144:147], v4, s[4:7], s80 offen offset:0 sc1
Mavvs 188,220,108
s_nop 3
s_nop 0
buffer_load_dword v7, v30, s[4:7], s70 offen sc1
AR 232,36
AR 233,37
AR 234,38
AR 235,39
AR 236,44
AR 237,45
AR 238,46
AR 239,47
v_pk_mul_f32 v[232:233], v[232:233], v[8:9]
v_pk_mul_f32 v[234:235], v[234:235], v[8:9]
v_pk_mul_f32 v[236:237], v[236:237], v[8:9]
v_pk_mul_f32 v[238:239], v[238:239], v[8:9]
CV 148,232,233
CV 149,234,235
CV 150,236,237
CV 151,238,239
buffer_store_dwordx4 v[148:151], v4, s[4:7], s80 offen offset:1024 sc1
AR 224,48
AR 225,49
AR 226,50
AR 227,51
AR 228,56
AR 229,57
AR 230,58
AR 231,59
v_pk_mul_f32 v[224:225], v[224:225], v[8:9]
v_pk_mul_f32 v[226:227], v[226:227], v[8:9]
v_pk_mul_f32 v[228:229], v[228:229], v[8:9]
v_pk_mul_f32 v[230:231], v[230:231], v[8:9]
CV 152,224,225
CV 153,226,227
CV 154,228,229
CV 155,230,231
buffer_store_dwordx4 v[152:155], v4, s[4:7], s80 offen offset:2048 sc1
AR 232,52
AR 233,53
AR 234,54
AR 235,55
AR 236,60
AR 237,61
AR 238,62
AR 239,63
v_pk_mul_f32 v[232:233], v[232:233], v[8:9]
v_pk_mul_f32 v[234:235], v[234:235], v[8:9]
v_pk_mul_f32 v[236:237], v[236:237], v[8:9]
v_pk_mul_f32 v[238:239], v[238:239], v[8:9]
CV 156,232,233
CV 157,234,235
CV 158,236,237
CV 159,238,239
buffer_store_dwordx4 v[156:159], v4, s[4:7], s80 offen offset:3072 sc1
s_add_u32 s80, s80, 4096
AR 224,64
AR 225,65
AR 226,66
AR 227,67
AR 228,72
AR 229,73
AR 230,74
AR 231,75
v_pk_mul_f32 v[224:225], v[224:225], v[8:9]
v_pk_mul_f32 v[226:227], v[226:227], v[8:9]
v_pk_mul_f32 v[228:229], v[228:229], v[8:9]
v_pk_mul_f32 v[230:231], v[230:231], v[8:9]
CV 160,224,225
CV 161,226,227
CV 162,228,229
CV 163,230,231
buffer_store_dwordx4 v[160:163], v4, s[4:7], s80 offen offset:0 sc1
AR 232,68
AR 233,69
AR 234,70
AR 235,71
AR 236,76
AR 237,77
AR 238,78
AR 239,79
v_pk_mul_f32 v[232:233], v[232:233], v[8:9]
v_pk_mul_f32 v[234:235], v[234:235], v[8:9]
v_pk_mul_f32 v[236:237], v[236:237], v[8:9]
v_pk_mul_f32 v[238:239], v[238:239], v[8:9]
CV 164,232,233
CV 165,234,235
CV 166,236,237
CV 167,238,239
buffer_store_dwordx4 v[164:167], v4, s[4:7], s80 offen offset:1024 sc1
AR 224,80
AR 225,81
AR 226,82
AR 227,83
AR 228,88
AR 229,89
AR 230,90
AR 231,91
v_pk_mul_f32 v[224:225], v[224:225], v[8:9]
v_pk_mul_f32 v[226:227], v[226:227], v[8:9]
v_pk_mul_f32 v[228:229], v[228:229], v[8:9]
v_pk_mul_f32 v[230:231], v[230:231], v[8:9]
CV 168,224,225
CV 169,226,227
CV 170,228,229
CV 171,230,231
buffer_store_dwordx4 v[168:171], v4, s[4:7], s80 offen offset:2048 sc1
AR 232,84
AR 233,85
AR 234,86
AR 235,87
AR 236,92
AR 237,93
AR 238,94
AR 239,95
v_pk_mul_f32 v[232:233], v[232:233], v[8:9]
v_pk_mul_f32 v[234:235], v[234:235], v[8:9]
v_pk_mul_f32 v[236:237], v[236:237], v[8:9]
v_pk_mul_f32 v[238:239], v[238:239], v[8:9]
CV 172,232,233
CV 173,234,235
CV 174,236,237
CV 175,238,239
buffer_store_dwordx4 v[172:175], v4, s[4:7], s80 offen offset:3072 sc1
s_add_u32 s80, s80, 4096
AR 224,96
AR 225,97
AR 226,98
AR 227,99
AR 228,104
AR 229,105
AR 230,106
AR 231,107
v_pk_mul_f32 v[224:225], v[224:225], v[8:9]
v_pk_mul_f32 v[226:227], v[226:227], v[8:9]
v_pk_mul_f32 v[228:229], v[228:229], v[8:9]
v_pk_mul_f32 v[230:231], v[230:231], v[8:9]
CV 176,224,225
CV 177,226,227
CV 178,228,229
CV 179,230,231
buffer_store_dwordx4 v[176:179], v4, s[4:7], s80 offen offset:0 sc1
AR 232,100
AR 233,101
AR 234,102
AR 235,103
AR 236,108
AR 237,109
AR 238,110
AR 239,111
v_pk_mul_f32 v[232:233], v[232:233], v[8:9]
v_pk_mul_f32 v[234:235], v[234:235], v[8:9]
v_pk_mul_f32 v[236:237], v[236:237], v[8:9]
v_pk_mul_f32 v[238:239], v[238:239], v[8:9]
CV 180,232,233
CV 181,234,235
CV 182,236,237
CV 183,238,239
buffer_store_dwordx4 v[180:183], v4, s[4:7], s80 offen offset:1024 sc1
AR 224,112
AR 225,113
AR 226,114
AR 227,115
AR 228,120
AR 229,121
AR 230,122
AR 231,123
v_pk_mul_f32 v[224:225], v[224:225], v[8:9]
v_pk_mul_f32 v[226:227], v[226:227], v[8:9]
v_pk_mul_f32 v[228:229], v[228:229], v[8:9]
v_pk_mul_f32 v[230:231], v[230:231], v[8:9]
CV 184,224,225
CV 185,226,227
CV 186,228,229
CV 187,230,231
buffer_store_dwordx4 v[184:187], v4, s[4:7], s80 offen offset:2048 sc1
AR 232,116
AR 233,117
AR 234,118
AR 235,119
AR 236,124
AR 237,125
AR 238,126
AR 239,127
v_pk_mul_f32 v[232:233], v[232:233], v[8:9]
v_pk_mul_f32 v[234:235], v[234:235], v[8:9]
v_pk_mul_f32 v[236:237], v[236:237], v[8:9]
v_pk_mul_f32 v[238:239], v[238:239], v[8:9]
CV 188,232,233
CV 189,234,235
CV 190,236,237
CV 191,238,239
buffer_store_dwordx4 v[188:191], v4, s[4:7], s80 offen offset:3072 sc1
EV_22:
s_lshl_b32 s62, s48, 2
s_add_u32 s64, s62, 4
s_add_u32 s62, s62, s44
s_cmp_eq_u32 s46, 0
s_cselect_b32 s63, s50, 0
s_sub_u32 s64, s64, s63
s_cmp_lg_u32 s51, 0
s_cselect_b32 s64, s50, s64
s_waitcnt vmcnt(11)
s_cmp_lg_u32 s44, 0
s_cbranch_scc1 WOK_28
s_mov_b32 s73, 0
WSP_29:
v_cmp_eq_u32 vcc, v7, v6
s_and_b32 s72, vcc_lo, 0xffff
s_cmp_eq_u32 s72, 0xffff
s_cbranch_scc1 WOK_28
s_sleep 8
buffer_load_dword v7, v30, s[4:7], s70 offen sc1
s_waitcnt vmcnt(0)
s_add_u32 s73, s73, 1
s_cmp_lt_u32 s73, 20000
s_cbranch_scc1 WSP_29
WOK_28:
s_barrier
s_mul_i32 s72, s45, 2097152
s_mul_i32 s73, s63, 32768
s_add_u32 s57, s72, s73
s_add_u32 s57, s57, 0x7ff8000
s_add_u32 s58, s57, 16384
v_add_u32 v10, s52, v4
s_add_u32 m0, s52, 0
s_add_u32 s57, s57, 32768
buffer_load_dwordx4 v10, s[4:7], s57 offen sc1 lds
buffer_load_dwordx4 v10, s[4:7], s57 offen offset:1024 sc1 lds
buffer_load_dwordx4 v10, s[4:7], s57 offen offset:2048 sc1 lds
buffer_load_dwordx4 v10, s[4:7], s57 offen offset:3072 sc1 lds
s_add_u32 m0, s52, 16384
s_add_u32 s57, s57, 32768
buffer_load_dwordx4 v10, s[4:7], s57 offen sc1 lds
buffer_load_dwordx4 v10, s[4:7], s57 offen offset:1024 sc1 lds
buffer_load_dwordx4 v10, s[4:7], s57 offen offset:2048 sc1 lds
buffer_load_dwordx4 v10, s[4:7], s57 offen offset:3072 sc1 lds
s_add_u32 m0, s52, 65536
s_add_u32 s58, s58, 32768
buffer_load_dwordx4 v10, s[4:7], s58 offen sc1 lds
buffer_load_dwordx4 v10, s[4:7], s58 offen offset:1024 sc1 lds
buffer_load_dwordx4 v10, s[4:7], s58 offen offset:2048 sc1 lds
buffer_load_dwordx4 v10, s[4:7], s58 offen offset:3072 sc1 lds
s_cmp_lg_u32 s99, 0
s_cbranch_scc1 OD_30
AR 224,128
AR 225,129
AR 226,130
AR 227,131
v_max_f32 v224, 0, v224
v_max_f32 v225, 0, v225
v_max_f32 v226, 0, v226
v_max_f32 v227, 0, v227
v_pk_mul_f32 v[224:225], v[224:225], v[224:225]
v_pk_mul_f32 v[226:227], v[226:227], v[226:227]
CV 228,224,225
CV 229,226,227
AW 192,v228
AW 193,v229
AR 232,136
AR 233,137
AR 234,138
AR 235,139
v_max_f32 v232, 0, v232
v_max_f32 v233, 0, v233
v_max_f32 v234, 0, v234
v_max_f32 v235, 0, v235
v_pk_mul_f32 v[232:233], v[232:233], v[232:233]
v_pk_mul_f32 v[234:235], v[234:235], v[234:235]
CV 236,232,233
CV 237,234,235
AW 194,v236
AW 195,v237
AR 224,132
AR 225,133
AR 226,134
AR 227,135
v_max_f32 v224, 0, v224
v_max_f32 v225, 0, v225
v_max_f32 v226, 0, v226
v_max_f32 v227, 0, v227
v_pk_mul_f32 v[224:225], v[224:225], v[224:225]
v_pk_mul_f32 v[226:227], v[226:227], v[226:227]
CV 228,224,225
CV 229,226,227
AW 196,v228
AW 197,v229
AR 232,140
AR 233,141
AR 234,142
AR 235,143
v_max_f32 v232, 0, v232
v_max_f32 v233, 0, v233
v_max_f32 v234, 0, v234
v_max_f32 v235, 0, v235
v_pk_mul_f32 v[232:233], v[232:233], v[232:233]
v_pk_mul_f32 v[234:235], v[234:235], v[234:235]
CV 236,232,233
CV 237,234,235
AW 198,v236
AW 199,v237
AR 224,144
AR 225,145
AR 226,146
AR 227,147
v_max_f32 v224, 0, v224
v_max_f32 v225, 0, v225
v_max_f32 v226, 0, v226
v_max_f32 v227, 0, v227
v_pk_mul_f32 v[224:225], v[224:225], v[224:225]
v_pk_mul_f32 v[226:227], v[226:227], v[226:227]
CV 228,224,225
CV 229,226,227
AW 200,v228
AW 201,v229
AR 232,152
AR 233,153
AR 234,154
AR 235,155
v_max_f32 v232, 0, v232
v_max_f32 v233, 0, v233
v_max_f32 v234, 0, v234
v_max_f32 v235, 0, v235
v_pk_mul_f32 v[232:233], v[232:233], v[232:233]
v_pk_mul_f32 v[234:235], v[234:235], v[234:235]
CV 236,232,233
CV 237,234,235
AW 202,v236
AW 203,v237
AR 224,148
AR 225,149
AR 226,150
AR 227,151
v_max_f32 v224, 0, v224
v_max_f32 v225, 0, v225
v_max_f32 v226, 0, v226
v_max_f32 v227, 0, v227
v_pk_mul_f32 v[224:225], v[224:225], v[224:225]
v_pk_mul_f32 v[226:227], v[226:227], v[226:227]
CV 228,224,225
CV 229,226,227
AW 204,v228
AW 205,v229
AR 232,156
AR 233,157
AR 234,158
AR 235,159
v_max_f32 v232, 0, v232
v_max_f32 v233, 0, v233
v_max_f32 v234, 0, v234
v_max_f32 v235, 0, v235
v_pk_mul_f32 v[232:233], v[232:233], v[232:233]
v_pk_mul_f32 v[234:235], v[234:235], v[234:235]
CV 236,232,233
CV 237,234,235
AW 206,v236
AW 207,v237
AR 224,160
AR 225,161
AR 226,162
AR 227,163
v_max_f32 v224, 0, v224
v_max_f32 v225, 0, v225
v_max_f32 v226, 0, v226
v_max_f32 v227, 0, v227
v_pk_mul_f32 v[224:225], v[224:225], v[224:225]
v_pk_mul_f32 v[226:227], v[226:227], v[226:227]
CV 228,224,225
CV 229,226,227
AW 208,v228
AW 209,v229
AR 232,168
AR 233,169
AR 234,170
AR 235,171
v_max_f32 v232, 0, v232
v_max_f32 v233, 0, v233
v_max_f32 v234, 0, v234
v_max_f32 v235, 0, v235
v_pk_mul_f32 v[232:233], v[232:233], v[232:233]
v_pk_mul_f32 v[234:235], v[234:235], v[234:235]
CV 236,232,233
CV 237,234,235
AW 210,v236
AW 211,v237
AR 224,164
AR 225,165
AR 226,166
AR 227,167
v_max_f32 v224, 0, v224
v_max_f32 v225, 0, v225
v_max_f32 v226, 0, v226
v_max_f32 v227, 0, v227
v_pk_mul_f32 v[224:225], v[224:225], v[224:225]
v_pk_mul_f32 v[226:227], v[226:227], v[226:227]
CV 228,224,225
CV 229,226,227
AW 212,v228
AW 213,v229
AR 232,172
AR 233,173
AR 234,174
AR 235,175
v_max_f32 v232, 0, v232
v_max_f32 v233, 0, v233
v_max_f32 v234, 0, v234
v_max_f32 v235, 0, v235
v_pk_mul_f32 v[232:233], v[232:233], v[232:233]
v_pk_mul_f32 v[234:235], v[234:235], v[234:235]
CV 236,232,233
CV 237,234,235
AW 214,v236
AW 215,v237
AR 224,176
AR 225,177
AR 226,178
AR 227,179
v_max_f32 v224, 0, v224
v_max_f32 v225, 0, v225
v_max_f32 v226, 0, v226
v_max_f32 v227, 0, v227
v_pk_mul_f32 v[224:225], v[224:225], v[224:225]
v_pk_mul_f32 v[226:227], v[226:227], v[226:227]
CV 228,224,225
CV 229,226,227
AW 216,v228
AW 217,v229
AR 232,184
AR 233,185
AR 234,186
AR 235,187
v_max_f32 v232, 0, v232
v_max_f32 v233, 0, v233
v_max_f32 v234, 0, v234
v_max_f32 v235, 0, v235
v_pk_mul_f32 v[232:233], v[232:233], v[232:233]
v_pk_mul_f32 v[234:235], v[234:235], v[234:235]
CV 236,232,233
CV 237,234,235
AW 218,v236
AW 219,v237
AR 224,180
AR 225,181
AR 226,182
AR 227,183
v_max_f32 v224, 0, v224
v_max_f32 v225, 0, v225
v_max_f32 v226, 0, v226
v_max_f32 v227, 0, v227
v_pk_mul_f32 v[224:225], v[224:225], v[224:225]
v_pk_mul_f32 v[226:227], v[226:227], v[226:227]
CV 228,224,225
CV 229,226,227
AW 220,v228
AW 221,v229
AR 232,188
AR 233,189
AR 234,190
AR 235,191
v_max_f32 v232, 0, v232
v_max_f32 v233, 0, v233
v_max_f32 v234, 0, v234
v_max_f32 v235, 0, v235
v_pk_mul_f32 v[232:233], v[232:233], v[232:233]
v_pk_mul_f32 v[234:235], v[234:235], v[234:235]
CV 236,232,233
CV 237,234,235
AW 222,v236
AW 223,v237
s_branch EV_31
OD_30:
AR 224,128
AR 225,129
AR 226,130
AR 227,131
v_max_f32 v224, 0, v224
v_max_f32 v225, 0, v225
v_max_f32 v226, 0, v226
v_max_f32_e64 v227, 0, v227
v_pk_mul_f32 v[224:225], v[224:225], v[224:225]
v_pk_mul_f32 v[226:227], v[226:227], v[226:227]
CV 228,224,225
CV 229,226,227
AW 192,v228
AW 193,v229
AR 232,136
AR 233,137
AR 234,138
AR 235,139
v_max_f32 v232, 0, v232
v_max_f32 v233, 0, v233
v_max_f32 v234, 0, v234
v_max_f32 v235, 0, v235
v_pk_mul_f32 v[232:233], v[232:233], v[232:233]
v_pk_mul_f32 v[234:235], v[234:235], v[234:235]
CV 236,232,233
CV 237,234,235
AW 194,v236
AW 195,v237
AR 224,132
AR 225,133
AR 226,134
AR 227,135
v_max_f32 v224, 0, v224
v_max_f32 v225, 0, v225
v_max_f32 v226, 0, v226
v_max_f32 v227, 0, v227
v_pk_mul_f32 v[224:225], v[224:225], v[224:225]
v_pk_mul_f32 v[226:227], v[226:227], v[226:227]
CV 228,224,225
CV 229,226,227
AW 196,v228
AW 197,v229
AR 232,140
AR 233,141
AR 234,142
AR 235,143
v_max_f32 v232, 0, v232
v_max_f32 v233, 0, v233
v_max_f32 v234, 0, v234
v_max_f32 v235, 0, v235
v_pk_mul_f32 v[232:233], v[232:233], v[232:233]
v_pk_mul_f32 v[234:235], v[234:235], v[234:235]
CV 236,232,233
CV 237,234,235
AW 198,v236
AW 199,v237
AR 224,144
AR 225,145
AR 226,146
AR 227,147
v_max_f32 v224, 0, v224
v_max_f32 v225, 0, v225
v_max_f32 v226, 0, v226
v_max_f32 v227, 0, v227
v_pk_mul_f32 v[224:225], v[224:225], v[224:225]
v_pk_mul_f32 v[226:227], v[226:227], v[226:227]
CV 228,224,225
CV 229,226,227
AW 200,v228
AW 201,v229
AR 232,152
AR 233,153
AR 234,154
AR 235,155
v_max_f32 v232, 0, v232
v_max_f32 v233, 0, v233
v_max_f32 v234, 0, v234
v_max_f32 v235, 0, v235
v_pk_mul_f32 v[232:233], v[232:233], v[232:233]
v_pk_mul_f32 v[234:235], v[234:235], v[234:235]
CV 236,232,233
CV 237,234,235
AW 202,v236
AW 203,v237
AR 224,148
AR 225,149
AR 226,150
AR 227,151
v_max_f32 v224, 0, v224
v_max_f32 v225, 0, v225
v_max_f32 v226, 0, v226
v_max_f32 v227, 0, v227
v_pk_mul_f32 v[224:225], v[224:225], v[224:225]
v_pk_mul_f32 v[226:227], v[226:227], v[226:227]
CV 228,224,225
CV 229,226,227
AW 204,v228
AW 205,v229
AR 232,156
AR 233,157
AR 234,158
AR 235,159
v_max_f32 v232, 0, v232
v_max_f32 v233, 0, v233
v_max_f32 v234, 0, v234
v_max_f32 v235, 0, v235
v_pk_mul_f32 v[232:233], v[232:233], v[232:233]
v_pk_mul_f32 v[234:235], v[234:235], v[234:235]
CV 236,232,233
CV 237,234,235
AW 206,v236
AW 207,v237
AR 224,160
AR 225,161
AR 226,162
AR 227,163
v_max_f32 v224, 0, v224
v_max_f32 v225, 0, v225
v_max_f32 v226, 0, v226
v_max_f32 v227, 0, v227
v_pk_mul_f32 v[224:225], v[224:225], v[224:225]
v_pk_mul_f32 v[226:227], v[226:227], v[226:227]
CV 228,224,225
CV 229,226,227
AW 208,v228
AW 209,v229
AR 232,168
AR 233,169
AR 234,170
AR 235,171
v_max_f32 v232, 0, v232
v_max_f32 v233, 0, v233
v_max_f32 v234, 0, v234
v_max_f32 v235, 0, v235
v_pk_mul_f32 v[232:233], v[232:233], v[232:233]
v_pk_mul_f32 v[234:235], v[234:235], v[234:235]
CV 236,232,233
CV 237,234,235
AW 210,v236
AW 211,v237
AR 224,164
AR 225,165
AR 226,166
AR 227,167
v_max_f32 v224, 0, v224
v_max_f32 v225, 0, v225
v_max_f32 v226, 0, v226
v_max_f32 v227, 0, v227
v_pk_mul_f32 v[224:225], v[224:225], v[224:225]
v_pk_mul_f32 v[226:227], v[226:227], v[226:227]
CV 228,224,225
CV 229,226,227
AW 212,v228
AW 213,v229
AR 232,172
AR 233,173
AR 234,174
AR 235,175
v_max_f32 v232, 0, v232
v_max_f32 v233, 0, v233
v_max_f32 v234, 0, v234
v_max_f32 v235, 0, v235
v_pk_mul_f32 v[232:233], v[232:233], v[232:233]
v_pk_mul_f32 v[234:235], v[234:235], v[234:235]
CV 236,232,233
CV 237,234,235
AW 214,v236
AW 215,v237
EV_31:
s_cmp_eq_u32 s68, 0
s_cbranch_scc1 QF_32
s_waitcnt vmcnt(12)
s_barrier
s_lshl_b32 s72, s54, 8
s_add_u32 s72, s72, 0x6130000
buffer_store_dword v6, v5, s[4:7], s72 offen sc1
QF_32:
s_cmp_eq_u32 s51, 0
s_cbranch_scc1 OWN2_24
s_mov_b32 s59, s52
s_xor_b32 s60, s59, 0x8000
v_mov_b32_e64 v8, v4
v_add_u32 v9, 0x18000, v4
v_mov_b32 v16, 0x3f803f80
v_mov_b32 v17, 0x3f803f80
v_mov_b32 v18, 0x3f803f80
v_mov_b32 v19, 0x3f803f80
v_xor_b32 v20, 16, v1
v_lshlrev_b32 v20, 2, v20
v_xor_b32 v21, 32, v1
v_lshlrev_b32 v21, 2, v21
v_mov_b32 v72, 0xc1000000
v_mov_b32_e64 v80, 0
v_mov_b32 v73, 0xc1000000
v_mov_b32_e64 v81, 0
v_mov_b32 v74, 0xc1000000
v_mov_b32_e64 v82, 0
v_mov_b32 v75, 0xc1000000
v_mov_b32_e64 v83, 0
v_mov_b32 v76, 0xc1000000
v_mov_b32_e64 v84, 0
v_mov_b32 v77, 0xc1000000
v_mov_b32_e64 v85, 0
v_mov_b32 v78, 0xc1000000
v_mov_b32_e64 v86, 0
v_mov_b32 v79, 0xc1000000
v_mov_b32_e64 v87, 0
AW 0,0
AW 1,0
AW 2,0
AW 3,0
AW 4,0
AW 5,0
AW 6,0
AW 7,0
AW 8,0
AW 9,0
AW 10,0
AW 11,0
AW 12,0
AW 13,0
AW 14,0
AW 15,0
AW 16,0
AW 17,0
AW 18,0
AW 19,0
AW 20,0
AW 21,0
AW 22,0
AW 23,0
AW 24,0
AW 25,0
AW 26,0
AW 27,0
AW 28,0
AW 29,0
AW 30,0
AW 31,0
AW 32,0
AW 33,0
AW 34,0
AW 35,0
AW 36,0
AW 37,0
AW 38,0
AW 39,0
AW 40,0
AW 41,0
AW 42,0
AW 43,0
AW 44,0
AW 45,0
AW 46,0
AW 47,0
AW 48,0
AW 49,0
AW 50,0
AW 51,0
AW 52,0
AW 53,0
AW 54,0
AW 55,0
AW 56,0
AW 57,0
AW 58,0
AW 59,0
AW 60,0
AW 61,0
AW 62,0
AW 63,0
AW 64,0
AW 65,0
AW 66,0
AW 67,0
AW 68,0
AW 69,0
AW 70,0
AW 71,0
AW 72,0
AW 73,0
AW 74,0
AW 75,0
AW 76,0
AW 77,0
AW 78,0
AW 79,0
AW 80,0
AW 81,0
AW 82,0
AW 83,0
AW 84,0
AW 85,0
AW 86,0
AW 87,0
s_lshl_b32 s70, s54, 8
s_add_u32 s70, s70, 0x6130000
buffer_load_dword v7, v30, s[4:7], s70 offen sc1
s_waitcnt vmcnt(0)
s_cmp_lg_u32 s44, 0
s_cbranch_scc1 WOK_33
s_mov_b32 s73, 0
WSP_34:
v_cmp_eq_u32 vcc, v7, v6
s_and_b32 s72, vcc_lo, 0x1
s_cmp_eq_u32 s72, 0x1
s_cbranch_scc1 WOK_33
s_sleep 8
buffer_load_dword v7, v30, s[4:7], s70 offen sc1
s_waitcnt vmcnt(0)
s_add_u32 s73, s73, 1
s_cmp_lt_u32 s73, 20000
s_cbranch_scc1 WSP_34
WOK_33:
s_barrier
s_lshl_b32 s72, s54, 16
s_lshl_b32 s73, s44, 14
s_add_u32 s72, s72, s73
s_nop 0
s_add_u32 s72, s72, 0x3800000
buffer_load_dwordx4 a[128:131], v4, s[4:7], s72 offen offset:0 sc1
buffer_load_dwordx4 a[132:135], v4, s[4:7], s72 offen offset:1024 sc1
buffer_load_dwordx4 a[136:139], v4, s[4:7], s72 offen offset:2048 sc1
buffer_load_dwordx4 a[140:143], v4, s[4:7], s72 offen offset:3072 sc1
s_add_u32 s72, s72, 4096
buffer_load_dwordx4 a[144:147], v4, s[4:7], s72 offen offset:0 sc1
buffer_load_dwordx4 a[148:151], v4, s[4:7], s72 offen offset:1024 sc1
buffer_load_dwordx4 a[152:155], v4, s[4:7], s72 offen offset:2048 sc1
buffer_load_dwordx4 a[156:159], v4, s[4:7], s72 offen offset:3072 sc1
s_add_u32 s72, s72, 4096
buffer_load_dwordx4 a[160:163], v4, s[4:7], s72 offen offset:0 sc1
buffer_load_dwordx4 a[164:167], v4, s[4:7], s72 offen offset:1024 sc1
buffer_load_dwordx4 a[168:171], v4, s[4:7], s72 offen offset:2048 sc1
buffer_load_dwordx4 a[172:175], v4, s[4:7], s72 offen offset:3072 sc1
s_add_u32 s72, s72, 4096
buffer_load_dwordx4 a[176:179], v4, s[4:7], s72 offen offset:0 sc1
buffer_load_dwordx4 a[180:183], v4, s[4:7], s72 offen offset:1024 sc1
buffer_load_dwordx4 a[184:187], v4, s[4:7], s72 offen offset:2048 sc1
buffer_load_dwordx4 a[188:191], v4, s[4:7], s72 offen offset:3072 sc1
s_add_u32 m0, s52, 32768
s_add_u32 s57, s57, 32768
buffer_load_dwordx4 v10, s[4:7], s57 offen sc1 lds
buffer_load_dwordx4 v10, s[4:7], s57 offen offset:1024 sc1 lds
buffer_load_dwordx4 v10, s[4:7], s57 offen offset:2048 sc1 lds
buffer_load_dwordx4 v10, s[4:7], s57 offen offset:3072 sc1 lds
s_add_u32 m0, s52, 81920
s_add_u32 s58, s58, 32768
buffer_load_dwordx4 v10, s[4:7], s58 offen sc1 lds
buffer_load_dwordx4 v10, s[4:7], s58 offen offset:1024 sc1 lds
buffer_load_dwordx4 v10, s[4:7], s58 offen offset:2048 sc1 lds
buffer_load_dwordx4 v10, s[4:7], s58 offen offset:3072 sc1 lds
s_add_u32 m0, s52, 49152
s_add_u32 s57, s57, 32768
buffer_load_dwordx4 v10, s[4:7], s57 offen sc1 lds
buffer_load_dwordx4 v10, s[4:7], s57 offen offset:1024 sc1 lds
buffer_load_dwordx4 v10, s[4:7], s57 offen offset:2048 sc1 lds
buffer_load_dwordx4 v10, s[4:7], s57 offen offset:3072 sc1 lds
s_waitcnt vmcnt(12)
s_barrier
R4 88,8,0
R4 92,8,1024
R4 96,8,2048
R4 100,8,3072
R4 104,8,4096
R4 108,8,5120
R4 112,8,6144
LW 3
Mvvac 32,88,128,72
AW 88,0
AW 89,0
Mvvac 36,88,132,76
R4 116,8,7168
AW 90,0
Mvvas 32,92,136
AW 91,0
AW 92,0
Mvvas 36,92,140
R4 88,8,8192
AW 93,0
Mvvas 32,96,144
AW 94,0
AW 95,0
Mvvas 36,96,148
R4 92,8,9216
AW 96,0
Mvvas 32,100,152
LW 2
AW 97,0
AW 98,0
Mvvas 36,100,156
R4 96,8,10240
AW 99,0
Mvvas 32,104,160
AW 100,0
AW 101,0
Mvvas 36,104,164
R4 100,8,11264
AW 102,0
Mvvas 32,108,168
AW 103,0
AW 104,0
Mvvas 36,108,172
R4 104,8,12288
AW 105,0
Mvvas 32,112,176
AW 106,0
Mvvas 36,112,180
R4 108,8,13312
AW 107,0
Mvvas 32,116,184
LW 2
AW 108,0
AW 109,0
Mvvas 36,116,188
R4 112,8,14336
AW 110,0
Mvvac 40,88,128,72
AW 111,0
Mvvac 44,88,132,76
R4 116,8,15360
AW 112,0
Mvvas 40,92,136
AW 113,0
AW 114,0
Mvvas 44,92,140
R4 88,8,16384
AW 115,0
Mvvas 40,96,144
AW 116,0
Mvvas 44,96,148
R4 92,8,17408
AW 117,0
Mvvas 40,100,152
LW 2
AW 118,0
AW 119,0
Mvvas 44,100,156
R4 96,8,18432
AW 120,0
Mvvas 40,104,160
AW 121,0
Mvvas 44,104,164
R4 100,8,19456
AW 122,0
Mvvas 40,108,168
AW 123,0
AW 124,0
Mvvas 44,108,172
R4 104,8,20480
AW 125,0
Mvvas 40,112,176
AW 126,0
Mvvas 44,112,180
R4 108,8,21504
AW 127,0
Mvvas 40,116,184
LW 2
Mvvas 44,116,188
s_nop 0
R4 112,8,22528
s_barrier
s_nop 0
s_add_u32 m0, s52, 98304
s_add_u32 s58, s58, 32768
buffer_load_dwordx4 v10, s[4:7], s58 offen sc1 lds
buffer_load_dwordx4 v10, s[4:7], s58 offen offset:1024 sc1 lds
buffer_load_dwordx4 v10, s[4:7], s58 offen offset:2048 sc1 lds
buffer_load_dwordx4 v10, s[4:7], s58 offen offset:3072 sc1 lds
s_mov_b32 m0, s52
s_nop 0
s_add_u32 s57, s57, 32768
buffer_load_dwordx4 v10, s[4:7], s57 offen sc1 lds
buffer_load_dwordx4 v10, s[4:7], s57 offen offset:1024 sc1 lds
buffer_load_dwordx4 v10, s[4:7], s57 offen offset:2048 sc1 lds
buffer_load_dwordx4 v10, s[4:7], s57 offen offset:3072 sc1 lds
v_max3_f32 v22, v32, v33, v34
v_max3_f32 v22, v22, v35, v40
v_max3_f32 v22, v22, v41, v42
v_max_f32_e64 v22, v22, v43
v_max3_f32 v23, v36, v37, v38
v_max3_f32 v23, v23, v39, v44
v_max3_f32 v23, v23, v45, v46
v_max_f32_e64 v23, v23, v47
v_max_f32 v22, abs(v22), abs(v23)
v_cmp_nge_f32_e64 vcc, s56, v22
s_cbranch_vccnz CS_36
CB_35:
s_sub_u32 s61, s64, 6
s_cmp_eq_u32 s61, 0
s_cbranch_scc1 CT6_38
CL_39:
Mvvac 48,88,128,72
v_exp_f32_e64 v32, v32
Mvvac 52,88,132,76
R4 116,8,23552
Mvvas 48,92,136
v_exp_f32_e64 v33, v33
Mvvas 52,92,140
R4 88,8,24576
CV 64,32,33
Mvvas 48,96,144
v_exp_f32_e64 v34, v34
Mvvas 52,96,148
R4 92,8,25600
Mvvas 48,100,152
LW 2
v_exp_f32 v35, v35
Mvvas 52,100,156
R4 96,8,26624
CV 65,34,35
Mvvas 48,104,160
v_exp_f32_e64 v40, v40
Mvvas 52,104,164
R4 100,8,27648
Mvvas 48,108,168
v_exp_f32_e64 v41, v41
Mvvas 52,108,172
R4 104,8,28672
CV 66,40,41
Mvvas 48,112,176
v_exp_f32_e64 v42, v42
Mvvas 52,112,180
R4 108,8,29696
Mvvas 48,116,184
LW 2
v_exp_f32 v43, v43
Mvvas 52,116,188
R4 112,8,30720
CV 67,42,43
Mvvac 56,88,128,72
v_exp_f32_e64 v36, v36
Mvvac 60,88,132,76
R4 116,8,31744
v_xor_b32 v9, 0x8000, v9
Mvvas 56,92,136
v_exp_f32_e64 v37, v37
Mvvas 60,92,140
R4 88,9,0
CV 68,36,37
Mvvas 56,96,144
v_exp_f32_e64 v38, v38
Mvvas 60,96,148
R4 92,9,1024
Mvvas 56,100,152
LW 2
v_exp_f32 v39, v39
Mvvas 60,100,156
R4 96,9,2048
CV 69,38,39
Mvvas 56,104,160
v_exp_f32_e64 v44, v44
Mvvas 60,104,164
R4 100,9,3072
Mvvas 56,108,168
v_exp_f32_e64 v45, v45
Mvvas 60,108,172
R4 104,9,4096
CV 70,44,45
Mvvas 56,112,176
v_exp_f32_e64 v46, v46
Mvvas 60,112,180
R4 108,9,5120
Mvvas 56,116,184
LW 2
v_exp_f32 v47, v47
Mvvas 60,116,188
R4 112,9,6144
CV 71,46,47
Mavvs 0,88,64
s_add_u32 m0, s60, 81920
s_add_u32 s58, s58, 32768
Mavvs 4,88,68
R4 116,9,7168
Mavvs 8,92,64
s_waitcnt vmcnt(12)
s_barrier
Mavvs 12,92,68
R4 88,9,8192
Mavvs 16,96,64
buffer_load_dwordx4 v10, s[4:7], s58 offen sc1 lds
Mavvs 20,96,68
R4 92,9,9216
Mavvs 24,100,64
LW 2
v_max3_f32 v13, v48, v49, v50
Mavvs 28,100,68
R4 96,9,10240
v_max3_f32 v13, v13, v51, v52
Mavvs 32,104,64
buffer_load_dwordx4 v10, s[4:7], s58 offen offset:1024 sc1 lds
Mavvs 36,104,68
R4 100,9,11264
Mavvs 40,108,64
buffer_load_dwordx4 v10, s[4:7], s58 offen offset:2048 sc1 lds
Mavvs 44,108,68
R4 104,9,12288
v_max3_f32 v13, v13, v53, v54
Mavvs 48,112,64
buffer_load_dwordx4 v10, s[4:7], s58 offen offset:3072 sc1 lds
Mavvs 52,112,68
R4 108,9,13312
v_max3_f32 v13, v13, v55, v56
Mavvs 56,116,64
LW 2
s_add_u32 m0, s59, 16384
s_add_u32 s57, s57, 32768
Mavvs 60,116,68
R4 112,9,14336
Mavvs 64,88,64
buffer_load_dwordx4 v10, s[4:7], s57 offen sc1 lds
Mavvs 68,88,68
R4 116,9,15360
v_xor_b32 v8, 0x8000, v8
Mavvs 72,92,64
buffer_load_dwordx4 v10, s[4:7], s57 offen offset:1024 sc1 lds
Mavvs 76,92,68
R4 88,8,0
v_max3_f32 v13, v13, v57, v58
Mavvs 80,96,64
buffer_load_dwordx4 v10, s[4:7], s57 offen offset:2048 sc1 lds
Mavvs 84,96,68
R4 92,8,1024
v_max3_f32 v13, v13, v59, v60
Mavvs 88,100,64
LW 2
v_max3_f32 v13, v13, v61, v62
Mavvs 92,100,68
R4 96,8,2048
Mavvs 96,104,64
buffer_load_dwordx4 v10, s[4:7], s57 offen offset:3072 sc1 lds
Mavvs 100,104,68
R4 100,8,3072
v_max_f32 v13, v13, v63
Mavvs 104,108,64
Mavvs 108,108,68
R4 104,8,4096
Mavvs 112,112,64
v_cmp_lt_f32_e64 vcc, s56, v13
Mavvs 116,112,68
R4 108,8,5120
Mavvs 120,116,64
Mavvs 124,116,68
Mvvvs 80,16,64
LW 2
Mvvvs 84,16,68
R4 112,8,6144
s_cbranch_vccnz CS_41
CB_40:
Mvvac 32,88,128,72
v_exp_f32_e64 v48, v48
Mvvac 36,88,132,76
R4 116,8,7168
Mvvas 32,92,136
v_exp_f32_e64 v49, v49
Mvvas 36,92,140
R4 88,8,8192
CV 64,48,49
Mvvas 32,96,144
v_exp_f32_e64 v50, v50
Mvvas 36,96,148
R4 92,8,9216
Mvvas 32,100,152
LW 2
v_exp_f32 v51, v51
Mvvas 36,100,156
R4 96,8,10240
CV 65,50,51
Mvvas 32,104,160
v_exp_f32_e64 v56, v56
Mvvas 36,104,164
R4 100,8,11264
Mvvas 32,108,168
v_exp_f32_e64 v57, v57
Mvvas 36,108,172
R4 104,8,12288
CV 66,56,57
Mvvas 32,112,176
v_exp_f32_e64 v58, v58
Mvvas 36,112,180
R4 108,8,13312
Mvvas 32,116,184
LW 2
v_exp_f32 v59, v59
Mvvas 36,116,188
R4 112,8,14336
CV 67,58,59
Mvvac 40,88,128,72
v_exp_f32_e64 v52, v52
Mvvac 44,88,132,76
R4 116,8,15360
Mvvas 40,92,136
v_exp_f32_e64 v53, v53
Mvvas 44,92,140
R4 88,9,16384
CV 68,52,53
Mvvas 40,96,144
v_exp_f32_e64 v54, v54
Mvvas 44,96,148
R4 92,9,17408
Mvvas 40,100,152
LW 2
v_exp_f32 v55, v55
Mvvas 44,100,156
R4 96,9,18432
CV 69,54,55
Mvvas 40,104,160
v_exp_f32_e64 v60, v60
Mvvas 44,104,164
R4 100,9,19456
Mvvas 40,108,168
v_exp_f32_e64 v61, v61
Mvvas 44,108,172
R4 104,9,20480
CV 70,60,61
Mvvas 40,112,176
v_exp_f32_e64 v62, v62
Mvvas 44,112,180
R4 108,9,21504
Mvvas 40,116,184
LW 2
v_exp_f32 v63, v63
Mvvas 44,116,188
R4 112,9,22528
CV 71,62,63
Mavvs 0,88,64
s_add_u32 m0, s59, 65536
s_add_u32 s58, s58, 32768
Mavvs 4,88,68
R4 116,9,23552
Mavvs 8,92,64
s_waitcnt vmcnt(12)
s_barrier
Mavvs 12,92,68
R4 88,9,24576
Mavvs 16,96,64
buffer_load_dwordx4 v10, s[4:7], s58 offen sc1 lds
Mavvs 20,96,68
R4 92,9,25600
Mavvs 24,100,64
LW 2
v_max3_f32 v13, v32, v33, v34
Mavvs 28,100,68
R4 96,9,26624
v_max3_f32 v13, v13, v35, v36
Mavvs 32,104,64
buffer_load_dwordx4 v10, s[4:7], s58 offen offset:1024 sc1 lds
Mavvs 36,104,68
R4 100,9,27648
Mavvs 40,108,64
buffer_load_dwordx4 v10, s[4:7], s58 offen offset:2048 sc1 lds
Mavvs 44,108,68
R4 104,9,28672
v_max3_f32 v13, v13, v37, v38
Mavvs 48,112,64
buffer_load_dwordx4 v10, s[4:7], s58 offen offset:3072 sc1 lds
Mavvs 52,112,68
R4 108,9,29696
v_max3_f32 v13, v13, v39, v40
Mavvs 56,116,64
LW 2
s_add_u32 m0, s60, 0
s_add_u32 s57, s57, 32768
Mavvs 60,116,68
R4 112,9,30720
Mavvs 64,88,64
buffer_load_dwordx4 v10, s[4:7], s57 offen sc1 lds
Mavvs 68,88,68
R4 116,9,31744
v_max3_f32 v13, v13, v41, v42
Mavvs 72,92,64
buffer_load_dwordx4 v10, s[4:7], s57 offen offset:1024 sc1 lds
Mavvs 76,92,68
R4 88,8,16384
v_max3_f32 v13, v13, v43, v44
Mavvs 80,96,64
buffer_load_dwordx4 v10, s[4:7], s57 offen offset:2048 sc1 lds
Mavvs 84,96,68
R4 92,8,17408
Mavvs 88,100,64
LW 2
v_max3_f32 v13, v13, v45, v46
Mavvs 92,100,68
R4 96,8,18432
Mavvs 96,104,64
buffer_load_dwordx4 v10, s[4:7], s57 offen offset:3072 sc1 lds
Mavvs 100,104,68
R4 100,8,19456
v_max_f32_e64 v13, v13, v47
Mavvs 104,108,64
s_xor_b32 s59, s59, 0x8000
s_xor_b32 s60, s60, 0x8000
Mavvs 108,108,68
R4 104,8,20480
Mavvs 112,112,64
s_sub_u32 s61, s61, 2
v_cmp_lt_f32 vcc, s56, v13
Mavvs 116,112,68
R4 108,8,21504
Mavvs 120,116,64
s_cmp_lg_u32 s61, 0
Mavvs 124,116,68
Mvvvs 80,16,64
LW 2
Mvvvs 84,16,68
R4 112,8,22528
s_cbranch_vccnz CS_43
CB_42:
s_cbranch_scc1 CL_39
CT6_38:
Mvvac 48,88,128,72
v_exp_f32_e64 v32, v32
Mvvac 52,88,132,76
R4 116,8,23552
Mvvas 48,92,136
v_exp_f32_e64 v33, v33
Mvvas 52,92,140
R4 88,8,24576
CV 64,32,33
Mvvas 48,96,144
v_exp_f32_e64 v34, v34
Mvvas 52,96,148
R4 92,8,25600
Mvvas 48,100,152
LW 2
v_exp_f32 v35, v35
Mvvas 52,100,156
R4 96,8,26624
CV 65,34,35
Mvvas 48,104,160
v_exp_f32_e64 v40, v40
Mvvas 52,104,164
R4 100,8,27648
Mvvas 48,108,168
v_exp_f32_e64 v41, v41
Mvvas 52,108,172
R4 104,8,28672
CV 66,40,41
Mvvas 48,112,176
v_exp_f32_e64 v42, v42
Mvvas 52,112,180
R4 108,8,29696
Mvvas 48,116,184
LW 2
v_exp_f32 v43, v43
Mvvas 52,116,188
R4 112,8,30720
CV 67,42,43
Mvvac 56,88,128,72
v_exp_f32_e64 v36, v36
Mvvac 60,88,132,76
R4 116,8,31744
v_xor_b32 v9, 0x8000, v9
Mvvas 56,92,136
v_exp_f32_e64 v37, v37
Mvvas 60,92,140
R4 88,9,0
CV 68,36,37
Mvvas 56,96,144
v_exp_f32_e64 v38, v38
Mvvas 60,96,148
R4 92,9,1024
Mvvas 56,100,152
LW 2
v_exp_f32 v39, v39
Mvvas 60,100,156
R4 96,9,2048
CV 69,38,39
Mvvas 56,104,160
v_exp_f32_e64 v44, v44
Mvvas 60,104,164
R4 100,9,3072
Mvvas 56,108,168
v_exp_f32_e64 v45, v45
Mvvas 60,108,172
R4 104,9,4096
CV 70,44,45
Mvvas 56,112,176
v_exp_f32_e64 v46, v46
Mvvas 60,112,180
R4 108,9,5120
Mvvas 56,116,184
LW 2
v_exp_f32 v47, v47
Mvvas 60,116,188
R4 112,9,6144
CV 71,46,47
Mavvs 0,88,64
s_add_u32 m0, s60, 81920
s_add_u32 s58, s58, 32768
Mavvs 4,88,68
R4 116,9,7168
Mavvs 8,92,64
s_waitcnt vmcnt(12)
s_barrier
Mavvs 12,92,68
R4 88,9,8192
Mavvs 16,96,64
buffer_load_dwordx4 v10, s[4:7], s58 offen sc1 lds
Mavvs 20,96,68
R4 92,9,9216
Mavvs 24,100,64
LW 2
v_max3_f32 v13, v48, v49, v50
Mavvs 28,100,68
R4 96,9,10240
v_max3_f32 v13, v13, v51, v52
Mavvs 32,104,64
buffer_load_dwordx4 v10, s[4:7], s58 offen offset:1024 sc1 lds
Mavvs 36,104,68
R4 100,9,11264
Mavvs 40,108,64
buffer_load_dwordx4 v10, s[4:7], s58 offen offset:2048 sc1 lds
Mavvs 44,108,68
R4 104,9,12288
v_max3_f32 v13, v13, v53, v54
Mavvs 48,112,64
buffer_load_dwordx4 v10, s[4:7], s58 offen offset:3072 sc1 lds
Mavvs 52,112,68
R4 108,9,13312
v_max3_f32 v13, v13, v55, v56
Mavvs 56,116,64
LW 2
s_add_u32 m0, s59, 16384
s_add_u32 s57, s57, 32768
Mavvs 60,116,68
R4 112,9,14336
Mavvs 64,88,64
buffer_load_dwordx4 v10, s[4:7], s57 offen sc1 lds
Mavvs 68,88,68
R4 116,9,15360
v_xor_b32 v8, 0x8000, v8
Mavvs 72,92,64
buffer_load_dwordx4 v10, s[4:7], s57 offen offset:1024 sc1 lds
Mavvs 76,92,68
R4 88,8,0
v_max3_f32 v13, v13, v57, v58
Mavvs 80,96,64
buffer_load_dwordx4 v10, s[4:7], s57 offen offset:2048 sc1 lds
Mavvs 84,96,68
R4 92,8,1024
v_max3_f32 v13, v13, v59, v60
Mavvs 88,100,64
LW 2
v_max3_f32 v13, v13, v61, v62
Mavvs 92,100,68
R4 96,8,2048
Mavvs 96,104,64
buffer_load_dwordx4 v10, s[4:7], s57 offen offset:3072 sc1 lds
Mavvs 100,104,68
R4 100,8,3072
v_max_f32 v13, v13, v63
Mavvs 104,108,64
Mavvs 108,108,68
R4 104,8,4096
Mavvs 112,112,64
v_cmp_lt_f32_e64 vcc, s56, v13
Mavvs 116,112,68
R4 108,8,5120
Mavvs 120,116,64
Mavvs 124,116,68
Mvvvs 80,16,64
LW 2
Mvvvs 84,16,68
R4 112,8,6144
s_cbranch_vccnz CS_45
CB_44:
Mvvac 32,88,128,72
v_exp_f32_e64 v48, v48
Mvvac 36,88,132,76
R4 116,8,7168
Mvvas 32,92,136
v_exp_f32_e64 v49, v49
Mvvas 36,92,140
R4 88,8,8192
CV 64,48,49
Mvvas 32,96,144
v_exp_f32_e64 v50, v50
Mvvas 36,96,148
R4 92,8,9216
Mvvas 32,100,152
LW 2
v_exp_f32 v51, v51
Mvvas 36,100,156
R4 96,8,10240
CV 65,50,51
Mvvas 32,104,160
v_exp_f32_e64 v56, v56
Mvvas 36,104,164
R4 100,8,11264
Mvvas 32,108,168
v_exp_f32_e64 v57, v57
Mvvas 36,108,172
R4 104,8,12288
CV 66,56,57
Mvvas 32,112,176
v_exp_f32_e64 v58, v58
Mvvas 36,112,180
R4 108,8,13312
Mvvas 32,116,184
LW 2
v_exp_f32 v59, v59
Mvvas 36,116,188
R4 112,8,14336
CV 67,58,59
Mvvac 40,88,128,72
v_exp_f32_e64 v52, v52
Mvvac 44,88,132,76
R4 116,8,15360
Mvvas 40,92,136
v_exp_f32_e64 v53, v53
Mvvas 44,92,140
R4 88,9,16384
CV 68,52,53
Mvvas 40,96,144
v_exp_f32_e64 v54, v54
Mvvas 44,96,148
R4 92,9,17408
Mvvas 40,100,152
LW 2
v_exp_f32 v55, v55
Mvvas 44,100,156
R4 96,9,18432
CV 69,54,55
Mvvas 40,104,160
v_exp_f32_e64 v60, v60
Mvvas 44,104,164
R4 100,9,19456
Mvvas 40,108,168
v_exp_f32_e64 v61, v61
Mvvas 44,108,172
R4 104,9,20480
CV 70,60,61
Mvvas 40,112,176
v_exp_f32_e64 v62, v62
Mvvas 44,112,180
R4 108,9,21504
Mvvas 40,116,184
LW 2
v_exp_f32 v63, v63
Mvvas 44,116,188
R4 112,9,22528
CV 71,62,63
Mavvs 0,88,64
s_add_u32 m0, s59, 65536
s_add_u32 s58, s58, 32768
Mavvs 4,88,68
R4 116,9,23552
Mavvs 8,92,64
s_waitcnt vmcnt(12)
s_barrier
Mavvs 12,92,68
R4 88,9,24576
Mavvs 16,96,64
buffer_load_dwordx4 v10, s[4:7], s58 offen sc1 lds
Mavvs 20,96,68
R4 92,9,25600
Mavvs 24,100,64
LW 2
v_max3_f32 v13, v32, v33, v34
Mavvs 28,100,68
R4 96,9,26624
v_max3_f32 v13, v13, v35, v36
Mavvs 32,104,64
buffer_load_dwordx4 v10, s[4:7], s58 offen offset:1024 sc1 lds
Mavvs 36,104,68
R4 100,9,27648
Mavvs 40,108,64
buffer_load_dwordx4 v10, s[4:7], s58 offen offset:2048 sc1 lds
Mavvs 44,108,68
R4 104,9,28672
v_max3_f32 v13, v13, v37, v38
Mavvs 48,112,64
buffer_load_dwordx4 v10, s[4:7], s58 offen offset:3072 sc1 lds
Mavvs 52,112,68
R4 108,9,29696
v_max3_f32 v13, v13, v39, v40
Mavvs 56,116,64
LW 2
Mavvs 60,116,68
R4 112,9,30720
Mavvs 64,88,64
v_max3_f32 v13, v13, v41, v42
Mavvs 68,88,68
R4 116,9,31744
Mavvs 72,92,64
Mavvs 76,92,68
R4 88,8,16384
v_max3_f32 v13, v13, v43, v44
Mavvs 80,96,64
Mavvs 84,96,68
R4 92,8,17408
Mavvs 88,100,64
LW 2
v_max3_f32 v13, v13, v45, v46
Mavvs 92,100,68
R4 96,8,18432
Mavvs 96,104,64
Mavvs 100,104,68
R4 100,8,19456
v_max_f32 v13, v13, v47
Mavvs 104,108,64
s_xor_b32 s59, s59, 0x8000
Mavvs 108,108,68
R4 104,8,20480
Mavvs 112,112,64
s_xor_b32 s60, s60, 0x8000
v_cmp_lt_f32_e64 vcc, s56, v13
Mavvs 116,112,68
R4 108,8,21504
Mavvs 120,116,64
Mavvs 124,116,68
Mvvvs 80,16,64
LW 2
Mvvvs 84,16,68
R4 112,8,22528
s_cbranch_vccnz CS_47
CB_46:
Mvvac 48,88,128,72
v_exp_f32_e64 v32, v32
Mvvac 52,88,132,76
R4 116,8,23552
Mvvas 48,92,136
v_exp_f32_e64 v33, v33
Mvvas 52,92,140
R4 88,8,24576
CV 64,32,33
Mvvas 48,96,144
v_exp_f32_e64 v34, v34
Mvvas 52,96,148
R4 92,8,25600
Mvvas 48,100,152
LW 2
v_exp_f32 v35, v35
Mvvas 52,100,156
R4 96,8,26624
CV 65,34,35
Mvvas 48,104,160
v_exp_f32_e64 v40, v40
Mvvas 52,104,164
R4 100,8,27648
Mvvas 48,108,168
v_exp_f32_e64 v41, v41
Mvvas 52,108,172
R4 104,8,28672
CV 66,40,41
Mvvas 48,112,176
v_exp_f32_e64 v42, v42
Mvvas 52,112,180
R4 108,8,29696
Mvvas 48,116,184
LW 2
v_exp_f32 v43, v43
Mvvas 52,116,188
R4 112,8,30720
CV 67,42,43
Mvvac 56,88,128,72
v_exp_f32_e64 v36, v36
Mvvac 60,88,132,76
R4 116,8,31744
v_xor_b32 v9, 0x8000, v9
Mvvas 56,92,136
v_exp_f32_e64 v37, v37
Mvvas 60,92,140
R4 88,9,0
CV 68,36,37
Mvvas 56,96,144
v_exp_f32_e64 v38, v38
Mvvas 60,96,148
R4 92,9,1024
Mvvas 56,100,152
LW 2
v_exp_f32 v39, v39
Mvvas 60,100,156
R4 96,9,2048
CV 69,38,39
Mvvas 56,104,160
v_exp_f32_e64 v44, v44
Mvvas 60,104,164
R4 100,9,3072
Mvvas 56,108,168
v_exp_f32_e64 v45, v45
Mvvas 60,108,172
R4 104,9,4096
CV 70,44,45
Mvvas 56,112,176
v_exp_f32_e64 v46, v46
Mvvas 60,112,180
R4 108,9,5120
Mvvas 56,116,184
LW 2
v_exp_f32 v47, v47
Mvvas 60,116,188
R4 112,9,6144
CV 71,46,47
Mavvs 0,88,64
s_add_u32 m0, s60, 81920
s_add_u32 s58, s58, 32768
Mavvs 4,88,68
R4 116,9,7168
Mavvs 8,92,64
s_waitcnt vmcnt(8)
s_barrier
Mavvs 12,92,68
R4 88,9,8192
Mavvs 16,96,64
buffer_load_dwordx4 v10, s[4:7], s58 offen sc1 lds
Mavvs 20,96,68
R4 92,9,9216
Mavvs 24,100,64
LW 2
v_max3_f32 v13, v48, v49, v50
Mavvs 28,100,68
R4 96,9,10240
v_max3_f32 v13, v13, v51, v52
Mavvs 32,104,64
buffer_load_dwordx4 v10, s[4:7], s58 offen offset:1024 sc1 lds
Mavvs 36,104,68
R4 100,9,11264
Mavvs 40,108,64
buffer_load_dwordx4 v10, s[4:7], s58 offen offset:2048 sc1 lds
Mavvs 44,108,68
R4 104,9,12288
v_max3_f32 v13, v13, v53, v54
Mavvs 48,112,64
buffer_load_dwordx4 v10, s[4:7], s58 offen offset:3072 sc1 lds
Mavvs 52,112,68
R4 108,9,13312
v_max3_f32 v13, v13, v55, v56
Mavvs 56,116,64
LW 2
Mavvs 60,116,68
R4 112,9,14336
Mavvs 64,88,64
v_max3_f32 v13, v13, v57, v58
Mavvs 68,88,68
R4 116,9,15360
v_xor_b32 v8, 0x8000, v8
Mavvs 72,92,64
Mavvs 76,92,68
R4 88,8,0
v_max3_f32 v13, v13, v59, v60
Mavvs 80,96,64
Mavvs 84,96,68
R4 92,8,1024
Mavvs 88,100,64
LW 2
v_max3_f32 v13, v13, v61, v62
Mavvs 92,100,68
R4 96,8,2048
Mavvs 96,104,64
Mavvs 100,104,68
R4 100,8,3072
v_max_f32 v13, v13, v63
Mavvs 104,108,64
Mavvs 108,108,68
R4 104,8,4096
Mavvs 112,112,64
v_cmp_lt_f32_e64 vcc, s56, v13
Mavvs 116,112,68
R4 108,8,5120
Mavvs 120,116,64
Mavvs 124,116,68
Mvvvs 80,16,64
LW 2
Mvvvs 84,16,68
R4 112,8,6144
s_cbranch_vccnz CS_49
CB_48:
Mvvac 32,88,128,72
v_exp_f32_e64 v48, v48
Mvvac 36,88,132,76
R4 116,8,7168
Mvvas 32,92,136
v_exp_f32_e64 v49, v49
Mvvas 36,92,140
R4 88,8,8192
CV 64,48,49
Mvvas 32,96,144
v_exp_f32_e64 v50, v50
Mvvas 36,96,148
R4 92,8,9216
Mvvas 32,100,152
LW 2
v_exp_f32 v51, v51
Mvvas 36,100,156
R4 96,8,10240
CV 65,50,51
Mvvas 32,104,160
v_exp_f32_e64 v56, v56
Mvvas 36,104,164
R4 100,8,11264
Mvvas 32,108,168
v_exp_f32_e64 v57, v57
Mvvas 36,108,172
R4 104,8,12288
CV 66,56,57
Mvvas 32,112,176
v_exp_f32_e64 v58, v58
Mvvas 36,112,180
R4 108,8,13312
Mvvas 32,116,184
LW 2
v_exp_f32 v59, v59
Mvvas 36,116,188
R4 112,8,14336
CV 67,58,59
Mvvac 40,88,128,72
v_exp_f32_e64 v52, v52
Mvvac 44,88,132,76
R4 116,8,15360
Mvvas 40,92,136
v_exp_f32_e64 v53, v53
Mvvas 44,92,140
R4 88,9,16384
CV 68,52,53
Mvvas 40,96,144
v_exp_f32_e64 v54, v54
Mvvas 44,96,148
R4 92,9,17408
Mvvas 40,100,152
LW 2
v_exp_f32 v55, v55
Mvvas 44,100,156
R4 96,9,18432
CV 69,54,55
Mvvas 40,104,160
v_exp_f32_e64 v60, v60
Mvvas 44,104,164
R4 100,9,19456
Mvvas 40,108,168
v_exp_f32_e64 v61, v61
Mvvas 44,108,172
R4 104,9,20480
CV 70,60,61
Mvvas 40,112,176
v_exp_f32_e64 v62, v62
Mvvas 44,112,180
R4 108,9,21504
Mvvas 40,116,184
LW 2
v_exp_f32 v63, v63
Mvvas 44,116,188
R4 112,9,22528
CV 71,62,63
Mavvs 0,88,64
s_nop 0
Mavvs 4,88,68
R4 116,9,23552
Mavvs 8,92,64
s_waitcnt vmcnt(4)
s_barrier
Mavvs 12,92,68
R4 88,9,24576
Mavvs 16,96,64
Mavvs 20,96,68
R4 92,9,25600
Mavvs 24,100,64
LW 2
v_max3_f32 v13, v32, v33, v34
Mavvs 28,100,68
R4 96,9,26624
v_max3_f32 v13, v13, v35, v36
Mavvs 32,104,64
Mavvs 36,104,68
R4 100,9,27648
Mavvs 40,108,64
v_max3_f32 v13, v13, v37, v38
Mavvs 44,108,68
R4 104,9,28672
Mavvs 48,112,64
Mavvs 52,112,68
R4 108,9,29696
v_max3_f32 v13, v13, v39, v40
Mavvs 56,116,64
LW 2
Mavvs 60,116,68
R4 112,9,30720
Mavvs 64,88,64
v_max3_f32 v13, v13, v41, v42
Mavvs 68,88,68
R4 116,9,31744
Mavvs 72,92,64
Mavvs 76,92,68
R4 88,8,16384
v_max3_f32 v13, v13, v43, v44
Mavvs 80,96,64
Mavvs 84,96,68
R4 92,8,17408
Mavvs 88,100,64
LW 2
v_max3_f32 v13, v13, v45, v46
Mavvs 92,100,68
R4 96,8,18432
Mavvs 96,104,64
Mavvs 100,104,68
R4 100,8,19456
v_max_f32_e64 v13, v13, v47
Mavvs 104,108,64
s_xor_b32 s59, s59, 0x8000
Mavvs 108,108,68
R4 104,8,20480
Mavvs 112,112,64
s_xor_b32 s60, s60, 0x8000
v_cmp_lt_f32_e64 vcc, s56, v13
Mavvs 116,112,68
R4 108,8,21504
Mavvs 120,116,64
Mavvs 124,116,68
Mvvvs 80,16,64
LW 2
Mvvvs 84,16,68
R4 112,8,22528
s_cbranch_vccnz CS_51
CB_50:
Mvvac 48,88,128,72
v_exp_f32_e64 v32, v32
Mvvac 52,88,132,76
R4 116,8,23552
Mvvas 48,92,136
v_exp_f32_e64 v33, v33
Mvvas 52,92,140
R4 88,8,24576
CV 64,32,33
Mvvas 48,96,144
v_exp_f32_e64 v34, v34
Mvvas 52,96,148
R4 92,8,25600
Mvvas 48,100,152
LW 2
v_exp_f32 v35, v35
Mvvas 52,100,156
R4 96,8,26624
CV 65,34,35
Mvvas 48,104,160
v_exp_f32_e64 v40, v40
Mvvas 52,104,164
R4 100,8,27648
Mvvas 48,108,168
v_exp_f32_e64 v41, v41
Mvvas 52,108,172
R4 104,8,28672
CV 66,40,41
Mvvas 48,112,176
v_exp_f32_e64 v42, v42
Mvvas 52,112,180
R4 108,8,29696
Mvvas 48,116,184
LW 2
v_exp_f32 v43, v43
Mvvas 52,116,188
R4 112,8,30720
CV 67,42,43
Mvvac 56,88,128,72
v_exp_f32_e64 v36, v36
Mvvac 60,88,132,76
R4 116,8,31744
v_xor_b32 v9, 0x8000, v9
Mvvas 56,92,136
v_exp_f32_e64 v37, v37
Mvvas 60,92,140
R4 88,9,0
CV 68,36,37
Mvvas 56,96,144
v_exp_f32_e64 v38, v38
Mvvas 60,96,148
R4 92,9,1024
Mvvas 56,100,152
LW 2
v_exp_f32 v39, v39
Mvvas 60,100,156
R4 96,9,2048
CV 69,38,39
Mvvas 56,104,160
v_exp_f32_e64 v44, v44
Mvvas 60,104,164
R4 100,9,3072
Mvvas 56,108,168
v_exp_f32_e64 v45, v45
Mvvas 60,108,172
R4 104,9,4096
CV 70,44,45
Mvvas 56,112,176
v_exp_f32_e64 v46, v46
Mvvas 60,112,180
R4 108,9,5120
Mvvas 56,116,184
LW 2
v_exp_f32 v47, v47
Mvvas 60,116,188
R4 112,9,6144
CV 71,46,47
Mavvs 0,88,64
s_nop 0
Mavvs 4,88,68
R4 116,9,7168
Mavvs 8,92,64
s_waitcnt vmcnt(0)
s_barrier
Mavvs 12,92,68
R4 88,9,8192
Mavvs 16,96,64
Mavvs 20,96,68
R4 92,9,9216
Mavvs 24,100,64
LW 2
v_max3_f32 v13, v48, v49, v50
Mavvs 28,100,68
R4 96,9,10240
v_max3_f32 v13, v13, v51, v52
Mavvs 32,104,64
Mavvs 36,104,68
R4 100,9,11264
Mavvs 40,108,64
v_max3_f32 v13, v13, v53, v54
Mavvs 44,108,68
R4 104,9,12288
Mavvs 48,112,64
Mavvs 52,112,68
R4 108,9,13312
v_max3_f32 v13, v13, v55, v56
Mavvs 56,116,64
LW 2
Mavvs 60,116,68
R4 112,9,14336
Mavvs 64,88,64
v_max3_f32 v13, v13, v57, v58
Mavvs 68,88,68
R4 116,9,15360
Mavvs 72,92,64
Mavvs 76,92,68
R4 88,9,16384
v_max3_f32 v13, v13, v59, v60
Mavvs 80,96,64
Mavvs 84,96,68
R4 92,9,17408
Mavvs 88,100,64
LW 2
v_max3_f32 v13, v13, v61, v62
Mavvs 92,100,68
R4 96,9,18432
Mavvs 96,104,64
Mavvs 100,104,68
R4 100,9,19456
v_max_f32_e64 v13, v13, v63
Mavvs 104,108,64
Mavvs 108,108,68
R4 104,9,20480
Mavvs 112,112,64
v_cmp_lt_f32_e64 vcc, s56, v13
Mavvs 116,112,68
R4 108,9,21504
Mavvs 120,116,64
Mavvs 124,116,68
Mvvvs 80,16,64
LW 2
Mvvvs 84,16,68
R4 112,9,22528
s_cbranch_vccnz CS_53
CB_52:
v_exp_f32 v48, v48
v_exp_f32 v49, v49
v_exp_f32 v50, v50
v_exp_f32 v51, v51
v_exp_f32 v56, v56
v_exp_f32 v57, v57
v_exp_f32 v58, v58
v_exp_f32 v59, v59
CV 64,48,49
CV 65,50,51
CV 66,56,57
CV 67,58,59
v_exp_f32 v52, v52
v_exp_f32 v53, v53
v_exp_f32 v54, v54
v_exp_f32 v55, v55
v_exp_f32 v60, v60
v_exp_f32 v61, v61
v_exp_f32 v62, v62
v_exp_f32 v63, v63
CV 68,52,53
CV 69,54,55
CV 70,60,61
CV 71,62,63
s_nop 1
Mavvs 0,88,64
s_nop 0
Mavvs 4,88,68
R4 116,9,23552
Mavvs 8,92,64
Mavvs 12,92,68
R4 88,9,24576
Mavvs 16,96,64
Mavvs 20,96,68
R4 92,9,25600
Mavvs 24,100,64
LW 2
Mavvs 28,100,68
R4 96,9,26624
Mavvs 32,104,64
Mavvs 36,104,68
R4 100,9,27648
Mavvs 40,108,64
Mavvs 44,108,68
R4 104,9,28672
Mavvs 48,112,64
Mavvs 52,112,68
R4 108,9,29696
Mavvs 56,116,64
LW 2
Mavvs 60,116,68
R4 112,9,30720
Mavvs 64,88,64
Mavvs 68,88,68
R4 116,9,31744
Mavvs 72,92,64
Mavvs 76,92,68
Mavvs 80,96,64
Mavvs 84,96,68
Mavvs 88,100,64
LW 0
Mavvs 92,100,68
Mavvs 96,104,64
Mavvs 100,104,68
Mavvs 104,108,64
s_xor_b32 s59, s59, 0x8000
Mavvs 108,108,68
Mavvs 112,112,64
s_xor_b32 s60, s60, 0x8000
Mavvs 116,112,68
Mavvs 120,116,64
Mavvs 124,116,68
Mvvvs 80,16,64
Mvvvs 84,16,68
s_lshl_b32 s62, s48, 2
s_add_u32 s64, s62, 4
s_add_u32 s62, s62, s44
s_cmp_eq_u32 s46, 0
s_cselect_b32 s63, s50, 0
s_sub_u32 s64, s64, s63
s_barrier
s_mul_i32 s72, s45, 2097152
s_mul_i32 s73, s63, 32768
s_add_u32 s57, s72, s73
s_nop 0
s_add_u32 s57, s57, 0x7ff8000
s_add_u32 s58, s57, 16384
v_add_u32 v10, s52, v4
s_add_u32 m0, s52, 0
s_add_u32 s57, s57, 32768
buffer_load_dwordx4 v10, s[4:7], s57 offen sc1 lds
buffer_load_dwordx4 v10, s[4:7], s57 offen offset:1024 sc1 lds
buffer_load_dwordx4 v10, s[4:7], s57 offen offset:2048 sc1 lds
buffer_load_dwordx4 v10, s[4:7], s57 offen offset:3072 sc1 lds
s_add_u32 m0, s52, 16384
s_add_u32 s57, s57, 32768
buffer_load_dwordx4 v10, s[4:7], s57 offen sc1 lds
buffer_load_dwordx4 v10, s[4:7], s57 offen offset:1024 sc1 lds
buffer_load_dwordx4 v10, s[4:7], s57 offen offset:2048 sc1 lds
buffer_load_dwordx4 v10, s[4:7], s57 offen offset:3072 sc1 lds
s_add_u32 m0, s52, 65536
s_add_u32 s58, s58, 32768
buffer_load_dwordx4 v10, s[4:7], s58 offen sc1 lds
buffer_load_dwordx4 v10, s[4:7], s58 offen offset:1024 sc1 lds
buffer_load_dwordx4 v10, s[4:7], s58 offen offset:2048 sc1 lds
buffer_load_dwordx4 v10, s[4:7], s58 offen offset:3072 sc1 lds
s_nop 7
s_mul_i32 s72, s54, 135168
s_mul_i32 s73, s44, 33792
s_add_u32 s72, s72, s73
s_add_u32 s72, s72, 0x2400000
s_add_u32 s73, s72, 32768
v_mov_b32 v22, v72
v_mov_b32 v23, v76
v_mov_b32 v24, v80
v_mov_b32 v25, v84
buffer_store_dwordx4 v[22:25], v4, s[4:7], s73 offen sc1
AR 32,0
AR 33,1
AR 34,2
AR 35,3
AR 36,4
AR 37,5
AR 38,6
AR 39,7
CV 40,32,33
CV 41,34,35
CV 42,36,37
CV 43,38,39
buffer_store_dwordx4 v[40:43], v4, s[4:7], s72 offen offset:0 sc1
AR 48,8
AR 49,9
AR 50,10
AR 51,11
AR 52,12
AR 53,13
AR 54,14
AR 55,15
CV 56,48,49
CV 57,50,51
CV 58,52,53
CV 59,54,55
buffer_store_dwordx4 v[56:59], v4, s[4:7], s72 offen offset:1024 sc1
AR 32,16
AR 33,17
AR 34,18
AR 35,19
AR 36,20
AR 37,21
AR 38,22
AR 39,23
CV 40,32,33
CV 41,34,35
CV 42,36,37
CV 43,38,39
buffer_store_dwordx4 v[40:43], v4, s[4:7], s72 offen offset:2048 sc1
AR 48,24
AR 49,25
AR 50,26
AR 51,27
AR 52,28
AR 53,29
AR 54,30
AR 55,31
CV 56,48,49
CV 57,50,51
CV 58,52,53
CV 59,54,55
buffer_store_dwordx4 v[56:59], v4, s[4:7], s72 offen offset:3072 sc1
s_add_u32 s72, s72, 4096
AR 32,32
AR 33,33
AR 34,34
AR 35,35
AR 36,36
AR 37,37
AR 38,38
AR 39,39
CV 40,32,33
CV 41,34,35
CV 42,36,37
CV 43,38,39
buffer_store_dwordx4 v[40:43], v4, s[4:7], s72 offen offset:0 sc1
AR 48,40
AR 49,41
AR 50,42
AR 51,43
AR 52,44
AR 53,45
AR 54,46
AR 55,47
CV 56,48,49
CV 57,50,51
CV 58,52,53
CV 59,54,55
buffer_store_dwordx4 v[56:59], v4, s[4:7], s72 offen offset:1024 sc1
AR 32,48
AR 33,49
AR 34,50
AR 35,51
AR 36,52
AR 37,53
AR 38,54
AR 39,55
CV 40,32,33
CV 41,34,35
CV 42,36,37
CV 43,38,39
buffer_store_dwordx4 v[40:43], v4, s[4:7], s72 offen offset:2048 sc1
AR 48,56
AR 49,57
AR 50,58
AR 51,59
AR 52,60
AR 53,61
AR 54,62
AR 55,63
CV 56,48,49
CV 57,50,51
CV 58,52,53
CV 59,54,55
buffer_store_dwordx4 v[56:59], v4, s[4:7], s72 offen offset:3072 sc1
s_add_u32 s72, s72, 4096
AR 32,64
AR 33,65
AR 34,66
AR 35,67
AR 36,68
AR 37,69
AR 38,70
AR 39,71
CV 40,32,33
CV 41,34,35
CV 42,36,37
CV 43,38,39
buffer_store_dwordx4 v[40:43], v4, s[4:7], s72 offen offset:0 sc1
AR 48,72
AR 49,73
AR 50,74
AR 51,75
AR 52,76
AR 53,77
AR 54,78
AR 55,79
CV 56,48,49
CV 57,50,51
CV 58,52,53
CV 59,54,55
buffer_store_dwordx4 v[56:59], v4, s[4:7], s72 offen offset:1024 sc1
AR 32,80
AR 33,81
AR 34,82
AR 35,83
AR 36,84
AR 37,85
AR 38,86
AR 39,87
CV 40,32,33
CV 41,34,35
CV 42,36,37
CV 43,38,39
buffer_store_dwordx4 v[40:43], v4, s[4:7], s72 offen offset:2048 sc1
AR 48,88
AR 49,89
AR 50,90
AR 51,91
AR 52,92
AR 53,93
AR 54,94
AR 55,95
CV 56,48,49
CV 57,50,51
CV 58,52,53
CV 59,54,55
buffer_store_dwordx4 v[56:59], v4, s[4:7], s72 offen offset:3072 sc1
s_add_u32 s72, s72, 4096
AR 32,96
AR 33,97
AR 34,98
AR 35,99
AR 36,100
AR 37,101
AR 38,102
AR 39,103
CV 40,32,33
CV 41,34,35
CV 42,36,37
CV 43,38,39
buffer_store_dwordx4 v[40:43], v4, s[4:7], s72 offen offset:0 sc1
AR 48,104
AR 49,105
AR 50,106
AR 51,107
AR 52,108
AR 53,109
AR 54,110
AR 55,111
CV 56,48,49
CV 57,50,51
CV 58,52,53
CV 59,54,55
buffer_store_dwordx4 v[56:59], v4, s[4:7], s72 offen offset:1024 sc1
AR 32,112
AR 33,113
AR 34,114
AR 35,115
AR 36,116
AR 37,117
AR 38,118
AR 39,119
CV 40,32,33
CV 41,34,35
CV 42,36,37
CV 43,38,39
buffer_store_dwordx4 v[40:43], v4, s[4:7], s72 offen offset:2048 sc1
AR 48,120
AR 49,121
AR 50,122
AR 51,123
AR 52,124
AR 53,125
AR 54,126
AR 55,127
CV 56,48,49
CV 57,50,51
CV 58,52,53
CV 59,54,55
buffer_store_dwordx4 v[56:59], v4, s[4:7], s72 offen offset:3072 sc1
s_nop 1
OWN2_24:
s_mov_b32 s59, s52
s_xor_b32 s60, s59, 0x8000
v_mov_b32_e64 v8, v4
v_add_u32 v9, 0x18000, v4
v_and_b32 v2, 15, v1
v_lshrrev_b32 v3, 4, v1
v_lshlrev_b32 v3, 2, v3
v_sub_u32 v12, v2, v3
s_lshl_b32 s72, s44, 4
v_add_u32 v12, s72, v12
s_sub_u32 s72, s64, 4
s_lshl_b32 s72, s72, 5
v_add_u32_e64 v11, s72, v12
s_lshl_b32 s62, s3, 4
s_sub_u32 s62, s62, 64
v_mov_b32 v14, 0xff800000
v_mov_b32 v16, 0x3f803f80
v_mov_b32 v17, 0x3f803f80
v_mov_b32 v18, 0x3f803f80
v_mov_b32 v19, 0x3f803f80
v_xor_b32 v20, 16, v1
v_lshlrev_b32 v20, 2, v20
v_xor_b32 v21, 32, v1
v_lshlrev_b32 v21, 2, v21
v_mov_b32 v72, 0xc1000000
v_mov_b32_e64 v80, 0
v_mov_b32 v73, 0xc1000000
v_mov_b32_e64 v81, 0
v_mov_b32 v74, 0xc1000000
v_mov_b32_e64 v82, 0
v_mov_b32 v75, 0xc1000000
v_mov_b32_e64 v83, 0
v_mov_b32 v76, 0xc1000000
v_mov_b32_e64 v84, 0
v_mov_b32 v77, 0xc1000000
v_mov_b32_e64 v85, 0
v_mov_b32 v78, 0xc1000000
v_mov_b32_e64 v86, 0
v_mov_b32 v79, 0xc1000000
v_mov_b32_e64 v87, 0
AW 0,0
AW 1,0
AW 2,0
AW 3,0
AW 4,0
AW 5,0
AW 6,0
AW 7,0
AW 8,0
AW 9,0
AW 10,0
AW 11,0
AW 12,0
AW 13,0
AW 14,0
AW 15,0
AW 16,0
AW 17,0
AW 18,0
AW 19,0
AW 20,0
AW 21,0
AW 22,0
AW 23,0
AW 24,0
AW 25,0
AW 26,0
AW 27,0
AW 28,0
AW 29,0
AW 30,0
AW 31,0
AW 32,0
AW 33,0
AW 34,0
AW 35,0
AW 36,0
AW 37,0
AW 38,0
AW 39,0
AW 40,0
AW 41,0
AW 42,0
AW 43,0
AW 44,0
AW 45,0
AW 46,0
AW 47,0
AW 48,0
AW 49,0
AW 50,0
AW 51,0
AW 52,0
AW 53,0
AW 54,0
AW 55,0
AW 56,0
AW 57,0
AW 58,0
AW 59,0
AW 60,0
AW 61,0
AW 62,0
AW 63,0
AW 64,0
AW 65,0
AW 66,0
AW 67,0
AW 68,0
AW 69,0
AW 70,0
AW 71,0
AW 72,0
AW 73,0
AW 74,0
AW 75,0
AW 76,0
AW 77,0
AW 78,0
AW 79,0
AW 80,0
AW 81,0
AW 82,0
AW 83,0
AW 84,0
AW 85,0
AW 86,0
AW 87,0
s_add_u32 m0, s52, 32768
s_add_u32 s57, s57, 32768
buffer_load_dwordx4 v10, s[4:7], s57 offen sc1 lds
buffer_load_dwordx4 v10, s[4:7], s57 offen offset:1024 sc1 lds
buffer_load_dwordx4 v10, s[4:7], s57 offen offset:2048 sc1 lds
buffer_load_dwordx4 v10, s[4:7], s57 offen offset:3072 sc1 lds
s_add_u32 m0, s52, 81920
s_add_u32 s58, s58, 32768
buffer_load_dwordx4 v10, s[4:7], s58 offen sc1 lds
buffer_load_dwordx4 v10, s[4:7], s58 offen offset:1024 sc1 lds
buffer_load_dwordx4 v10, s[4:7], s58 offen offset:2048 sc1 lds
buffer_load_dwordx4 v10, s[4:7], s58 offen offset:3072 sc1 lds
s_add_u32 m0, s52, 49152
s_add_u32 s57, s57, 32768
buffer_load_dwordx4 v10, s[4:7], s57 offen sc1 lds
buffer_load_dwordx4 v10, s[4:7], s57 offen offset:1024 sc1 lds
buffer_load_dwordx4 v10, s[4:7], s57 offen offset:2048 sc1 lds
buffer_load_dwordx4 v10, s[4:7], s57 offen offset:3072 sc1 lds
s_cmp_eq_u32 s51, 0
s_cbranch_scc1 FW_54
s_waitcnt vmcnt(29)
s_branch FW_55
FW_54:
s_waitcnt vmcnt(12)
FW_55:
s_barrier
s_cmp_lt_u32 s47, 6
s_cbranch_scc1 PD_56
v_lshlrev_b32_e64 v2, 7, v0
s_mul_i32 s73, s45, 229376
s_mul_i32 s74, s98, 896
s_cmp_eq_u32 s46, 0
s_cbranch_scc1 PD_58
s_cmp_eq_u32 s47, 7
s_cbranch_scc1 PD_57
s_add_u32 s72, s73, 0
s_nop 0
buffer_load_dword v31, v2, s[24:27], s72 offen
s_add_u32 s72, s73, 32768
buffer_load_dword v31, v2, s[24:27], s72 offen
s_add_u32 s72, s73, 65536
buffer_load_dword v31, v2, s[24:27], s72 offen
s_add_u32 s72, s73, 98304
buffer_load_dword v31, v2, s[24:27], s72 offen
s_add_u32 s72, s73, 131072
buffer_load_dword v31, v2, s[24:27], s72 offen
s_add_u32 s72, s73, 163840
buffer_load_dword v31, v2, s[24:27], s72 offen
s_branch PD_56
PD_57:
s_nop 0
s_add_u32 s72, s73, 196608
buffer_load_dword v31, v2, s[24:27], s72 offen
s_add_u32 s72, s74, 0
buffer_load_dword v31, v2, s[28:31], s72 offen
s_add_u32 s72, s74, 32768
buffer_load_dword v31, v2, s[28:31], s72 offen
s_add_u32 s72, s74, 65536
buffer_load_dword v31, v2, s[28:31], s72 offen
s_branch PD_56
PD_58:
s_cmp_eq_u32 s47, 6
s_cbranch_scc1 PD_56
v_min_u32 v3, 16256, v2
s_add_u32 s72, s74, 98304
buffer_load_dword v31, v3, s[28:31], s72 offen
v_add_u32 v2, M_D_START-M_CODE_START-10240, v2
s_mul_i32 s72, s99, 13056
s_cmp_ge_u32 s44, 2
s_cselect_b32 s72, s72, 0
v_add_u32_e64 v2, s72, v2
v_min_u32 v2, M_CODE_END-M_CODE_START-4, v2
global_load_dword v31, v2, s[66:67]
PD_56:
R4 88,8,0
R4 92,8,1024
R4 96,8,2048
R4 100,8,3072
R4 104,8,4096
R4 108,8,5120
R4 112,8,6144
LW 3
Mvvvc 32,88,128,72
AW 88,0
AW 89,0
Mvvvc 36,88,132,76
R4 116,8,7168
AW 90,0
Mvvvs 32,92,136
AW 91,0
AW 92,0
Mvvvs 36,92,140
R4 88,8,8192
AW 93,0
Mvvvs 32,96,144
AW 94,0
AW 95,0
Mvvvs 36,96,148
R4 92,8,9216
AW 96,0
Mvvvs 32,100,152
LW 2
AW 97,0
AW 98,0
Mvvvs 36,100,156
R4 96,8,10240
AW 99,0
Mvvvs 32,104,160
AW 100,0
AW 101,0
Mvvvs 36,104,164
R4 100,8,11264
AW 102,0
Mvvvs 32,108,168
AW 103,0
AW 104,0
Mvvvs 36,108,172
R4 104,8,12288
AW 105,0
Mvvvs 32,112,176
AW 106,0
Mvvvs 36,112,180
R4 108,8,13312
AW 107,0
Mvvvs 32,116,184
LW 2
AW 108,0
AW 109,0
Mvvvs 36,116,188
R4 112,8,14336
AW 110,0
Mvvvc 40,88,128,72
AW 111,0
Mvvvc 44,88,132,76
R4 116,8,15360
AW 112,0
Mvvvs 40,92,136
AW 113,0
AW 114,0
Mvvvs 44,92,140
R4 88,8,16384
AW 115,0
Mvvvs 40,96,144
AW 116,0
Mvvvs 44,96,148
R4 92,8,17408
AW 117,0
Mvvvs 40,100,152
LW 2
AW 118,0
AW 119,0
Mvvvs 44,100,156
R4 96,8,18432
AW 120,0
Mvvvs 40,104,160
AW 121,0
Mvvvs 44,104,164
R4 100,8,19456
AW 122,0
Mvvvs 40,108,168
AW 123,0
AW 124,0
Mvvvs 44,108,172
R4 104,8,20480
AW 125,0
Mvvvs 40,112,176
AW 126,0
Mvvvs 44,112,180
R4 108,8,21504
AW 127,0
Mvvvs 40,116,184
LW 2
Mvvvs 44,116,188
R4 112,8,22528
s_cmp_eq_u32 s51, 0
s_cbranch_scc1 FX_59
s_waitcnt vmcnt(12)
FX_59:
s_barrier
s_cmp_eq_u32 s51, 0
s_cbranch_scc1 PF_60
s_lshl_b32 s72, s54, 8
s_add_u32 s72, s72, 0x6120000
buffer_store_dword v6, v5, s[4:7], s72 offen sc1
PF_60:
s_add_u32 m0, s52, 98304
s_add_u32 s58, s58, 32768
buffer_load_dwordx4 v10, s[4:7], s58 offen sc1 lds
buffer_load_dwordx4 v10, s[4:7], s58 offen offset:1024 sc1 lds
buffer_load_dwordx4 v10, s[4:7], s58 offen offset:2048 sc1 lds
buffer_load_dwordx4 v10, s[4:7], s58 offen offset:3072 sc1 lds
s_mov_b32 m0, s52
s_nop 0
s_add_u32 s57, s57, 32768
buffer_load_dwordx4 v10, s[4:7], s57 offen sc1 lds
buffer_load_dwordx4 v10, s[4:7], s57 offen offset:1024 sc1 lds
buffer_load_dwordx4 v10, s[4:7], s57 offen offset:2048 sc1 lds
buffer_load_dwordx4 v10, s[4:7], s57 offen offset:3072 sc1 lds
v_cmp_gt_i32 s[86:87], 0, v11
v_cmp_gt_i32 s[88:89], 1, v11
v_cmp_gt_i32 s[90:91], 2, v11
v_cmp_gt_i32 s[92:93], 3, v11
v_cndmask_b32 v32, v32, v14, s[86:87]
v_cndmask_b32 v33, v33, v14, s[88:89]
v_cndmask_b32 v34, v34, v14, s[90:91]
v_cndmask_b32 v35, v35, v14, s[92:93]
v_cmp_gt_i32 s[86:87], 16, v11
v_cmp_gt_i32 s[88:89], 17, v11
v_cmp_gt_i32 s[90:91], 18, v11
v_cmp_gt_i32 s[92:93], 19, v11
v_cndmask_b32 v40, v40, v14, s[86:87]
v_cndmask_b32 v41, v41, v14, s[88:89]
v_cndmask_b32 v42, v42, v14, s[90:91]
v_cndmask_b32 v43, v43, v14, s[92:93]
v_max3_f32 v22, v32, v33, v34
v_max3_f32 v22, v22, v35, v40
v_max3_f32 v22, v22, v41, v42
v_max_f32_e64 v22, v22, v43
v_max3_f32 v23, v36, v37, v38
v_max3_f32 v23, v23, v39, v44
v_max3_f32 v23, v23, v45, v46
v_max_f32_e64 v23, v23, v47
v_max_f32 v22, abs(v22), abs(v23)
v_cmp_nge_f32_e64 vcc, s56, v22
s_cbranch_vccnz CS_62
CB_61:
s_cmp_eq_u32 s64, 4
s_cbranch_scc1 CT4_63
s_sub_u32 s61, s64, 6
s_cmp_eq_u32 s61, 0
s_cbranch_scc1 CT6_64
CL_65:
Mvvvc 48,88,128,72
v_exp_f32_e64 v32, v32
Mvvvc 52,88,132,76
R4 116,8,23552
Mvvvs 48,92,136
v_exp_f32_e64 v33, v33
Mvvvs 52,92,140
R4 88,8,24576
CV 64,32,33
Mvvvs 48,96,144
v_exp_f32_e64 v34, v34
Mvvvs 52,96,148
R4 92,8,25600
Mvvvs 48,100,152
LW 2
v_exp_f32 v35, v35
Mvvvs 52,100,156
R4 96,8,26624
CV 65,34,35
Mvvvs 48,104,160
v_exp_f32_e64 v40, v40
Mvvvs 52,104,164
R4 100,8,27648
Mvvvs 48,108,168
v_exp_f32_e64 v41, v41
Mvvvs 52,108,172
R4 104,8,28672
CV 66,40,41
Mvvvs 48,112,176
v_exp_f32_e64 v42, v42
Mvvvs 52,112,180
R4 108,8,29696
Mvvvs 48,116,184
LW 2
v_exp_f32 v43, v43
Mvvvs 52,116,188
R4 112,8,30720
CV 67,42,43
Mvvvc 56,88,128,72
v_exp_f32_e64 v36, v36
Mvvvc 60,88,132,76
R4 116,8,31744
v_xor_b32 v9, 0x8000, v9
Mvvvs 56,92,136
v_exp_f32_e64 v37, v37
Mvvvs 60,92,140
R4 88,9,0
CV 68,36,37
Mvvvs 56,96,144
v_exp_f32_e64 v38, v38
Mvvvs 60,96,148
R4 92,9,1024
Mvvvs 56,100,152
LW 2
v_exp_f32 v39, v39
Mvvvs 60,100,156
R4 96,9,2048
CV 69,38,39
Mvvvs 56,104,160
v_exp_f32_e64 v44, v44
Mvvvs 60,104,164
R4 100,9,3072
Mvvvs 56,108,168
v_exp_f32_e64 v45, v45
Mvvvs 60,108,172
R4 104,9,4096
CV 70,44,45
Mvvvs 56,112,176
v_exp_f32_e64 v46, v46
Mvvvs 60,112,180
R4 108,9,5120
Mvvvs 56,116,184
LW 2
v_exp_f32 v47, v47
Mvvvs 60,116,188
R4 112,9,6144
CV 71,46,47
Mavvs 0,88,64
s_add_u32 m0, s60, 81920
s_add_u32 s58, s58, 32768
Mavvs 4,88,68
R4 116,9,7168
Mavvs 8,92,64
s_waitcnt vmcnt(12)
s_barrier
Mavvs 12,92,68
R4 88,9,8192
Mavvs 16,96,64
buffer_load_dwordx4 v10, s[4:7], s58 offen sc1 lds
Mavvs 20,96,68
R4 92,9,9216
Mavvs 24,100,64
LW 2
v_max3_f32 v13, v48, v49, v50
Mavvs 28,100,68
R4 96,9,10240
v_max3_f32 v13, v13, v51, v52
Mavvs 32,104,64
buffer_load_dwordx4 v10, s[4:7], s58 offen offset:1024 sc1 lds
Mavvs 36,104,68
R4 100,9,11264
Mavvs 40,108,64
buffer_load_dwordx4 v10, s[4:7], s58 offen offset:2048 sc1 lds
Mavvs 44,108,68
R4 104,9,12288
v_max3_f32 v13, v13, v53, v54
Mavvs 48,112,64
buffer_load_dwordx4 v10, s[4:7], s58 offen offset:3072 sc1 lds
Mavvs 52,112,68
R4 108,9,13312
v_max3_f32 v13, v13, v55, v56
Mavvs 56,116,64
LW 2
s_add_u32 m0, s59, 16384
s_add_u32 s57, s57, 32768
Mavvs 60,116,68
R4 112,9,14336
Mavvs 64,88,64
buffer_load_dwordx4 v10, s[4:7], s57 offen sc1 lds
Mavvs 68,88,68
R4 116,9,15360
v_xor_b32 v8, 0x8000, v8
Mavvs 72,92,64
buffer_load_dwordx4 v10, s[4:7], s57 offen offset:1024 sc1 lds
Mavvs 76,92,68
R4 88,8,0
v_max3_f32 v13, v13, v57, v58
Mavvs 80,96,64
buffer_load_dwordx4 v10, s[4:7], s57 offen offset:2048 sc1 lds
Mavvs 84,96,68
R4 92,8,1024
v_max3_f32 v13, v13, v59, v60
Mavvs 88,100,64
LW 2
v_max3_f32 v13, v13, v61, v62
Mavvs 92,100,68
R4 96,8,2048
Mavvs 96,104,64
buffer_load_dwordx4 v10, s[4:7], s57 offen offset:3072 sc1 lds
Mavvs 100,104,68
R4 100,8,3072
v_max_f32 v13, v13, v63
Mavvs 104,108,64
Mavvs 108,108,68
R4 104,8,4096
Mavvs 112,112,64
v_cmp_lt_f32_e64 vcc, s56, v13
Mavvs 116,112,68
R4 108,8,5120
Mavvs 120,116,64
Mavvs 124,116,68
Mvvvs 80,16,64
LW 2
Mvvvs 84,16,68
R4 112,8,6144
s_cbranch_vccnz CS_67
CB_66:
Mvvvc 32,88,128,72
v_exp_f32_e64 v48, v48
Mvvvc 36,88,132,76
R4 116,8,7168
Mvvvs 32,92,136
v_exp_f32_e64 v49, v49
Mvvvs 36,92,140
R4 88,8,8192
CV 64,48,49
Mvvvs 32,96,144
v_exp_f32_e64 v50, v50
Mvvvs 36,96,148
R4 92,8,9216
Mvvvs 32,100,152
LW 2
v_exp_f32 v51, v51
Mvvvs 36,100,156
R4 96,8,10240
CV 65,50,51
Mvvvs 32,104,160
v_exp_f32_e64 v56, v56
Mvvvs 36,104,164
R4 100,8,11264
Mvvvs 32,108,168
v_exp_f32_e64 v57, v57
Mvvvs 36,108,172
R4 104,8,12288
CV 66,56,57
Mvvvs 32,112,176
v_exp_f32_e64 v58, v58
Mvvvs 36,112,180
R4 108,8,13312
Mvvvs 32,116,184
LW 2
v_exp_f32 v59, v59
Mvvvs 36,116,188
R4 112,8,14336
CV 67,58,59
Mvvvc 40,88,128,72
v_exp_f32_e64 v52, v52
Mvvvc 44,88,132,76
R4 116,8,15360
Mvvvs 40,92,136
v_exp_f32_e64 v53, v53
Mvvvs 44,92,140
R4 88,9,16384
CV 68,52,53
Mvvvs 40,96,144
v_exp_f32_e64 v54, v54
Mvvvs 44,96,148
R4 92,9,17408
Mvvvs 40,100,152
LW 2
v_exp_f32 v55, v55
Mvvvs 44,100,156
R4 96,9,18432
CV 69,54,55
Mvvvs 40,104,160
v_exp_f32_e64 v60, v60
Mvvvs 44,104,164
R4 100,9,19456
Mvvvs 40,108,168
v_exp_f32_e64 v61, v61
Mvvvs 44,108,172
R4 104,9,20480
CV 70,60,61
Mvvvs 40,112,176
v_exp_f32_e64 v62, v62
Mvvvs 44,112,180
R4 108,9,21504
Mvvvs 40,116,184
LW 2
v_exp_f32 v63, v63
Mvvvs 44,116,188
R4 112,9,22528
CV 71,62,63
Mavvs 0,88,64
s_add_u32 m0, s59, 65536
s_add_u32 s58, s58, 32768
Mavvs 4,88,68
R4 116,9,23552
Mavvs 8,92,64
s_waitcnt vmcnt(12)
s_barrier
Mavvs 12,92,68
R4 88,9,24576
Mavvs 16,96,64
buffer_load_dwordx4 v10, s[4:7], s58 offen sc1 lds
Mavvs 20,96,68
R4 92,9,25600
Mavvs 24,100,64
LW 2
v_max3_f32 v13, v32, v33, v34
Mavvs 28,100,68
R4 96,9,26624
v_max3_f32 v13, v13, v35, v36
Mavvs 32,104,64
buffer_load_dwordx4 v10, s[4:7], s58 offen offset:1024 sc1 lds
Mavvs 36,104,68
R4 100,9,27648
Mavvs 40,108,64
buffer_load_dwordx4 v10, s[4:7], s58 offen offset:2048 sc1 lds
Mavvs 44,108,68
R4 104,9,28672
v_max3_f32 v13, v13, v37, v38
Mavvs 48,112,64
buffer_load_dwordx4 v10, s[4:7], s58 offen offset:3072 sc1 lds
Mavvs 52,112,68
R4 108,9,29696
v_max3_f32 v13, v13, v39, v40
Mavvs 56,116,64
LW 2
s_add_u32 m0, s60, 0
s_add_u32 s57, s57, 32768
Mavvs 60,116,68
R4 112,9,30720
Mavvs 64,88,64
buffer_load_dwordx4 v10, s[4:7], s57 offen sc1 lds
Mavvs 68,88,68
R4 116,9,31744
v_max3_f32 v13, v13, v41, v42
Mavvs 72,92,64
buffer_load_dwordx4 v10, s[4:7], s57 offen offset:1024 sc1 lds
Mavvs 76,92,68
R4 88,8,16384
v_max3_f32 v13, v13, v43, v44
Mavvs 80,96,64
buffer_load_dwordx4 v10, s[4:7], s57 offen offset:2048 sc1 lds
Mavvs 84,96,68
R4 92,8,17408
Mavvs 88,100,64
LW 2
v_max3_f32 v13, v13, v45, v46
Mavvs 92,100,68
R4 96,8,18432
Mavvs 96,104,64
buffer_load_dwordx4 v10, s[4:7], s57 offen offset:3072 sc1 lds
Mavvs 100,104,68
R4 100,8,19456
v_max_f32_e64 v13, v13, v47
Mavvs 104,108,64
s_xor_b32 s59, s59, 0x8000
s_xor_b32 s60, s60, 0x8000
Mavvs 108,108,68
R4 104,8,20480
Mavvs 112,112,64
s_sub_u32 s61, s61, 2
v_cmp_lt_f32 vcc, s56, v13
Mavvs 116,112,68
R4 108,8,21504
Mavvs 120,116,64
s_cmp_lg_u32 s61, 0
Mavvs 124,116,68
Mvvvs 80,16,64
LW 2
Mvvvs 84,16,68
R4 112,8,22528
s_cbranch_vccnz CS_69
CB_68:
s_cbranch_scc1 CL_65
CT6_64:
s_lshl_b32 s70, s54, 8
s_add_u32 s70, s70, 0x6120000
buffer_load_dword v7, v30, s[4:7], s70 offen sc1
Mvvvc 48,88,128,72
v_exp_f32 v32, v32
Mvvvc 52,88,132,76
R4 116,8,23552
Mvvvs 48,92,136
v_exp_f32_e64 v33, v33
Mvvvs 52,92,140
R4 88,8,24576
CV 64,32,33
Mvvvs 48,96,144
v_exp_f32_e64 v34, v34
Mvvvs 52,96,148
R4 92,8,25600
Mvvvs 48,100,152
LW 2
v_exp_f32 v35, v35
Mvvvs 52,100,156
R4 96,8,26624
CV 65,34,35
Mvvvs 48,104,160
v_exp_f32_e64 v40, v40
Mvvvs 52,104,164
R4 100,8,27648
Mvvvs 48,108,168
v_exp_f32_e64 v41, v41
Mvvvs 52,108,172
R4 104,8,28672
CV 66,40,41
Mvvvs 48,112,176
v_exp_f32_e64 v42, v42
Mvvvs 52,112,180
R4 108,8,29696
Mvvvs 48,116,184
LW 2
v_exp_f32 v43, v43
Mvvvs 52,116,188
R4 112,8,30720
CV 67,42,43
Mvvvc 56,88,128,72
v_exp_f32_e64 v36, v36
Mvvvc 60,88,132,76
R4 116,8,31744
v_xor_b32 v9, 0x8000, v9
Mvvvs 56,92,136
v_exp_f32_e64 v37, v37
Mvvvs 60,92,140
R4 88,9,0
CV 68,36,37
Mvvvs 56,96,144
v_exp_f32_e64 v38, v38
Mvvvs 60,96,148
R4 92,9,1024
Mvvvs 56,100,152
LW 2
v_exp_f32 v39, v39
Mvvvs 60,100,156
R4 96,9,2048
CV 69,38,39
Mvvvs 56,104,160
v_exp_f32_e64 v44, v44
Mvvvs 60,104,164
R4 100,9,3072
Mvvvs 56,108,168
v_exp_f32_e64 v45, v45
Mvvvs 60,108,172
R4 104,9,4096
CV 70,44,45
Mvvvs 56,112,176
v_exp_f32_e64 v46, v46
Mvvvs 60,112,180
R4 108,9,5120
Mvvvs 56,116,184
LW 2
v_exp_f32 v47, v47
Mvvvs 60,116,188
R4 112,9,6144
CV 71,46,47
Mavvs 0,88,64
s_add_u32 m0, s60, 81920
s_add_u32 s58, s58, 32768
Mavvs 4,88,68
R4 116,9,7168
Mavvs 8,92,64
s_waitcnt vmcnt(12)
s_barrier
Mavvs 12,92,68
R4 88,9,8192
Mavvs 16,96,64
buffer_load_dwordx4 v10, s[4:7], s58 offen sc1 lds
Mavvs 20,96,68
R4 92,9,9216
Mavvs 24,100,64
LW 2
v_max3_f32 v13, v48, v49, v50
Mavvs 28,100,68
R4 96,9,10240
v_max3_f32 v13, v13, v51, v52
Mavvs 32,104,64
buffer_load_dwordx4 v10, s[4:7], s58 offen offset:1024 sc1 lds
Mavvs 36,104,68
R4 100,9,11264
Mavvs 40,108,64
buffer_load_dwordx4 v10, s[4:7], s58 offen offset:2048 sc1 lds
Mavvs 44,108,68
R4 104,9,12288
v_max3_f32 v13, v13, v53, v54
Mavvs 48,112,64
buffer_load_dwordx4 v10, s[4:7], s58 offen offset:3072 sc1 lds
Mavvs 52,112,68
R4 108,9,13312
v_max3_f32 v13, v13, v55, v56
Mavvs 56,116,64
LW 2
s_add_u32 m0, s59, 16384
s_add_u32 s57, s57, 32768
Mavvs 60,116,68
R4 112,9,14336
Mavvs 64,88,64
buffer_load_dwordx4 v10, s[4:7], s57 offen sc1 lds
Mavvs 68,88,68
R4 116,9,15360
v_xor_b32 v8, 0x8000, v8
Mavvs 72,92,64
buffer_load_dwordx4 v10, s[4:7], s57 offen offset:1024 sc1 lds
Mavvs 76,92,68
R4 88,8,0
v_max3_f32 v13, v13, v57, v58
Mavvs 80,96,64
buffer_load_dwordx4 v10, s[4:7], s57 offen offset:2048 sc1 lds
Mavvs 84,96,68
R4 92,8,1024
v_max3_f32 v13, v13, v59, v60
Mavvs 88,100,64
LW 2
v_max3_f32 v13, v13, v61, v62
Mavvs 92,100,68
R4 96,8,2048
Mavvs 96,104,64
buffer_load_dwordx4 v10, s[4:7], s57 offen offset:3072 sc1 lds
Mavvs 100,104,68
R4 100,8,3072
v_max_f32 v13, v13, v63
Mavvs 104,108,64
Mavvs 108,108,68
R4 104,8,4096
Mavvs 112,112,64
v_cmp_lt_f32_e64 vcc, s56, v13
Mavvs 116,112,68
R4 108,8,5120
Mavvs 120,116,64
Mavvs 124,116,68
Mvvvs 80,16,64
LW 2
Mvvvs 84,16,68
R4 112,8,6144
s_cbranch_vccnz CS_71
CB_70:
Mvvvc 32,88,128,72
v_exp_f32_e64 v48, v48
Mvvvc 36,88,132,76
R4 116,8,7168
Mvvvs 32,92,136
v_exp_f32_e64 v49, v49
Mvvvs 36,92,140
R4 88,8,8192
CV 64,48,49
Mvvvs 32,96,144
v_exp_f32_e64 v50, v50
Mvvvs 36,96,148
R4 92,8,9216
Mvvvs 32,100,152
LW 2
v_exp_f32 v51, v51
Mvvvs 36,100,156
R4 96,8,10240
CV 65,50,51
Mvvvs 32,104,160
v_exp_f32_e64 v56, v56
Mvvvs 36,104,164
R4 100,8,11264
Mvvvs 32,108,168
v_exp_f32_e64 v57, v57
Mvvvs 36,108,172
R4 104,8,12288
CV 66,56,57
Mvvvs 32,112,176
v_exp_f32_e64 v58, v58
Mvvvs 36,112,180
R4 108,8,13312
Mvvvs 32,116,184
LW 2
v_exp_f32 v59, v59
Mvvvs 36,116,188
R4 112,8,14336
CV 67,58,59
Mvvvc 40,88,128,72
v_exp_f32_e64 v52, v52
Mvvvc 44,88,132,76
R4 116,8,15360
Mvvvs 40,92,136
v_exp_f32_e64 v53, v53
Mvvvs 44,92,140
R4 88,9,16384
CV 68,52,53
Mvvvs 40,96,144
v_exp_f32_e64 v54, v54
Mvvvs 44,96,148
R4 92,9,17408
Mvvvs 40,100,152
LW 2
v_exp_f32 v55, v55
Mvvvs 44,100,156
R4 96,9,18432
CV 69,54,55
Mvvvs 40,104,160
v_exp_f32_e64 v60, v60
Mvvvs 44,104,164
R4 100,9,19456
Mvvvs 40,108,168
v_exp_f32_e64 v61, v61
Mvvvs 44,108,172
R4 104,9,20480
CV 70,60,61
Mvvvs 40,112,176
v_exp_f32_e64 v62, v62
Mvvvs 44,112,180
R4 108,9,21504
Mvvvs 40,116,184
LW 2
v_exp_f32 v63, v63
Mvvvs 44,116,188
R4 112,9,22528
CV 71,62,63
Mavvs 0,88,64
s_add_u32 m0, s59, 65536
s_add_u32 s58, s58, 32768
Mavvs 4,88,68
R4 116,9,23552
Mavvs 8,92,64
s_waitcnt vmcnt(12)
s_barrier
Mavvs 12,92,68
R4 88,9,24576
Mavvs 16,96,64
buffer_load_dwordx4 v10, s[4:7], s58 offen sc1 lds
Mavvs 20,96,68
R4 92,9,25600
Mavvs 24,100,64
LW 2
v_mov_b32 v11, v12
v_cmp_gt_i32 s[86:87], 0, v11
Mavvs 28,100,68
R4 96,9,26624
v_cmp_gt_i32 s[88:89], 1, v11
Mavvs 32,104,64
buffer_load_dwordx4 v10, s[4:7], s58 offen offset:1024 sc1 lds
Mavvs 36,104,68
R4 100,9,27648
v_cmp_gt_i32 s[90:91], 2, v11
Mavvs 40,108,64
buffer_load_dwordx4 v10, s[4:7], s58 offen offset:2048 sc1 lds
Mavvs 44,108,68
R4 104,9,28672
v_cmp_gt_i32 s[92:93], 3, v11
Mavvs 48,112,64
buffer_load_dwordx4 v10, s[4:7], s58 offen offset:3072 sc1 lds
Mavvs 52,112,68
R4 108,9,29696
v_cndmask_b32 v32, v32, v14, s[86:87]
Mavvs 56,116,64
LW 2
v_cndmask_b32 v33, v33, v14, s[88:89]
v_cndmask_b32 v34, v34, v14, s[90:91]
Mavvs 60,116,68
R4 112,9,30720
v_cndmask_b32 v35, v35, v14, s[92:93]
Mavvs 64,88,64
v_cmp_gt_i32 s[86:87], 16, v11
v_cmp_gt_i32 s[88:89], 17, v11
Mavvs 68,88,68
R4 116,9,31744
v_cmp_gt_i32 s[90:91], 18, v11
Mavvs 72,92,64
v_cmp_gt_i32 s[92:93], 19, v11
v_cndmask_b32 v40, v40, v14, s[86:87]
Mavvs 76,92,68
R4 88,8,16384
v_cndmask_b32 v41, v41, v14, s[88:89]
Mavvs 80,96,64
v_cndmask_b32 v42, v42, v14, s[90:91]
Mavvs 84,96,68
R4 92,8,17408
v_cndmask_b32 v43, v43, v14, s[92:93]
Mavvs 88,100,64
LW 2
v_max3_f32 v13, v32, v33, v34
Mavvs 92,100,68
R4 96,8,18432
v_max3_f32 v13, v13, v35, v36
Mavvs 96,104,64
v_max3_f32 v13, v13, v37, v38
Mavvs 100,104,68
R4 100,8,19456
v_max3_f32 v13, v13, v39, v40
Mavvs 104,108,64
s_xor_b32 s59, s59, 0x8000
v_max3_f32 v13, v13, v41, v42
Mavvs 108,108,68
R4 104,8,20480
v_max3_f32 v13, v13, v43, v44
Mavvs 112,112,64
s_xor_b32 s60, s60, 0x8000
v_max3_f32 v13, v13, v45, v46
Mavvs 116,112,68
R4 108,8,21504
v_max_f32_e64 v13, v13, v47
Mavvs 120,116,64
v_cmp_lt_f32_e64 vcc, s56, v13
Mavvs 124,116,68
Mvvvs 80,16,64
LW 2
Mvvvs 84,16,68
R4 112,8,22528
s_cbranch_vccnz CS_73
CB_72:
CT4_63:
s_mul_i32 s71, s54, 135168
s_mul_i32 s76, s44, 33792
s_add_u32 s71, s71, s76
s_add_u32 s71, s71, 0x2400000
s_cmp_eq_u32 s63, 0
s_cselect_b32 s71, 0x70000000, s71
s_cmp_eq_u32 s63, 0
s_cbranch_scc1 NMC_74
s_waitcnt vmcnt(12)
s_cmp_lg_u32 s44, 0
s_cbranch_scc1 WOK_75
s_mov_b32 s73, 0
WSP_76:
v_cmp_eq_u32 vcc, v7, v6
s_and_b32 s72, vcc_lo, 0x1
s_cmp_eq_u32 s72, 0x1
s_cbranch_scc1 WOK_75
s_sleep 8
buffer_load_dword v7, v30, s[4:7], s70 offen sc1
s_waitcnt vmcnt(0)
s_add_u32 s73, s73, 1
s_cmp_lt_u32 s73, 20000
s_cbranch_scc1 WSP_76
WOK_75:
NMC_74:
Mvvvc 48,88,128,72
v_exp_f32_e64 v32, v32
Mvvvc 52,88,132,76
R4 116,8,23552
v_lshrrev_b32_e64 v2, 3, v1
Mvvvs 48,92,136
v_exp_f32_e64 v33, v33
Mvvvs 52,92,140
R4 88,8,24576
CV 64,32,33
Mvvvs 48,96,144
v_exp_f32_e64 v34, v34
Mvvvs 52,96,148
R4 92,8,25600
v_mul_u32_u24 v3, 896, v2
Mvvvs 48,100,152
LW 2
v_exp_f32 v35, v35
Mvvvs 52,100,156
R4 96,8,26624
CV 65,34,35
Mvvvs 48,104,160
v_exp_f32_e64 v40, v40
Mvvvs 52,104,164
R4 100,8,27648
v_bfe_u32 v2, v1, 4, 2
v_bfe_u32 v120, v1, 1, 2
Mvvvs 48,108,168
v_exp_f32_e64 v41, v41
Mvvvs 52,108,172
R4 104,8,28672
CV 66,40,41
Mvvvs 48,112,176
v_exp_f32_e64 v42, v42
Mvvvs 52,112,180
R4 108,8,29696
v_xor_b32 v2, v2, v120
v_and_b32 v120, 1, v1
Mvvvs 48,116,184
LW 2
v_exp_f32 v43, v43
Mvvvs 52,116,188
R4 112,8,30720
CV 67,42,43
v_lshl_add_u32 v2, v2, 1, v120
Mvvvc 56,88,128,72
v_exp_f32_e64 v36, v36
Mvvvc 60,88,132,76
R4 116,8,31744
v_xor_b32 v9, 0x8000, v9
Mvvvs 56,92,136
v_exp_f32_e64 v37, v37
Mvvvs 60,92,140
R4 88,9,0
CV 68,36,37
Mvvvs 56,96,144
v_exp_f32_e64 v38, v38
Mvvvs 60,96,148
R4 92,9,1024
v_lshl_add_u32 v3, v2, 4, v3
Mvvvs 56,100,152
LW 2
v_exp_f32 v39, v39
Mvvvs 60,100,156
R4 96,9,2048
CV 69,38,39
Mvvvs 56,104,160
v_exp_f32_e64 v44, v44
Mvvvs 60,104,164
R4 100,9,3072
v_add_u32_e64 v120, 0, v3
v_add_u32 v121, 6144, v3
Mvvvs 56,108,168
v_exp_f32_e64 v45, v45
Mvvvs 60,108,172
R4 104,9,4096
CV 70,44,45
Mvvvs 56,112,176
v_exp_f32_e64 v46, v46
Mvvvs 60,112,180
R4 108,9,5120
v_add_u32 v122, 12288, v3
v_add_u32 v123, 18432, v3
Mvvvs 56,116,184
LW 2
v_exp_f32 v47, v47
Mvvvs 60,116,188
R4 112,9,6144
CV 71,46,47
Mavvs 0,88,64
s_add_u32 m0, s60, 81920
s_add_u32 s58, s58, 32768
Mavvs 4,88,68
R4 116,9,7168
Mavvs 8,92,64
s_waitcnt vmcnt(8)
s_barrier
Mavvs 12,92,68
R4 88,9,8192
Mavvs 16,96,64
buffer_load_dwordx4 v10, s[4:7], s58 offen sc1 lds
Mavvs 20,96,68
R4 92,9,9216
Mavvs 24,100,64
LW 2
v_subrev_u32 v11, 32, v12
v_cmp_gt_i32 s[86:87], 0, v11
Mavvs 28,100,68
R4 96,9,10240
v_cmp_gt_i32 s[88:89], 1, v11
Mavvs 32,104,64
buffer_load_dwordx4 v10, s[4:7], s58 offen offset:1024 sc1 lds
Mavvs 36,104,68
R4 100,9,11264
v_cmp_gt_i32 s[90:91], 2, v11
Mavvs 40,108,64
buffer_load_dwordx4 v10, s[4:7], s58 offen offset:2048 sc1 lds
Mavvs 44,108,68
R4 104,9,12288
v_cmp_gt_i32 s[92:93], 3, v11
Mavvs 48,112,64
buffer_load_dwordx4 v10, s[4:7], s58 offen offset:3072 sc1 lds
Mavvs 52,112,68
R4 108,9,13312
v_cndmask_b32 v48, v48, v14, s[86:87]
Mavvs 56,116,64
LW 2
s_add_u32 s76, s71, 32768
v_cndmask_b32 v49, v49, v14, s[88:89]
Mavvs 60,116,68
R4 112,9,14336
v_cndmask_b32 v50, v50, v14, s[90:91]
v_cndmask_b32 v51, v51, v14, s[92:93]
Mavvs 64,88,64
buffer_load_dwordx4 v[124:127], v4, s[4:7], s76 offen sc1
Mavvs 68,88,68
R4 116,9,15360
v_xor_b32 v8, 0x8000, v8
Mavvs 72,92,64
buffer_load_dwordx4 v[192:195], v4, s[4:7], s71 offen offset:0 sc1
Mavvs 76,92,68
R4 88,8,0
v_cmp_gt_i32 s[86:87], 16, v11
v_cmp_gt_i32 s[88:89], 17, v11
Mavvs 80,96,64
buffer_load_dwordx4 v[196:199], v4, s[4:7], s71 offen offset:1024 sc1
Mavvs 84,96,68
R4 92,8,1024
v_cmp_gt_i32 s[90:91], 18, v11
Mavvs 88,100,64
LW 2
v_cmp_gt_i32 s[92:93], 19, v11
v_cndmask_b32 v56, v56, v14, s[86:87]
Mavvs 92,100,68
R4 96,8,2048
v_cndmask_b32 v57, v57, v14, s[88:89]
Mavvs 96,104,64
buffer_load_dwordx4 v[200:203], v4, s[4:7], s71 offen offset:2048 sc1
Mavvs 100,104,68
R4 100,8,3072
v_cndmask_b32 v58, v58, v14, s[90:91]
v_cndmask_b32 v59, v59, v14, s[92:93]
Mavvs 104,108,64
buffer_load_dwordx4 v[204:207], v4, s[4:7], s71 offen offset:3072 sc1
Mavvs 108,108,68
R4 104,8,4096
s_add_u32 s71, s71, 4096
v_max3_f32 v13, v48, v49, v50
Mavvs 112,112,64
buffer_load_dwordx4 v[208:211], v4, s[4:7], s71 offen offset:0 sc1
Mavvs 116,112,68
R4 108,8,5120
v_max3_f32 v13, v13, v51, v52
v_max3_f32 v13, v13, v53, v54
Mavvs 120,116,64
buffer_load_dwordx4 v[212:215], v4, s[4:7], s71 offen offset:1024 sc1
Mavvs 124,116,68
v_max3_f32 v13, v13, v55, v56
v_max3_f32 v13, v13, v57, v58
Mvvvs 80,16,64
LW 4
v_max3_f32 v13, v13, v59, v60
v_max3_f32 v13, v13, v61, v62
Mvvvs 84,16,68
R4 112,8,6144
v_max_f32 v13, v13, v63
v_cmp_lt_f32 vcc, s56, v13
s_cbranch_vccnz CS_78
CB_77:
Mvvvc 36,88,132,76
R4 116,8,7168
v_exp_f32_e64 v48, v48
Mvvvs 36,92,140
LW 4
R4 88,8,8192
Mvvvs 36,96,148
R4 92,8,9216
v_exp_f32 v49, v49
Mvvvs 36,100,156
LW 4
R4 96,8,10240
Mvvvs 36,104,164
R4 100,8,11264
v_exp_f32 v50, v50
Mvvvs 36,108,172
LW 4
R4 104,8,12288
Mvvvs 36,112,180
R4 108,8,13312
CV 64,48,49
v_exp_f32 v51, v51
Mvvvs 36,116,188
LW 4
R4 112,8,14336
v_exp_f32 v56, v56
CV 65,50,51
Mvvvc 44,88,132,76
R4 116,8,15360
v_exp_f32 v57, v57
v_exp_f32 v58, v58
Mvvvs 44,92,140
LW 4
R4 88,9,16384
CV 66,56,57
v_exp_f32 v59, v59
Mvvvs 44,96,148
R4 92,9,17408
v_exp_f32_e64 v52, v52
Mvvvs 44,100,156
LW 4
R4 96,9,18432
CV 67,58,59
v_exp_f32 v53, v53
Mvvvs 44,104,164
R4 100,9,19456
v_exp_f32_e64 v54, v54
CV 68,52,53
Mvvvs 44,108,172
LW 4
R4 104,9,20480
v_exp_f32 v55, v55
v_exp_f32_e64 v60, v60
CV 69,54,55
v_exp_f32 v61, v61
v_exp_f32 v62, v62
CV 70,60,61
v_exp_f32 v63, v63
s_nop 0
CV 71,62,63
Mvvvs 44,112,180
R4 108,9,21504
Mvvvs 44,116,188
LW 2
R4 112,9,22528
Mavvs 0,88,64
s_nop 0
Mavvs 4,88,68
R4 116,9,23552
Mavvs 8,92,64
s_waitcnt vmcnt(11)
s_barrier
Mavvs 12,92,68
R4 88,9,24576
Mavvs 16,96,64
buffer_load_dwordx4 v[216:219], v4, s[4:7], s71 offen offset:2048 sc1
Mavvs 20,96,68
R4 92,9,25600
s_lshl_b32 s77, s45, 8
Mavvs 24,100,64
LW 2
s_lshl_b32 s78, s44, 6
v_mov_b32 v32, 0
Mavvs 28,100,68
R4 96,9,26624
v_mov_b32 v33, 0
v_mov_b32 v34, 0
Mavvs 32,104,64
buffer_load_dwordx4 v[220:223], v4, s[4:7], s71 offen offset:3072 sc1
Mavvs 36,104,68
R4 100,9,27648
s_add_u32 s71, s71, 4096
v_mov_b32_e64 v35, 0
Mavvs 40,108,64
buffer_load_dwordx4 v[224:227], v4, s[4:7], s71 offen offset:0 sc1
Mavvs 44,108,68
R4 104,9,28672
s_add_u32 s77, s77, s78
Mavvs 48,112,64
buffer_load_dwordx4 v[228:231], v4, s[4:7], s71 offen offset:1024 sc1
Mavvs 52,112,68
R4 108,9,29696
v_mov_b32 v40, 0
Mavvs 56,116,64
LW 2
s_mul_i32 s57, s77, 896
v_mov_b32 v41, 0
Mavvs 60,116,68
R4 112,9,30720
v_mov_b32 v42, 0
v_mov_b32 v43, 0
Mavvs 64,88,64
buffer_load_dwordx4 v[232:235], v4, s[4:7], s71 offen offset:2048 sc1
Mavvs 68,88,68
R4 116,9,31744
v_add_u32_e64 v11, s62, v12
v_cmp_gt_i32 s[86:87], 0, v11
Mavvs 72,92,64
buffer_load_dwordx4 v[236:239], v4, s[4:7], s71 offen offset:3072 sc1
Mavvs 76,92,68
R4 88,8,16384
s_add_u32 s71, s71, 4096
v_cmp_gt_i32 s[88:89], 1, v11
v_cmp_gt_i32 s[90:91], 2, v11
Mavvs 80,96,64
buffer_load_dwordx4 v[240:243], v4, s[4:7], s71 offen offset:0 sc1
Mavvs 84,96,68
R4 92,8,17408
s_lshl_b32 s78, s44, 5
v_cmp_gt_i32 s[92:93], 3, v11
Mavvs 88,100,64
LW 2
v_cndmask_b32 v36, v36, v14, s[86:87]
v_cndmask_b32 v37, v37, v14, s[88:89]
Mavvs 92,100,68
R4 96,8,18432
s_add_u32 s77, s98, s78
v_cndmask_b32 v38, v38, v14, s[90:91]
v_cndmask_b32 v39, v39, v14, s[92:93]
Mavvs 96,104,64
buffer_load_dwordx4 v[244:247], v4, s[4:7], s71 offen offset:1024 sc1
Mavvs 100,104,68
R4 100,8,19456
v_cmp_gt_i32 s[86:87], 16, v11
v_cmp_gt_i32 s[88:89], 17, v11
Mavvs 104,108,64
buffer_load_dwordx4 v[248:251], v4, s[4:7], s71 offen offset:2048 sc1
Mavvs 108,108,68
R4 104,8,20480
s_mul_i32 s58, s77, 896
v_cmp_gt_i32 s[90:91], 18, v11
Mavvs 112,112,64
s_xor_b32 s59, s59, 0x8000
s_xor_b32 s60, s60, 0x8000
v_cmp_gt_i32 s[92:93], 19, v11
Mavvs 116,112,68
R4 108,8,21504
v_cndmask_b32 v44, v44, v14, s[86:87]
v_cndmask_b32 v45, v45, v14, s[88:89]
Mavvs 120,116,64
buffer_load_dwordx4 v[252:255], v4, s[4:7], s71 offen offset:3072 sc1
Mavvs 124,116,68
v_cndmask_b32 v46, v46, v14, s[90:91]
v_cndmask_b32 v47, v47, v14, s[92:93]
Mvvvs 80,16,64
LW 4
v_max3_f32 v13, v36, v37, v38
v_max3_f32 v13, v13, v39, v44
Mvvvs 84,16,68
R4 112,8,22528
v_max3_f32 v13, v13, v45, v46
v_max_f32 v13, v13, v47
v_cmp_lt_f32_e64 vcc, s56, v13
s_cbranch_vccnz CS_80
CB_79:
Mvvvc 52,88,132,76
R4 116,8,23552
v_exp_f32_e64 v36, v36
Mvvvs 52,92,140
LW 4
R4 88,8,24576
Mvvvs 52,96,148
R4 92,8,25600
v_exp_f32 v37, v37
Mvvvs 52,100,156
LW 4
R4 96,8,26624
Mvvvs 52,104,164
R4 100,8,27648
v_exp_f32 v38, v38
Mvvvs 52,108,172
LW 4
R4 104,8,28672
Mvvvs 52,112,180
R4 108,8,29696
CV 68,36,37
v_exp_f32 v39, v39
Mvvvs 52,116,188
LW 4
R4 112,8,30720
Mvvvc 60,88,132,76
R4 116,8,31744
v_xor_b32 v9, 0x8000, v9
Mvvvs 60,92,140
LW 4
R4 88,9,0
Mvvvs 60,96,148
R4 92,9,1024
v_exp_f32_e64 v44, v44
Mvvvs 60,100,156
LW 4
R4 96,9,2048
CV 69,38,39
Mvvvs 60,104,164
R4 100,9,3072
v_exp_f32 v45, v45
Mvvvs 60,108,172
LW 4
R4 104,9,4096
v_exp_f32 v46, v46
CV 70,44,45
v_exp_f32 v47, v47
s_nop 0
CV 71,46,47
Mvvvs 60,112,180
R4 108,9,5120
Mvvvs 60,116,188
LW 4
R4 112,9,6144
Mavvs 4,88,68
R4 116,9,7168
s_nop 0
Mavvs 12,92,68
s_waitcnt vmcnt(17)
s_barrier
LW 4
R4 88,9,8192
Mavvs 20,96,68
R4 92,9,9216
s_lshl_b32 s72, s52, 1
Mavvs 28,100,68
LW 4
R4 96,9,10240
Mavvs 36,104,68
R4 100,9,11264
s_add_u32 m0, s72, 0
Mavvs 44,108,68
LW 4
R4 104,9,12288
v_mov_b32 v48, 0
Mavvs 52,112,68
R4 108,9,13312
s_add_u32 s73, s57, 0
buffer_load_dwordx4 v120, s[24:27], s73 offen offset:0 lds
Mavvs 60,116,68
LW 4
R4 112,9,14336
v_mov_b32_e64 v49, 0
Mavvs 68,88,68
R4 116,9,15360
buffer_load_dwordx4 v121, s[24:27], s73 offen offset:1024 lds
Mavvs 76,92,68
LW 4
R4 88,9,16384
v_mov_b32 v50, 0
v_mov_b32 v51, 0
v_mov_b32 v56, 0
Mavvs 84,96,68
R4 92,9,17408
buffer_load_dwordx4 v122, s[24:27], s73 offen offset:2048 lds
Mavvs 92,100,68
LW 4
R4 96,9,18432
v_mov_b32 v57, 0
v_mov_b32 v58, 0
v_mov_b32 v59, 0
v_subrev_u32_e64 v11, 32, v11
v_cmp_gt_i32 s[86:87], 0, v11
Mavvs 100,104,68
R4 100,9,19456
buffer_load_dwordx4 v123, s[24:27], s73 offen offset:3072 lds
Mavvs 108,108,68
LW 4
R4 104,9,20480
v_cmp_gt_i32 s[88:89], 1, v11
v_cmp_gt_i32 s[90:91], 2, v11
v_cmp_gt_i32 s[92:93], 3, v11
Mavvs 116,112,68
R4 108,9,21504
s_add_u32 m0, s72, 4096
v_cndmask_b32 v52, v52, v14, s[86:87]
v_cndmask_b32 v53, v53, v14, s[88:89]
Mavvs 124,116,68
LW 4
s_add_u32 s73, s57, 28672
v_cndmask_b32 v54, v54, v14, s[90:91]
v_cndmask_b32 v55, v55, v14, s[92:93]
v_cmp_gt_i32 s[86:87], 16, v11
v_cmp_gt_i32 s[88:89], 17, v11
v_cmp_gt_i32 s[90:91], 18, v11
v_cmp_gt_i32 s[92:93], 19, v11
v_cndmask_b32 v60, v60, v14, s[86:87]
v_cndmask_b32 v61, v61, v14, s[88:89]
v_cndmask_b32 v62, v62, v14, s[90:91]
v_cndmask_b32 v63, v63, v14, s[92:93]
v_max3_f32 v13, v52, v53, v54
v_max3_f32 v13, v13, v55, v60
v_max3_f32 v13, v13, v61, v62
v_max_f32 v13, v13, v63
v_cmp_lt_f32 vcc, s56, v13
Mvvvs 84,16,68
R4 112,9,22528
buffer_load_dwordx4 v120, s[24:27], s73 offen offset:0 lds
buffer_load_dwordx4 v121, s[24:27], s73 offen offset:1024 lds
s_cbranch_vccnz CS_82
CB_81:
v_exp_f32 v52, v52
v_exp_f32 v53, v53
v_exp_f32 v54, v54
v_exp_f32 v55, v55
v_exp_f32 v60, v60
v_exp_f32 v61, v61
v_exp_f32 v62, v62
v_exp_f32_e64 v63, v63
CV 68,52,53
CV 69,54,55
CV 70,60,61
CV 71,62,63
s_nop 1
Mavvs 4,88,68
R4 116,9,23552
s_nop 0
Mavvs 12,92,68
LW 4
R4 88,9,24576
Mavvs 20,96,68
R4 92,9,25600
buffer_load_dwordx4 v122, s[24:27], s73 offen offset:2048 lds
Mavvs 28,100,68
LW 4
R4 96,9,26624
Mavvs 36,104,68
R4 100,9,27648
buffer_load_dwordx4 v123, s[24:27], s73 offen offset:3072 lds
Mavvs 44,108,68
LW 4
R4 104,9,28672
Mavvs 52,112,68
R4 108,9,29696
s_add_u32 m0, s52, 32768
Mavvs 60,116,68
LW 4
R4 112,9,30720
Mavvs 68,88,68
R4 116,9,31744
s_add_u32 s73, s58, 0
Mavvs 76,92,68
LW 4
Mavvs 84,96,68
buffer_load_dwordx4 v120, s[28:31], s73 offen offset:0 lds
Mavvs 92,100,68
LW 2
Mavvs 100,104,68
buffer_load_dwordx4 v121, s[28:31], s73 offen offset:1024 lds
Mavvs 108,108,68
LW 0
s_xor_b32 s59, s59, 0x8000
s_xor_b32 s60, s60, 0x8000
Mavvs 116,112,68
buffer_load_dwordx4 v122, s[28:31], s73 offen offset:2048 lds
Mavvs 124,116,68
buffer_load_dwordx4 v123, s[28:31], s73 offen offset:3072 lds
Mvvvs 84,16,68
M_D_START:
s_barrier
s_lshl_b32 s72, s52, 1
s_add_u32 m0, s72, 49152
s_add_u32 s73, s57, 128
buffer_load_dwordx4 v120, s[24:27], s73 offen offset:0 lds
buffer_load_dwordx4 v121, s[24:27], s73 offen offset:1024 lds
buffer_load_dwordx4 v122, s[24:27], s73 offen offset:2048 lds
buffer_load_dwordx4 v123, s[24:27], s73 offen offset:3072 lds
s_add_u32 m0, s72, 53248
s_add_u32 s73, s57, 28800
buffer_load_dwordx4 v120, s[24:27], s73 offen offset:0 lds
buffer_load_dwordx4 v121, s[24:27], s73 offen offset:1024 lds
buffer_load_dwordx4 v122, s[24:27], s73 offen offset:2048 lds
buffer_load_dwordx4 v123, s[24:27], s73 offen offset:3072 lds
s_add_u32 m0, s52, 81920
s_add_u32 s73, s58, 128
buffer_load_dwordx4 v120, s[28:31], s73 offen offset:0 lds
buffer_load_dwordx4 v121, s[28:31], s73 offen offset:1024 lds
buffer_load_dwordx4 v122, s[28:31], s73 offen offset:2048 lds
buffer_load_dwordx4 v123, s[28:31], s73 offen offset:3072 lds
s_cmp_lg_u32 s63, 0
s_cbranch_scc0 NOMRG_83
s_waitcnt vmcnt(24)
s_mov_b32 s72, 0xffff0000
v_min_f32 v2, v72, v124
v_sub_f32 v3, v2, v72
v_exp_f32 v8, v3
v_sub_f32 v3, v2, v124
v_exp_f32 v16, v3
s_nop 0
v_mul_f32 v2, v8, v80
v_fmac_f32 v2, v16, v126
v_mul_f32 v2, s101, v2
v_rcp_f32 v2, v2
s_nop 0
v_mul_f32 v8, v8, v2
v_mul_f32 v16, v16, v2
v_mov_b32 v9, v8
v_mov_b32 v17, v16
v_min_f32 v2, v76, v125
v_sub_f32 v3, v2, v76
v_exp_f32 v10, v3
v_sub_f32 v3, v2, v125
v_exp_f32 v18, v3
s_nop 0
v_mul_f32 v2, v10, v84
v_fmac_f32 v2, v18, v127
v_mul_f32 v2, s101, v2
v_rcp_f32 v2, v2
s_nop 0
v_mul_f32 v10, v10, v2
v_mul_f32 v18, v18, v2
v_mov_b32 v11, v10
v_mov_b32_e64 v19, v18
AR 20,0
AR 21,1
AR 22,2
AR 23,3
v_lshlrev_b32 v24, 16, v192
v_and_b32 v25, s72, v192
v_lshlrev_b32 v26, 16, v193
v_and_b32 v27, s72, v193
v_pk_mul_f32 v[20:21], v[20:21], v[8:9]
v_pk_mul_f32 v[22:23], v[22:23], v[8:9]
v_pk_fma_f32 v[20:21], v[24:25], v[16:17], v[20:21]
v_pk_fma_f32 v[22:23], v[26:27], v[16:17], v[22:23]
CV 32,20,21
CV 33,22,23
AR 12,8
AR 13,9
AR 14,10
AR 15,11
v_lshlrev_b32 v24, 16, v196
v_and_b32 v25, s72, v196
v_lshlrev_b32 v26, 16, v197
v_and_b32 v27, s72, v197
v_pk_mul_f32 v[12:13], v[12:13], v[8:9]
v_pk_mul_f32 v[14:15], v[14:15], v[8:9]
v_pk_fma_f32 v[12:13], v[24:25], v[16:17], v[12:13]
v_pk_fma_f32 v[14:15], v[26:27], v[16:17], v[14:15]
CV 34,12,13
CV 35,14,15
AR 20,4
AR 21,5
AR 22,6
AR 23,7
v_lshlrev_b32 v24, 16, v194
v_and_b32 v25, s72, v194
v_lshlrev_b32 v26, 16, v195
v_and_b32 v27, s72, v195
v_pk_mul_f32 v[20:21], v[20:21], v[10:11]
v_pk_mul_f32 v[22:23], v[22:23], v[10:11]
v_pk_fma_f32 v[20:21], v[24:25], v[18:19], v[20:21]
v_pk_fma_f32 v[22:23], v[26:27], v[18:19], v[22:23]
CV 36,20,21
CV 37,22,23
AR 12,12
AR 13,13
AR 14,14
AR 15,15
v_lshlrev_b32 v24, 16, v198
v_and_b32 v25, s72, v198
v_lshlrev_b32 v26, 16, v199
v_and_b32 v27, s72, v199
v_pk_mul_f32 v[12:13], v[12:13], v[10:11]
v_pk_mul_f32 v[14:15], v[14:15], v[10:11]
v_pk_fma_f32 v[12:13], v[24:25], v[18:19], v[12:13]
v_pk_fma_f32 v[14:15], v[26:27], v[18:19], v[14:15]
CV 38,12,13
CV 39,14,15
AR 20,16
AR 21,17
AR 22,18
AR 23,19
v_lshlrev_b32 v24, 16, v200
v_and_b32 v25, s72, v200
v_lshlrev_b32 v26, 16, v201
v_and_b32 v27, s72, v201
v_pk_mul_f32 v[20:21], v[20:21], v[8:9]
v_pk_mul_f32 v[22:23], v[22:23], v[8:9]
v_pk_fma_f32 v[20:21], v[24:25], v[16:17], v[20:21]
v_pk_fma_f32 v[22:23], v[26:27], v[16:17], v[22:23]
CV 40,20,21
CV 41,22,23
AR 12,24
AR 13,25
AR 14,26
AR 15,27
v_lshlrev_b32 v24, 16, v204
v_and_b32 v25, s72, v204
v_lshlrev_b32 v26, 16, v205
v_and_b32 v27, s72, v205
v_pk_mul_f32 v[12:13], v[12:13], v[8:9]
v_pk_mul_f32 v[14:15], v[14:15], v[8:9]
v_pk_fma_f32 v[12:13], v[24:25], v[16:17], v[12:13]
v_pk_fma_f32 v[14:15], v[26:27], v[16:17], v[14:15]
CV 42,12,13
CV 43,14,15
AR 20,20
AR 21,21
AR 22,22
AR 23,23
v_lshlrev_b32 v24, 16, v202
v_and_b32 v25, s72, v202
v_lshlrev_b32 v26, 16, v203
v_and_b32 v27, s72, v203
v_pk_mul_f32 v[20:21], v[20:21], v[10:11]
v_pk_mul_f32 v[22:23], v[22:23], v[10:11]
v_pk_fma_f32 v[20:21], v[24:25], v[18:19], v[20:21]
v_pk_fma_f32 v[22:23], v[26:27], v[18:19], v[22:23]
CV 44,20,21
CV 45,22,23
AR 12,28
AR 13,29
AR 14,30
AR 15,31
v_lshlrev_b32 v24, 16, v206
v_and_b32 v25, s72, v206
v_lshlrev_b32 v26, 16, v207
v_and_b32 v27, s72, v207
v_pk_mul_f32 v[12:13], v[12:13], v[10:11]
v_pk_mul_f32 v[14:15], v[14:15], v[10:11]
v_pk_fma_f32 v[12:13], v[24:25], v[18:19], v[12:13]
v_pk_fma_f32 v[14:15], v[26:27], v[18:19], v[14:15]
CV 46,12,13
CV 47,14,15
AR 20,32
AR 21,33
AR 22,34
AR 23,35
v_lshlrev_b32 v24, 16, v208
v_and_b32 v25, s72, v208
v_lshlrev_b32 v26, 16, v209
v_and_b32 v27, s72, v209
v_pk_mul_f32 v[20:21], v[20:21], v[8:9]
v_pk_mul_f32 v[22:23], v[22:23], v[8:9]
v_pk_fma_f32 v[20:21], v[24:25], v[16:17], v[20:21]
v_pk_fma_f32 v[22:23], v[26:27], v[16:17], v[22:23]
CV 48,20,21
CV 49,22,23
AR 12,40
AR 13,41
AR 14,42
AR 15,43
v_lshlrev_b32 v24, 16, v212
v_and_b32 v25, s72, v212
v_lshlrev_b32 v26, 16, v213
v_and_b32 v27, s72, v213
v_pk_mul_f32 v[12:13], v[12:13], v[8:9]
v_pk_mul_f32 v[14:15], v[14:15], v[8:9]
v_pk_fma_f32 v[12:13], v[24:25], v[16:17], v[12:13]
v_pk_fma_f32 v[14:15], v[26:27], v[16:17], v[14:15]
CV 50,12,13
CV 51,14,15
AR 20,36
AR 21,37
AR 22,38
AR 23,39
v_lshlrev_b32 v24, 16, v210
v_and_b32 v25, s72, v210
v_lshlrev_b32 v26, 16, v211
v_and_b32 v27, s72, v211
v_pk_mul_f32 v[20:21], v[20:21], v[10:11]
v_pk_mul_f32 v[22:23], v[22:23], v[10:11]
v_pk_fma_f32 v[20:21], v[24:25], v[18:19], v[20:21]
v_pk_fma_f32 v[22:23], v[26:27], v[18:19], v[22:23]
CV 52,20,21
CV 53,22,23
AR 12,44
AR 13,45
AR 14,46
AR 15,47
v_lshlrev_b32 v24, 16, v214
v_and_b32 v25, s72, v214
v_lshlrev_b32 v26, 16, v215
v_and_b32 v27, s72, v215
v_pk_mul_f32 v[12:13], v[12:13], v[10:11]
v_pk_mul_f32 v[14:15], v[14:15], v[10:11]
v_pk_fma_f32 v[12:13], v[24:25], v[18:19], v[12:13]
v_pk_fma_f32 v[14:15], v[26:27], v[18:19], v[14:15]
CV 54,12,13
CV 55,14,15
AR 20,48
AR 21,49
AR 22,50
AR 23,51
v_lshlrev_b32 v24, 16, v216
v_and_b32 v25, s72, v216
v_lshlrev_b32 v26, 16, v217
v_and_b32 v27, s72, v217
v_pk_mul_f32 v[20:21], v[20:21], v[8:9]
v_pk_mul_f32 v[22:23], v[22:23], v[8:9]
v_pk_fma_f32 v[20:21], v[24:25], v[16:17], v[20:21]
v_pk_fma_f32 v[22:23], v[26:27], v[16:17], v[22:23]
CV 56,20,21
CV 57,22,23
AR 12,56
AR 13,57
AR 14,58
AR 15,59
v_lshlrev_b32 v24, 16, v220
v_and_b32 v25, s72, v220
v_lshlrev_b32 v26, 16, v221
v_and_b32 v27, s72, v221
v_pk_mul_f32 v[12:13], v[12:13], v[8:9]
v_pk_mul_f32 v[14:15], v[14:15], v[8:9]
v_pk_fma_f32 v[12:13], v[24:25], v[16:17], v[12:13]
v_pk_fma_f32 v[14:15], v[26:27], v[16:17], v[14:15]
CV 58,12,13
CV 59,14,15
AR 20,52
AR 21,53
AR 22,54
AR 23,55
v_lshlrev_b32 v24, 16, v218
v_and_b32 v25, s72, v218
v_lshlrev_b32 v26, 16, v219
v_and_b32 v27, s72, v219
v_pk_mul_f32 v[20:21], v[20:21], v[10:11]
v_pk_mul_f32 v[22:23], v[22:23], v[10:11]
v_pk_fma_f32 v[20:21], v[24:25], v[18:19], v[20:21]
v_pk_fma_f32 v[22:23], v[26:27], v[18:19], v[22:23]
CV 60,20,21
CV 61,22,23
AR 12,60
AR 13,61
AR 14,62
AR 15,63
v_lshlrev_b32 v24, 16, v222
v_and_b32 v25, s72, v222
v_lshlrev_b32 v26, 16, v223
v_and_b32 v27, s72, v223
v_pk_mul_f32 v[12:13], v[12:13], v[10:11]
v_pk_mul_f32 v[14:15], v[14:15], v[10:11]
v_pk_fma_f32 v[12:13], v[24:25], v[18:19], v[12:13]
v_pk_fma_f32 v[14:15], v[26:27], v[18:19], v[14:15]
CV 62,12,13
CV 63,14,15
AR 20,64
AR 21,65
AR 22,66
AR 23,67
v_lshlrev_b32 v24, 16, v224
v_and_b32 v25, s72, v224
v_lshlrev_b32 v26, 16, v225
v_and_b32 v27, s72, v225
v_pk_mul_f32 v[20:21], v[20:21], v[8:9]
v_pk_mul_f32 v[22:23], v[22:23], v[8:9]
v_pk_fma_f32 v[20:21], v[24:25], v[16:17], v[20:21]
v_pk_fma_f32 v[22:23], v[26:27], v[16:17], v[22:23]
CV 64,20,21
CV 65,22,23
AR 12,72
AR 13,73
AR 14,74
AR 15,75
v_lshlrev_b32 v24, 16, v228
v_and_b32 v25, s72, v228
v_lshlrev_b32 v26, 16, v229
v_and_b32 v27, s72, v229
v_pk_mul_f32 v[12:13], v[12:13], v[8:9]
v_pk_mul_f32 v[14:15], v[14:15], v[8:9]
v_pk_fma_f32 v[12:13], v[24:25], v[16:17], v[12:13]
v_pk_fma_f32 v[14:15], v[26:27], v[16:17], v[14:15]
CV 66,12,13
CV 67,14,15
AR 20,68
AR 21,69
AR 22,70
AR 23,71
v_lshlrev_b32 v24, 16, v226
v_and_b32 v25, s72, v226
v_lshlrev_b32 v26, 16, v227
v_and_b32 v27, s72, v227
v_pk_mul_f32 v[20:21], v[20:21], v[10:11]
v_pk_mul_f32 v[22:23], v[22:23], v[10:11]
v_pk_fma_f32 v[20:21], v[24:25], v[18:19], v[20:21]
v_pk_fma_f32 v[22:23], v[26:27], v[18:19], v[22:23]
CV 68,20,21
CV 69,22,23
AR 12,76
AR 13,77
AR 14,78
AR 15,79
v_lshlrev_b32 v24, 16, v230
v_and_b32 v25, s72, v230
v_lshlrev_b32 v26, 16, v231
v_and_b32 v27, s72, v231
v_pk_mul_f32 v[12:13], v[12:13], v[10:11]
v_pk_mul_f32 v[14:15], v[14:15], v[10:11]
v_pk_fma_f32 v[12:13], v[24:25], v[18:19], v[12:13]
v_pk_fma_f32 v[14:15], v[26:27], v[18:19], v[14:15]
CV 70,12,13
CV 71,14,15
AR 20,80
AR 21,81
AR 22,82
AR 23,83
v_lshlrev_b32 v24, 16, v232
v_and_b32 v25, s72, v232
v_lshlrev_b32 v26, 16, v233
v_and_b32 v27, s72, v233
v_pk_mul_f32 v[20:21], v[20:21], v[8:9]
v_pk_mul_f32 v[22:23], v[22:23], v[8:9]
v_pk_fma_f32 v[20:21], v[24:25], v[16:17], v[20:21]
v_pk_fma_f32 v[22:23], v[26:27], v[16:17], v[22:23]
CV 72,20,21
CV 73,22,23
AR 12,88
AR 13,89
AR 14,90
AR 15,91
v_lshlrev_b32 v24, 16, v236
v_and_b32 v25, s72, v236
v_lshlrev_b32 v26, 16, v237
v_and_b32 v27, s72, v237
v_pk_mul_f32 v[12:13], v[12:13], v[8:9]
v_pk_mul_f32 v[14:15], v[14:15], v[8:9]
v_pk_fma_f32 v[12:13], v[24:25], v[16:17], v[12:13]
v_pk_fma_f32 v[14:15], v[26:27], v[16:17], v[14:15]
CV 74,12,13
CV 75,14,15
AR 20,84
AR 21,85
AR 22,86
AR 23,87
v_lshlrev_b32 v24, 16, v234
v_and_b32 v25, s72, v234
v_lshlrev_b32 v26, 16, v235
v_and_b32 v27, s72, v235
v_pk_mul_f32 v[20:21], v[20:21], v[10:11]
v_pk_mul_f32 v[22:23], v[22:23], v[10:11]
v_pk_fma_f32 v[20:21], v[24:25], v[18:19], v[20:21]
v_pk_fma_f32 v[22:23], v[26:27], v[18:19], v[22:23]
CV 76,20,21
CV 77,22,23
AR 12,92
AR 13,93
AR 14,94
AR 15,95
v_lshlrev_b32 v24, 16, v238
v_and_b32 v25, s72, v238
v_lshlrev_b32 v26, 16, v239
v_and_b32 v27, s72, v239
v_pk_mul_f32 v[12:13], v[12:13], v[10:11]
v_pk_mul_f32 v[14:15], v[14:15], v[10:11]
v_pk_fma_f32 v[12:13], v[24:25], v[18:19], v[12:13]
v_pk_fma_f32 v[14:15], v[26:27], v[18:19], v[14:15]
CV 78,12,13
CV 79,14,15
AR 20,96
AR 21,97
AR 22,98
AR 23,99
v_lshlrev_b32 v24, 16, v240
v_and_b32 v25, s72, v240
v_lshlrev_b32 v26, 16, v241
v_and_b32 v27, s72, v241
v_pk_mul_f32 v[20:21], v[20:21], v[8:9]
v_pk_mul_f32 v[22:23], v[22:23], v[8:9]
v_pk_fma_f32 v[20:21], v[24:25], v[16:17], v[20:21]
v_pk_fma_f32 v[22:23], v[26:27], v[16:17], v[22:23]
CV 80,20,21
CV 81,22,23
AR 12,104
AR 13,105
AR 14,106
AR 15,107
v_lshlrev_b32 v24, 16, v244
v_and_b32 v25, s72, v244
v_lshlrev_b32 v26, 16, v245
v_and_b32 v27, s72, v245
v_pk_mul_f32 v[12:13], v[12:13], v[8:9]
v_pk_mul_f32 v[14:15], v[14:15], v[8:9]
v_pk_fma_f32 v[12:13], v[24:25], v[16:17], v[12:13]
v_pk_fma_f32 v[14:15], v[26:27], v[16:17], v[14:15]
CV 82,12,13
CV 83,14,15
AR 20,100
AR 21,101
AR 22,102
AR 23,103
v_lshlrev_b32 v24, 16, v242
v_and_b32 v25, s72, v242
v_lshlrev_b32 v26, 16, v243
v_and_b32 v27, s72, v243
v_pk_mul_f32 v[20:21], v[20:21], v[10:11]
v_pk_mul_f32 v[22:23], v[22:23], v[10:11]
v_pk_fma_f32 v[20:21], v[24:25], v[18:19], v[20:21]
v_pk_fma_f32 v[22:23], v[26:27], v[18:19], v[22:23]
CV 84,20,21
CV 85,22,23
AR 12,108
AR 13,109
AR 14,110
AR 15,111
v_lshlrev_b32 v24, 16, v246
v_and_b32 v25, s72, v246
v_lshlrev_b32 v26, 16, v247
v_and_b32 v27, s72, v247
v_pk_mul_f32 v[12:13], v[12:13], v[10:11]
v_pk_mul_f32 v[14:15], v[14:15], v[10:11]
v_pk_fma_f32 v[12:13], v[24:25], v[18:19], v[12:13]
v_pk_fma_f32 v[14:15], v[26:27], v[18:19], v[14:15]
CV 86,12,13
CV 87,14,15
AR 20,112
AR 21,113
AR 22,114
AR 23,115
v_lshlrev_b32 v24, 16, v248
v_and_b32 v25, s72, v248
v_lshlrev_b32 v26, 16, v249
v_and_b32 v27, s72, v249
v_pk_mul_f32 v[20:21], v[20:21], v[8:9]
v_pk_mul_f32 v[22:23], v[22:23], v[8:9]
v_pk_fma_f32 v[20:21], v[24:25], v[16:17], v[20:21]
v_pk_fma_f32 v[22:23], v[26:27], v[16:17], v[22:23]
CV 88,20,21
CV 89,22,23
AR 12,120
AR 13,121
AR 14,122
AR 15,123
v_lshlrev_b32 v24, 16, v252
v_and_b32 v25, s72, v252
v_lshlrev_b32 v26, 16, v253
v_and_b32 v27, s72, v253
v_pk_mul_f32 v[12:13], v[12:13], v[8:9]
v_pk_mul_f32 v[14:15], v[14:15], v[8:9]
v_pk_fma_f32 v[12:13], v[24:25], v[16:17], v[12:13]
v_pk_fma_f32 v[14:15], v[26:27], v[16:17], v[14:15]
CV 90,12,13
CV 91,14,15
AR 20,116
AR 21,117
AR 22,118
AR 23,119
v_lshlrev_b32 v24, 16, v250
v_and_b32 v25, s72, v250
v_lshlrev_b32 v26, 16, v251
v_and_b32 v27, s72, v251
v_pk_mul_f32 v[20:21], v[20:21], v[10:11]
v_pk_mul_f32 v[22:23], v[22:23], v[10:11]
v_pk_fma_f32 v[20:21], v[24:25], v[18:19], v[20:21]
v_pk_fma_f32 v[22:23], v[26:27], v[18:19], v[22:23]
CV 92,20,21
CV 93,22,23
AR 12,124
AR 13,125
AR 14,126
AR 15,127
v_lshlrev_b32 v24, 16, v254
v_and_b32 v25, s72, v254
v_lshlrev_b32 v26, 16, v255
v_and_b32 v27, s72, v255
v_pk_mul_f32 v[12:13], v[12:13], v[10:11]
v_pk_mul_f32 v[14:15], v[14:15], v[10:11]
v_pk_fma_f32 v[12:13], v[24:25], v[18:19], v[12:13]
v_pk_fma_f32 v[14:15], v[26:27], v[18:19], v[14:15]
CV 94,12,13
CV 95,14,15
s_branch FIN_84
NOMRG_83:
v_mul_f32 v80, s101, v80
v_mul_f32 v84, s101, v84
v_rcp_f32 v8, v80
v_rcp_f32 v10, v84
s_nop 0
v_mov_b32 v9, v8
v_mov_b32 v11, v10
AR 20,0
AR 21,1
AR 22,2
AR 23,3
v_pk_mul_f32 v[20:21], v[20:21], v[8:9]
v_pk_mul_f32 v[22:23], v[22:23], v[8:9]
CV 32,20,21
CV 33,22,23
AR 12,8
AR 13,9
AR 14,10
AR 15,11
v_pk_mul_f32 v[12:13], v[12:13], v[8:9]
v_pk_mul_f32 v[14:15], v[14:15], v[8:9]
CV 34,12,13
CV 35,14,15
AR 20,4
AR 21,5
AR 22,6
AR 23,7
v_pk_mul_f32 v[20:21], v[20:21], v[10:11]
v_pk_mul_f32 v[22:23], v[22:23], v[10:11]
CV 36,20,21
CV 37,22,23
AR 12,12
AR 13,13
AR 14,14
AR 15,15
v_pk_mul_f32 v[12:13], v[12:13], v[10:11]
v_pk_mul_f32 v[14:15], v[14:15], v[10:11]
CV 38,12,13
CV 39,14,15
AR 20,16
AR 21,17
AR 22,18
AR 23,19
v_pk_mul_f32 v[20:21], v[20:21], v[8:9]
v_pk_mul_f32 v[22:23], v[22:23], v[8:9]
CV 40,20,21
CV 41,22,23
AR 12,24
AR 13,25
AR 14,26
AR 15,27
v_pk_mul_f32 v[12:13], v[12:13], v[8:9]
v_pk_mul_f32 v[14:15], v[14:15], v[8:9]
CV 42,12,13
CV 43,14,15
AR 20,20
AR 21,21
AR 22,22
AR 23,23
v_pk_mul_f32 v[20:21], v[20:21], v[10:11]
v_pk_mul_f32 v[22:23], v[22:23], v[10:11]
CV 44,20,21
CV 45,22,23
AR 12,28
AR 13,29
AR 14,30
AR 15,31
v_pk_mul_f32 v[12:13], v[12:13], v[10:11]
v_pk_mul_f32 v[14:15], v[14:15], v[10:11]
CV 46,12,13
CV 47,14,15
AR 20,32
AR 21,33
AR 22,34
AR 23,35
v_pk_mul_f32 v[20:21], v[20:21], v[8:9]
v_pk_mul_f32 v[22:23], v[22:23], v[8:9]
CV 48,20,21
CV 49,22,23
AR 12,40
AR 13,41
AR 14,42
AR 15,43
v_pk_mul_f32 v[12:13], v[12:13], v[8:9]
v_pk_mul_f32 v[14:15], v[14:15], v[8:9]
CV 50,12,13
CV 51,14,15
AR 20,36
AR 21,37
AR 22,38
AR 23,39
v_pk_mul_f32 v[20:21], v[20:21], v[10:11]
v_pk_mul_f32 v[22:23], v[22:23], v[10:11]
CV 52,20,21
CV 53,22,23
AR 12,44
AR 13,45
AR 14,46
AR 15,47
v_pk_mul_f32 v[12:13], v[12:13], v[10:11]
v_pk_mul_f32 v[14:15], v[14:15], v[10:11]
CV 54,12,13
CV 55,14,15
AR 20,48
AR 21,49
AR 22,50
AR 23,51
v_pk_mul_f32 v[20:21], v[20:21], v[8:9]
v_pk_mul_f32 v[22:23], v[22:23], v[8:9]
CV 56,20,21
CV 57,22,23
AR 12,56
AR 13,57
AR 14,58
AR 15,59
v_pk_mul_f32 v[12:13], v[12:13], v[8:9]
v_pk_mul_f32 v[14:15], v[14:15], v[8:9]
CV 58,12,13
CV 59,14,15
AR 20,52
AR 21,53
AR 22,54
AR 23,55
v_pk_mul_f32 v[20:21], v[20:21], v[10:11]
v_pk_mul_f32 v[22:23], v[22:23], v[10:11]
CV 60,20,21
CV 61,22,23
AR 12,60
AR 13,61
AR 14,62
AR 15,63
v_pk_mul_f32 v[12:13], v[12:13], v[10:11]
v_pk_mul_f32 v[14:15], v[14:15], v[10:11]
CV 62,12,13
CV 63,14,15
AR 20,64
AR 21,65
AR 22,66
AR 23,67
v_pk_mul_f32 v[20:21], v[20:21], v[8:9]
v_pk_mul_f32 v[22:23], v[22:23], v[8:9]
CV 64,20,21
CV 65,22,23
AR 12,72
AR 13,73
AR 14,74
AR 15,75
v_pk_mul_f32 v[12:13], v[12:13], v[8:9]
v_pk_mul_f32 v[14:15], v[14:15], v[8:9]
CV 66,12,13
CV 67,14,15
AR 20,68
AR 21,69
AR 22,70
AR 23,71
v_pk_mul_f32 v[20:21], v[20:21], v[10:11]
v_pk_mul_f32 v[22:23], v[22:23], v[10:11]
CV 68,20,21
CV 69,22,23
AR 12,76
AR 13,77
AR 14,78
AR 15,79
v_pk_mul_f32 v[12:13], v[12:13], v[10:11]
v_pk_mul_f32 v[14:15], v[14:15], v[10:11]
CV 70,12,13
CV 71,14,15
AR 20,80
AR 21,81
AR 22,82
AR 23,83
v_pk_mul_f32 v[20:21], v[20:21], v[8:9]
v_pk_mul_f32 v[22:23], v[22:23], v[8:9]
CV 72,20,21
CV 73,22,23
AR 12,88
AR 13,89
AR 14,90
AR 15,91
v_pk_mul_f32 v[12:13], v[12:13], v[8:9]
v_pk_mul_f32 v[14:15], v[14:15], v[8:9]
CV 74,12,13
CV 75,14,15
AR 20,84
AR 21,85
AR 22,86
AR 23,87
v_pk_mul_f32 v[20:21], v[20:21], v[10:11]
v_pk_mul_f32 v[22:23], v[22:23], v[10:11]
CV 76,20,21
CV 77,22,23
AR 12,92
AR 13,93
AR 14,94
AR 15,95
v_pk_mul_f32 v[12:13], v[12:13], v[10:11]
v_pk_mul_f32 v[14:15], v[14:15], v[10:11]
CV 78,12,13
CV 79,14,15
AR 20,96
AR 21,97
AR 22,98
AR 23,99
v_pk_mul_f32 v[20:21], v[20:21], v[8:9]
v_pk_mul_f32 v[22:23], v[22:23], v[8:9]
CV 80,20,21
CV 81,22,23
AR 12,104
AR 13,105
AR 14,106
AR 15,107
v_pk_mul_f32 v[12:13], v[12:13], v[8:9]
v_pk_mul_f32 v[14:15], v[14:15], v[8:9]
CV 82,12,13
CV 83,14,15
AR 20,100
AR 21,101
AR 22,102
AR 23,103
v_pk_mul_f32 v[20:21], v[20:21], v[10:11]
v_pk_mul_f32 v[22:23], v[22:23], v[10:11]
CV 84,20,21
CV 85,22,23
AR 12,108
AR 13,109
AR 14,110
AR 15,111
v_pk_mul_f32 v[12:13], v[12:13], v[10:11]
v_pk_mul_f32 v[14:15], v[14:15], v[10:11]
CV 86,12,13
CV 87,14,15
AR 20,112
AR 21,113
AR 22,114
AR 23,115
v_pk_mul_f32 v[20:21], v[20:21], v[8:9]
v_pk_mul_f32 v[22:23], v[22:23], v[8:9]
CV 88,20,21
CV 89,22,23
AR 12,120
AR 13,121
AR 14,122
AR 15,123
v_pk_mul_f32 v[12:13], v[12:13], v[8:9]
v_pk_mul_f32 v[14:15], v[14:15], v[8:9]
CV 90,12,13
CV 91,14,15
AR 20,116
AR 21,117
AR 22,118
AR 23,119
v_pk_mul_f32 v[20:21], v[20:21], v[10:11]
v_pk_mul_f32 v[22:23], v[22:23], v[10:11]
CV 92,20,21
CV 93,22,23
AR 12,124
AR 13,125
AR 14,126
AR 15,127
v_pk_mul_f32 v[12:13], v[12:13], v[10:11]
v_pk_mul_f32 v[14:15], v[14:15], v[10:11]
CV 94,12,13
CV 95,14,15
FIN_84:
s_cmp_lg_u32 s99, 0
s_cbranch_scc1 OD_85
v_lshrrev_b32_e64 v2, 2, v1
v_bfe_u32 v3, v1, 3, 2
v_and_b32 v8, 3, v1
v_lshlrev_b32 v8, 3, v8
v_lshl_add_u32 v8, v2, 7, v8
v_xor_b32_e64 v2, 0, v3
v_lshl_add_u32 v24, v2, 5, v8
v_xor_b32_e64 v2, 1, v3
v_lshl_add_u32 v25, v2, 5, v8
v_xor_b32_e64 v2, 2, v3
v_lshl_add_u32 v26, v2, 5, v8
v_xor_b32_e64 v2, 3, v3
v_lshl_add_u32 v27, v2, 5, v8
s_lshl_b32 s72, s48, 3
s_add_u32 s72, s72, s44
s_mul_i32 s72, s72, 229376
s_lshl_b32 s73, s45, 10
s_add_u32 s72, s72, s73
s_add_u32 s60, s72, 0x4000000
s_mul_i32 s72, s3, 229376
v_add_u32 v28, s72, v4
s_lshl_b32 s70, s48, 12
s_add_u32 s70, s70, 0x6140000
s_lshl_b32 s71, s45, 2
s_add_u32 s71, s71, s70
s_waitcnt vmcnt(12)
s_barrier
v_add_u32_e64 v20, 0, v24
RT 176,20,0
RT 178,20,2048
RT 180,20,4096
RT 182,20,6144
RT 184,20,8192
RT 186,20,10240
RT 188,20,12288
RT 190,20,14336
RT 192,20,16384
RT 194,20,18432
RT 196,20,20480
RT 198,20,22528
LW 8
Mvvvz 128,176,32
RT 200,20,24576
s_lshl_b32 s72, s52, 1
Mvvvz 132,176,36
RT 202,20,26624
s_add_u32 m0, s72, 98304
Mvvvs 128,180,40
RT 204,20,28672
s_add_u32 s73, s57, 256
Mvvvs 132,180,44
LW 7
RT 206,20,30720
Mvvvs 128,184,48
buffer_load_dwordx4 v120, s[24:27], s73 offen offset:0 lds
Mvvvs 132,184,52
RT 176,20,32768
RT 178,20,34816
Mvvvs 128,188,56
RT 180,20,36864
Mvvvs 132,188,60
LW 7
RT 182,20,38912
Mvvvs 128,192,64
buffer_load_dwordx4 v121, s[24:27], s73 offen offset:1024 lds
Mvvvs 132,192,68
RT 184,20,40960
RT 186,20,43008
Mvvvs 128,196,72
RT 188,20,45056
Mvvvs 132,196,76
LW 7
RT 190,20,47104
v_add_u32 v21, 0, v25
Mvvvs 128,200,80
buffer_load_dwordx4 v122, s[24:27], s73 offen offset:2048 lds
Mvvvs 132,200,84
RT 192,21,0
RT 194,21,2048
Mvvvs 128,204,88
RT 196,21,4096
Mvvvs 132,204,92
LW 7
RT 198,21,6144
Mvvas 128,176,192
buffer_load_dwordx4 v123, s[24:27], s73 offen offset:3072 lds
Mvvas 132,176,196
RT 200,21,8192
RT 202,21,10240
Mvvas 128,180,200
RT 204,21,12288
s_add_u32 m0, s72, 102400
Mvvas 132,180,204
LW 7
RT 206,21,14336
Mvvas 128,184,208
RT 176,21,16384
s_add_u32 s73, s57, 28928
Mvvas 132,184,212
RT 178,21,18432
buffer_load_dwordx4 v120, s[24:27], s73 offen offset:0 lds
Mvvas 128,188,216
RT 180,21,20480
Mvvas 132,188,220
LW 7
RT 182,21,22528
Mvvvz 136,192,32
buffer_load_dwordx4 v121, s[24:27], s73 offen offset:1024 lds
Mvvvz 140,192,36
RT 184,21,24576
RT 186,21,26624
Mvvvs 136,196,40
RT 188,21,28672
Mvvvs 140,196,44
LW 7
RT 190,21,30720
Mvvvs 136,200,48
buffer_load_dwordx4 v122, s[24:27], s73 offen offset:2048 lds
Mvvvs 140,200,52
RT 192,21,32768
RT 194,21,34816
Mvvvs 136,204,56
RT 196,21,36864
Mvvvs 140,204,60
LW 7
RT 198,21,38912
Mvvvs 136,176,64
buffer_load_dwordx4 v123, s[24:27], s73 offen offset:3072 lds
Mvvvs 140,176,68
RT 200,21,40960
RT 202,21,43008
Mvvvs 136,180,72
RT 204,21,45056
s_add_u32 m0, s52, 131072
Mvvvs 140,180,76
LW 7
RT 206,21,47104
v_add_u32_e64 v22, 0, v26
Mvvvs 136,184,80
RT 176,22,0
s_add_u32 s73, s58, 256
Mvvvs 140,184,84
RT 178,22,2048
Mvvvs 136,188,88
RT 180,22,4096
Mvvvs 140,188,92
LW 7
RT 182,22,6144
Mvvas 136,192,192
buffer_load_dwordx4 v120, s[28:31], s73 offen offset:0 lds
Mvvas 140,192,196
RT 184,22,8192
RT 186,22,10240
Mvvas 136,196,200
RT 188,22,12288
buffer_load_dwordx4 v121, s[28:31], s73 offen offset:1024 lds
Mvvas 140,196,204
LW 7
RT 190,22,14336
Mvvas 136,200,208
buffer_load_dwordx4 v122, s[28:31], s73 offen offset:2048 lds
Mvvas 140,200,212
RT 192,22,16384
RT 194,22,18432
Mvvas 136,204,216
RT 196,22,20480
Mvvas 140,204,220
LW 7
RT 198,22,22528
Mvvvz 144,176,32
buffer_load_dwordx4 v123, s[28:31], s73 offen offset:3072 lds
Mvvvz 148,176,36
RT 200,22,24576
RT 202,22,26624
Mvvvs 144,180,40
RT 204,22,28672
Mvvvs 148,180,44
LW 7
RT 206,22,30720
Mvvvs 144,184,48
RT 176,22,32768
Mvvvs 148,184,52
RT 178,22,34816
Mvvvs 144,188,56
RT 180,22,36864
CV 160,128,129
Mvvvs 148,188,60
LW 7
RT 182,22,38912
Mvvvs 144,192,64
RT 184,22,40960
CV 161,130,131
Mvvvs 148,192,68
RT 186,22,43008
CV 162,136,137
Mvvvs 144,196,72
RT 188,22,45056
CV 163,138,139
Mvvvs 148,196,76
LW 7
RT 190,22,47104
v_add_u32_e64 v23, 0, v27
Mvvvs 144,200,80
RT 192,23,0
s_add_u32 s76, s60, 0
Mvvvs 148,200,84
RT 194,23,2048
Mvvvs 144,204,88
RT 196,23,4096
Mvvvs 148,204,92
LW 7
RT 198,23,6144
Mvvas 144,176,192
buffer_store_dwordx4 v[160:163], v4, s[4:7], s76 offen sc1
Mvvas 148,176,196
RT 200,23,8192
RT 202,23,10240
Mvvas 144,180,200
RT 204,23,12288
CV 164,132,133
Mvvas 148,180,204
LW 7
RT 206,23,14336
Mvvas 144,184,208
RT 176,23,16384
CV 165,134,135
Mvvas 148,184,212
RT 178,23,18432
CV 166,140,141
Mvvas 144,188,216
RT 180,23,20480
CV 167,142,143
Mvvas 148,188,220
LW 7
RT 182,23,22528
Mvvvz 152,192,32
buffer_store_dwordx4 v[164:167], v28, s[4:7], s76 offen sc1
Mvvvz 156,192,36
RT 184,23,24576
RT 186,23,26624
Mvvvs 152,196,40
RT 188,23,28672
Mvvvs 156,196,44
LW 7
RT 190,23,30720
Mvvvs 152,200,48
RT 192,23,32768
Mvvvs 156,200,52
RT 194,23,34816
Mvvvs 152,204,56
RT 196,23,36864
Mvvvs 156,204,60
LW 7
RT 198,23,38912
Mvvvs 152,176,64
RT 200,23,40960
Mvvvs 156,176,68
s_waitcnt vmcnt(14)
s_barrier
RT 202,23,43008
Mvvvs 152,180,72
RT 204,23,45056
Mvvvs 156,180,76
LW 7
RT 206,23,47104
v_add_u32 v20, 49152, v24
Mvvvs 152,184,80
RT 176,20,0
Mvvvs 156,184,84
RT 178,20,2048
Mvvvs 152,188,88
RT 180,20,4096
Mvvvs 156,188,92
LW 7
RT 182,20,6144
Mvvas 152,192,192
RT 184,20,8192
Mvvas 156,192,196
RT 186,20,10240
Mvvas 152,196,200
RT 188,20,12288
Mvvas 156,196,204
LW 7
RT 190,20,14336
Mvvas 152,200,208
RT 192,20,16384
Mvvas 156,200,212
RT 194,20,18432
Mvvas 152,204,216
RT 196,20,20480
Mvvas 156,204,220
LW 7
RT 198,20,22528
Mvvvz 128,176,32
RT 200,20,24576
Mvvvz 132,176,36
s_barrier
RT 202,20,26624
Mvvvs 128,180,40
RT 204,20,28672
s_lshl_b32 s72, s52, 1
Mvvvs 132,180,44
LW 7
RT 206,20,30720
Mvvvs 128,184,48
RT 176,20,32768
s_add_u32 m0, s72, 0
Mvvvs 132,184,52
RT 178,20,34816
s_add_u32 s73, s57, 384
Mvvvs 128,188,56
RT 180,20,36864
CV 168,144,145
Mvvvs 132,188,60
LW 7
RT 182,20,38912
Mvvvs 128,192,64
buffer_load_dwordx4 v120, s[24:27], s73 offen offset:0 lds
Mvvvs 132,192,68
RT 184,20,40960
RT 186,20,43008
Mvvvs 128,196,72
RT 188,20,45056
CV 169,146,147
CV 170,152,153
Mvvvs 132,196,76
LW 7
RT 190,20,47104
v_add_u32 v21, 49152, v25
Mvvvs 128,200,80
buffer_load_dwordx4 v121, s[24:27], s73 offen offset:1024 lds
Mvvvs 132,200,84
RT 192,21,0
RT 194,21,2048
Mvvvs 128,204,88
RT 196,21,4096
CV 171,154,155
s_add_u32 s76, s60, 16384
Mvvvs 132,204,92
LW 7
RT 198,21,6144
buffer_store_dwordx4 v[168:171], v4, s[4:7], s76 offen sc1
Mvvas 128,176,192
buffer_load_dwordx4 v122, s[24:27], s73 offen offset:2048 lds
Mvvas 132,176,196
RT 200,21,8192
RT 202,21,10240
Mvvas 128,180,200
RT 204,21,12288
CV 172,148,149
CV 173,150,151
Mvvas 132,180,204
LW 7
RT 206,21,14336
CV 174,156,157
Mvvas 128,184,208
buffer_load_dwordx4 v123, s[24:27], s73 offen offset:3072 lds
Mvvas 132,184,212
RT 176,21,16384
RT 178,21,18432
Mvvas 128,188,216
RT 180,21,20480
s_add_u32 m0, s72, 4096
CV 175,158,159
Mvvas 132,188,220
LW 7
RT 182,21,22528
Mvvvz 136,192,32
RT 184,21,24576
s_add_u32 s73, s57, 29056
Mvvvz 140,192,36
RT 186,21,26624
buffer_store_dwordx4 v[172:175], v28, s[4:7], s76 offen sc1
Mvvvs 136,196,40
RT 188,21,28672
Mvvvs 140,196,44
LW 7
RT 190,21,30720
Mvvvs 136,200,48
buffer_load_dwordx4 v120, s[24:27], s73 offen offset:0 lds
Mvvvs 140,200,52
RT 192,21,32768
RT 194,21,34816
Mvvvs 136,204,56
RT 196,21,36864
Mvvvs 140,204,60
LW 7
RT 198,21,38912
Mvvvs 136,176,64
buffer_load_dwordx4 v121, s[24:27], s73 offen offset:1024 lds
Mvvvs 140,176,68
RT 200,21,40960
RT 202,21,43008
Mvvvs 136,180,72
RT 204,21,45056
Mvvvs 140,180,76
LW 7
RT 206,21,47104
v_add_u32 v22, 49152, v26
Mvvvs 136,184,80
buffer_load_dwordx4 v122, s[24:27], s73 offen offset:2048 lds
Mvvvs 140,184,84
RT 176,22,0
RT 178,22,2048
Mvvvs 136,188,88
RT 180,22,4096
Mvvvs 140,188,92
LW 7
RT 182,22,6144
Mvvas 136,192,192
buffer_load_dwordx4 v123, s[24:27], s73 offen offset:3072 lds
Mvvas 140,192,196
RT 184,22,8192
RT 186,22,10240
Mvvas 136,196,200
RT 188,22,12288
s_add_u32 m0, s52, 32768
Mvvas 140,196,204
LW 7
RT 190,22,14336
Mvvas 136,200,208
RT 192,22,16384
s_add_u32 s73, s58, 384
Mvvas 140,200,212
RT 194,22,18432
Mvvas 136,204,216
RT 196,22,20480
Mvvas 140,204,220
LW 7
RT 198,22,22528
Mvvvz 144,176,32
buffer_load_dwordx4 v120, s[28:31], s73 offen offset:0 lds
Mvvvz 148,176,36
RT 200,22,24576
RT 202,22,26624
Mvvvs 144,180,40
RT 204,22,28672
Mvvvs 148,180,44
LW 7
RT 206,22,30720
Mvvvs 144,184,48
buffer_load_dwordx4 v121, s[28:31], s73 offen offset:1024 lds
Mvvvs 148,184,52
RT 176,22,32768
RT 178,22,34816
Mvvvs 144,188,56
RT 180,22,36864
CV 160,128,129
Mvvvs 148,188,60
LW 7
RT 182,22,38912
Mvvvs 144,192,64
buffer_load_dwordx4 v122, s[28:31], s73 offen offset:2048 lds
Mvvvs 148,192,68
RT 184,22,40960
RT 186,22,43008
Mvvvs 144,196,72
RT 188,22,45056
CV 161,130,131
CV 162,136,137
Mvvvs 148,196,76
LW 7
RT 190,22,47104
v_add_u32 v23, 49152, v27
Mvvvs 144,200,80
buffer_load_dwordx4 v123, s[28:31], s73 offen offset:3072 lds
Mvvvs 148,200,84
RT 192,23,0
RT 194,23,2048
Mvvvs 144,204,88
RT 196,23,4096
CV 163,138,139
s_add_u32 s76, s60, 32768
Mvvvs 148,204,92
LW 7
RT 198,23,6144
Mvvas 144,176,192
buffer_store_dwordx4 v[160:163], v4, s[4:7], s76 offen sc1
Mvvas 148,176,196
RT 200,23,8192
RT 202,23,10240
Mvvas 144,180,200
RT 204,23,12288
CV 164,132,133
Mvvas 148,180,204
LW 7
RT 206,23,14336
Mvvas 144,184,208
RT 176,23,16384
CV 165,134,135
Mvvas 148,184,212
RT 178,23,18432
CV 166,140,141
Mvvas 144,188,216
RT 180,23,20480
CV 167,142,143
Mvvas 148,188,220
LW 7
RT 182,23,22528
Mvvvz 152,192,32
buffer_store_dwordx4 v[164:167], v28, s[4:7], s76 offen sc1
Mvvvz 156,192,36
RT 184,23,24576
RT 186,23,26624
Mvvvs 152,196,40
RT 188,23,28672
Mvvvs 156,196,44
LW 7
RT 190,23,30720
Mvvvs 152,200,48
RT 192,23,32768
Mvvvs 156,200,52
RT 194,23,34816
Mvvvs 152,204,56
RT 196,23,36864
Mvvvs 156,204,60
LW 7
RT 198,23,38912
Mvvvs 152,176,64
RT 200,23,40960
Mvvvs 156,176,68
s_waitcnt vmcnt(10)
s_waitcnt vmcnt(18)
s_barrier
RT 202,23,43008
Mvvvs 152,180,72
RT 204,23,45056
v_add_u32_e64 v9, 2, v6
Mvvvs 156,180,76
LW 7
RT 206,23,47104
v_add_u32 v20, 98304, v24
Mvvvs 152,184,80
buffer_store_dword v9, v5, s[4:7], s71 offen sc1
Mvvvs 156,184,84
RT 176,20,0
RT 178,20,2048
Mvvvs 152,188,88
RT 180,20,4096
Mvvvs 156,188,92
LW 7
RT 182,20,6144
Mvvas 152,192,192
RT 184,20,8192
Mvvas 156,192,196
RT 186,20,10240
Mvvas 152,196,200
RT 188,20,12288
Mvvas 156,196,204
LW 7
RT 190,20,14336
Mvvas 152,200,208
RT 192,20,16384
Mvvas 156,200,212
RT 194,20,18432
Mvvas 152,204,216
RT 196,20,20480
Mvvas 156,204,220
LW 7
RT 198,20,22528
Mvvvz 128,176,32
RT 200,20,24576
Mvvvz 132,176,36
s_barrier
RT 202,20,26624
Mvvvs 128,180,40
RT 204,20,28672
s_lshl_b32 s72, s52, 1
Mvvvs 132,180,44
LW 7
RT 206,20,30720
Mvvvs 128,184,48
RT 176,20,32768
s_add_u32 m0, s72, 49152
Mvvvs 132,184,52
RT 178,20,34816
s_add_u32 s73, s57, 512
Mvvvs 128,188,56
RT 180,20,36864
CV 168,144,145
Mvvvs 132,188,60
LW 7
RT 182,20,38912
Mvvvs 128,192,64
buffer_load_dwordx4 v120, s[24:27], s73 offen offset:0 lds
Mvvvs 132,192,68
RT 184,20,40960
RT 186,20,43008
Mvvvs 128,196,72
RT 188,20,45056
CV 169,146,147
CV 170,152,153
Mvvvs 132,196,76
LW 7
RT 190,20,47104
v_add_u32 v21, 98304, v25
Mvvvs 128,200,80
buffer_load_dwordx4 v121, s[24:27], s73 offen offset:1024 lds
Mvvvs 132,200,84
RT 192,21,0
RT 194,21,2048
Mvvvs 128,204,88
RT 196,21,4096
CV 171,154,155
s_add_u32 s76, s60, 49152
Mvvvs 132,204,92
LW 7
RT 198,21,6144
buffer_store_dwordx4 v[168:171], v4, s[4:7], s76 offen sc1
Mvvas 128,176,192
buffer_load_dwordx4 v122, s[24:27], s73 offen offset:2048 lds
Mvvas 132,176,196
RT 200,21,8192
RT 202,21,10240
Mvvas 128,180,200
RT 204,21,12288
CV 172,148,149
CV 173,150,151
Mvvas 132,180,204
LW 7
RT 206,21,14336
CV 174,156,157
Mvvas 128,184,208
buffer_load_dwordx4 v123, s[24:27], s73 offen offset:3072 lds
Mvvas 132,184,212
RT 176,21,16384
RT 178,21,18432
Mvvas 128,188,216
RT 180,21,20480
s_add_u32 m0, s72, 53248
CV 175,158,159
Mvvas 132,188,220
LW 7
RT 182,21,22528
Mvvvz 136,192,32
RT 184,21,24576
s_add_u32 s73, s57, 29184
Mvvvz 140,192,36
RT 186,21,26624
buffer_store_dwordx4 v[172:175], v28, s[4:7], s76 offen sc1
Mvvvs 136,196,40
RT 188,21,28672
Mvvvs 140,196,44
LW 7
RT 190,21,30720
Mvvvs 136,200,48
buffer_load_dwordx4 v120, s[24:27], s73 offen offset:0 lds
Mvvvs 140,200,52
RT 192,21,32768
RT 194,21,34816
Mvvvs 136,204,56
RT 196,21,36864
Mvvvs 140,204,60
LW 7
RT 198,21,38912
Mvvvs 136,176,64
buffer_load_dwordx4 v121, s[24:27], s73 offen offset:1024 lds
Mvvvs 140,176,68
RT 200,21,40960
RT 202,21,43008
Mvvvs 136,180,72
RT 204,21,45056
Mvvvs 140,180,76
LW 7
RT 206,21,47104
v_add_u32 v22, 98304, v26
Mvvvs 136,184,80
buffer_load_dwordx4 v122, s[24:27], s73 offen offset:2048 lds
Mvvvs 140,184,84
RT 176,22,0
RT 178,22,2048
Mvvvs 136,188,88
RT 180,22,4096
Mvvvs 140,188,92
LW 7
RT 182,22,6144
Mvvas 136,192,192
buffer_load_dwordx4 v123, s[24:27], s73 offen offset:3072 lds
Mvvas 140,192,196
RT 184,22,8192
RT 186,22,10240
Mvvas 136,196,200
RT 188,22,12288
s_add_u32 m0, s52, 81920
Mvvas 140,196,204
LW 7
RT 190,22,14336
Mvvas 136,200,208
RT 192,22,16384
s_add_u32 s73, s58, 512
Mvvas 140,200,212
RT 194,22,18432
Mvvas 136,204,216
RT 196,22,20480
Mvvas 140,204,220
LW 7
RT 198,22,22528
Mvvvz 144,176,32
buffer_load_dwordx4 v120, s[28:31], s73 offen offset:0 lds
Mvvvz 148,176,36
RT 200,22,24576
RT 202,22,26624
Mvvvs 144,180,40
RT 204,22,28672
Mvvvs 148,180,44
LW 7
RT 206,22,30720
Mvvvs 144,184,48
buffer_load_dwordx4 v121, s[28:31], s73 offen offset:1024 lds
Mvvvs 148,184,52
RT 176,22,32768
RT 178,22,34816
Mvvvs 144,188,56
RT 180,22,36864
CV 160,128,129
Mvvvs 148,188,60
LW 7
RT 182,22,38912
Mvvvs 144,192,64
buffer_load_dwordx4 v122, s[28:31], s73 offen offset:2048 lds
Mvvvs 148,192,68
RT 184,22,40960
RT 186,22,43008
Mvvvs 144,196,72
RT 188,22,45056
CV 161,130,131
CV 162,136,137
Mvvvs 148,196,76
LW 7
RT 190,22,47104
v_add_u32 v23, 98304, v27
Mvvvs 144,200,80
buffer_load_dwordx4 v123, s[28:31], s73 offen offset:3072 lds
Mvvvs 148,200,84
RT 192,23,0
RT 194,23,2048
Mvvvs 144,204,88
RT 196,23,4096
CV 163,138,139
s_add_u32 s76, s60, 65536
Mvvvs 148,204,92
LW 7
RT 198,23,6144
Mvvas 144,176,192
buffer_store_dwordx4 v[160:163], v4, s[4:7], s76 offen sc1
Mvvas 148,176,196
RT 200,23,8192
RT 202,23,10240
Mvvas 144,180,200
RT 204,23,12288
CV 164,132,133
Mvvas 148,180,204
LW 7
RT 206,23,14336
Mvvas 144,184,208
RT 176,23,16384
CV 165,134,135
Mvvas 148,184,212
RT 178,23,18432
CV 166,140,141
Mvvas 144,188,216
RT 180,23,20480
CV 167,142,143
Mvvas 148,188,220
LW 7
RT 182,23,22528
Mvvvz 152,192,32
buffer_store_dwordx4 v[164:167], v28, s[4:7], s76 offen sc1
Mvvvz 156,192,36
RT 184,23,24576
RT 186,23,26624
Mvvvs 152,196,40
RT 188,23,28672
Mvvvs 156,196,44
LW 7
RT 190,23,30720
Mvvvs 152,200,48
RT 192,23,32768
Mvvvs 156,200,52
RT 194,23,34816
Mvvvs 152,204,56
RT 196,23,36864
Mvvvs 156,204,60
LW 7
RT 198,23,38912
Mvvvs 152,176,64
RT 200,23,40960
Mvvvs 156,176,68
s_waitcnt vmcnt(10)
s_waitcnt vmcnt(19)
s_barrier
RT 202,23,43008
Mvvvs 152,180,72
RT 204,23,45056
v_add_u32 v8, 4, v6
Mvvvs 156,180,76
LW 7
RT 206,23,47104
v_add_u32 v20, 0, v24
Mvvvs 152,184,80
buffer_store_dword v8, v5, s[4:7], s71 offen sc1
Mvvvs 156,184,84
RT 176,20,0
RT 178,20,2048
Mvvvs 152,188,88
RT 180,20,4096
Mvvvs 156,188,92
LW 7
RT 182,20,6144
Mvvas 152,192,192
RT 184,20,8192
Mvvas 156,192,196
RT 186,20,10240
Mvvas 152,196,200
RT 188,20,12288
Mvvas 156,196,204
LW 7
RT 190,20,14336
Mvvas 152,200,208
RT 192,20,16384
Mvvas 156,200,212
RT 194,20,18432
Mvvas 152,204,216
RT 196,20,20480
Mvvas 156,204,220
LW 7
RT 198,20,22528
Mvvvz 128,176,32
RT 200,20,24576
Mvvvz 132,176,36
s_barrier
RT 202,20,26624
Mvvvs 128,180,40
RT 204,20,28672
s_lshl_b32 s72, s52, 1
Mvvvs 132,180,44
LW 7
RT 206,20,30720
Mvvvs 128,184,48
RT 176,20,32768
s_add_u32 m0, s72, 98304
Mvvvs 132,184,52
RT 178,20,34816
s_add_u32 s73, s57, 640
Mvvvs 128,188,56
RT 180,20,36864
CV 168,144,145
Mvvvs 132,188,60
LW 7
RT 182,20,38912
Mvvvs 128,192,64
buffer_load_dwordx4 v120, s[24:27], s73 offen offset:0 lds
Mvvvs 132,192,68
RT 184,20,40960
RT 186,20,43008
Mvvvs 128,196,72
RT 188,20,45056
CV 169,146,147
CV 170,152,153
Mvvvs 132,196,76
LW 7
RT 190,20,47104
v_add_u32_e64 v21, 0, v25
Mvvvs 128,200,80
buffer_load_dwordx4 v121, s[24:27], s73 offen offset:1024 lds
Mvvvs 132,200,84
RT 192,21,0
RT 194,21,2048
Mvvvs 128,204,88
RT 196,21,4096
CV 171,154,155
s_add_u32 s76, s60, 81920
Mvvvs 132,204,92
LW 7
RT 198,21,6144
buffer_store_dwordx4 v[168:171], v4, s[4:7], s76 offen sc1
Mvvas 128,176,192
buffer_load_dwordx4 v122, s[24:27], s73 offen offset:2048 lds
Mvvas 132,176,196
RT 200,21,8192
RT 202,21,10240
Mvvas 128,180,200
RT 204,21,12288
CV 172,148,149
CV 173,150,151
Mvvas 132,180,204
LW 7
RT 206,21,14336
CV 174,156,157
Mvvas 128,184,208
buffer_load_dwordx4 v123, s[24:27], s73 offen offset:3072 lds
Mvvas 132,184,212
RT 176,21,16384
RT 178,21,18432
Mvvas 128,188,216
RT 180,21,20480
s_add_u32 m0, s72, 102400
CV 175,158,159
Mvvas 132,188,220
LW 7
RT 182,21,22528
Mvvvz 136,192,32
RT 184,21,24576
s_add_u32 s73, s57, 29312
Mvvvz 140,192,36
RT 186,21,26624
buffer_store_dwordx4 v[172:175], v28, s[4:7], s76 offen sc1
Mvvvs 136,196,40
RT 188,21,28672
Mvvvs 140,196,44
LW 7
RT 190,21,30720
Mvvvs 136,200,48
buffer_load_dwordx4 v120, s[24:27], s73 offen offset:0 lds
Mvvvs 140,200,52
RT 192,21,32768
RT 194,21,34816
Mvvvs 136,204,56
RT 196,21,36864
Mvvvs 140,204,60
LW 7
RT 198,21,38912
Mvvvs 136,176,64
buffer_load_dwordx4 v121, s[24:27], s73 offen offset:1024 lds
Mvvvs 140,176,68
RT 200,21,40960
RT 202,21,43008
Mvvvs 136,180,72
RT 204,21,45056
Mvvvs 140,180,76
LW 7
RT 206,21,47104
v_add_u32_e64 v22, 0, v26
Mvvvs 136,184,80
buffer_load_dwordx4 v122, s[24:27], s73 offen offset:2048 lds
Mvvvs 140,184,84
RT 176,22,0
RT 178,22,2048
Mvvvs 136,188,88
RT 180,22,4096
Mvvvs 140,188,92
LW 7
RT 182,22,6144
Mvvas 136,192,192
buffer_load_dwordx4 v123, s[24:27], s73 offen offset:3072 lds
Mvvas 140,192,196
RT 184,22,8192
RT 186,22,10240
Mvvas 136,196,200
RT 188,22,12288
s_add_u32 m0, s52, 131072
Mvvas 140,196,204
LW 7
RT 190,22,14336
Mvvas 136,200,208
RT 192,22,16384
s_add_u32 s73, s58, 640
Mvvas 140,200,212
RT 194,22,18432
Mvvas 136,204,216
RT 196,22,20480
Mvvas 140,204,220
LW 7
RT 198,22,22528
Mvvvz 144,176,32
buffer_load_dwordx4 v120, s[28:31], s73 offen offset:0 lds
Mvvvz 148,176,36
RT 200,22,24576
RT 202,22,26624
Mvvvs 144,180,40
RT 204,22,28672
Mvvvs 148,180,44
LW 7
RT 206,22,30720
Mvvvs 144,184,48
buffer_load_dwordx4 v121, s[28:31], s73 offen offset:1024 lds
Mvvvs 148,184,52
RT 176,22,32768
RT 178,22,34816
Mvvvs 144,188,56
RT 180,22,36864
CV 160,128,129
Mvvvs 148,188,60
LW 7
RT 182,22,38912
Mvvvs 144,192,64
buffer_load_dwordx4 v122, s[28:31], s73 offen offset:2048 lds
Mvvvs 148,192,68
RT 184,22,40960
RT 186,22,43008
Mvvvs 144,196,72
RT 188,22,45056
CV 161,130,131
CV 162,136,137
Mvvvs 148,196,76
LW 7
RT 190,22,47104
v_add_u32_e64 v23, 0, v27
Mvvvs 144,200,80
buffer_load_dwordx4 v123, s[28:31], s73 offen offset:3072 lds
Mvvvs 148,200,84
RT 192,23,0
RT 194,23,2048
Mvvvs 144,204,88
RT 196,23,4096
CV 163,138,139
s_add_u32 s76, s60, 98304
Mvvvs 148,204,92
LW 7
RT 198,23,6144
Mvvas 144,176,192
buffer_store_dwordx4 v[160:163], v4, s[4:7], s76 offen sc1
Mvvas 148,176,196
RT 200,23,8192
RT 202,23,10240
Mvvas 144,180,200
RT 204,23,12288
CV 164,132,133
Mvvas 148,180,204
LW 7
RT 206,23,14336
Mvvas 144,184,208
RT 176,23,16384
CV 165,134,135
Mvvas 148,184,212
RT 178,23,18432
CV 166,140,141
Mvvas 144,188,216
RT 180,23,20480
CV 167,142,143
Mvvas 148,188,220
LW 7
RT 182,23,22528
Mvvvz 152,192,32
buffer_store_dwordx4 v[164:167], v28, s[4:7], s76 offen sc1
Mvvvz 156,192,36
RT 184,23,24576
RT 186,23,26624
Mvvvs 152,196,40
RT 188,23,28672
Mvvvs 156,196,44
LW 7
RT 190,23,30720
Mvvvs 152,200,48
RT 192,23,32768
Mvvvs 156,200,52
RT 194,23,34816
Mvvvs 152,204,56
RT 196,23,36864
Mvvvs 156,204,60
LW 7
RT 198,23,38912
Mvvvs 152,176,64
RT 200,23,40960
Mvvvs 156,176,68
s_waitcnt vmcnt(10)
s_waitcnt vmcnt(19)
s_barrier
RT 202,23,43008
Mvvvs 152,180,72
RT 204,23,45056
v_add_u32_e64 v9, 6, v6
Mvvvs 156,180,76
LW 7
RT 206,23,47104
v_add_u32 v20, 49152, v24
Mvvvs 152,184,80
buffer_store_dword v9, v5, s[4:7], s71 offen sc1
Mvvvs 156,184,84
RT 176,20,0
RT 178,20,2048
Mvvvs 152,188,88
RT 180,20,4096
Mvvvs 156,188,92
LW 7
RT 182,20,6144
Mvvas 152,192,192
RT 184,20,8192
Mvvas 156,192,196
RT 186,20,10240
Mvvas 152,196,200
RT 188,20,12288
Mvvas 156,196,204
LW 7
RT 190,20,14336
Mvvas 152,200,208
RT 192,20,16384
Mvvas 156,200,212
RT 194,20,18432
Mvvas 152,204,216
RT 196,20,20480
Mvvas 156,204,220
LW 7
RT 198,20,22528
Mvvvz 128,176,32
RT 200,20,24576
Mvvvz 132,176,36
s_barrier
RT 202,20,26624
Mvvvs 128,180,40
RT 204,20,28672
s_lshl_b32 s72, s52, 1
Mvvvs 132,180,44
LW 7
RT 206,20,30720
Mvvvs 128,184,48
RT 176,20,32768
s_add_u32 m0, s72, 0
Mvvvs 132,184,52
RT 178,20,34816
s_add_u32 s73, s57, 768
Mvvvs 128,188,56
RT 180,20,36864
CV 168,144,145
Mvvvs 132,188,60
LW 7
RT 182,20,38912
Mvvvs 128,192,64
buffer_load_dwordx4 v120, s[24:27], s73 offen offset:0 lds
Mvvvs 132,192,68
RT 184,20,40960
RT 186,20,43008
Mvvvs 128,196,72
RT 188,20,45056
CV 169,146,147
CV 170,152,153
Mvvvs 132,196,76
LW 7
RT 190,20,47104
v_add_u32 v21, 49152, v25
Mvvvs 128,200,80
buffer_load_dwordx4 v121, s[24:27], s73 offen offset:1024 lds
Mvvvs 132,200,84
RT 192,21,0
RT 194,21,2048
Mvvvs 128,204,88
RT 196,21,4096
CV 171,154,155
s_add_u32 s76, s60, 114688
Mvvvs 132,204,92
LW 7
RT 198,21,6144
buffer_store_dwordx4 v[168:171], v4, s[4:7], s76 offen sc1
Mvvas 128,176,192
buffer_load_dwordx4 v122, s[24:27], s73 offen offset:2048 lds
Mvvas 132,176,196
RT 200,21,8192
RT 202,21,10240
Mvvas 128,180,200
RT 204,21,12288
CV 172,148,149
CV 173,150,151
Mvvas 132,180,204
LW 7
RT 206,21,14336
CV 174,156,157
Mvvas 128,184,208
buffer_load_dwordx4 v123, s[24:27], s73 offen offset:3072 lds
Mvvas 132,184,212
RT 176,21,16384
RT 178,21,18432
Mvvas 128,188,216
RT 180,21,20480
s_add_u32 m0, s72, 4096
CV 175,158,159
Mvvas 132,188,220
LW 7
RT 182,21,22528
Mvvvz 136,192,32
RT 184,21,24576
s_add_u32 s73, s57, 29440
Mvvvz 140,192,36
RT 186,21,26624
buffer_store_dwordx4 v[172:175], v28, s[4:7], s76 offen sc1
Mvvvs 136,196,40
RT 188,21,28672
Mvvvs 140,196,44
LW 7
RT 190,21,30720
Mvvvs 136,200,48
buffer_load_dwordx4 v120, s[24:27], s73 offen offset:0 lds
Mvvvs 140,200,52
RT 192,21,32768
RT 194,21,34816
Mvvvs 136,204,56
RT 196,21,36864
Mvvvs 140,204,60
LW 7
RT 198,21,38912
Mvvvs 136,176,64
buffer_load_dwordx4 v121, s[24:27], s73 offen offset:1024 lds
Mvvvs 140,176,68
RT 200,21,40960
RT 202,21,43008
Mvvvs 136,180,72
RT 204,21,45056
Mvvvs 140,180,76
LW 7
RT 206,21,47104
v_add_u32 v22, 49152, v26
Mvvvs 136,184,80
buffer_load_dwordx4 v122, s[24:27], s73 offen offset:2048 lds
Mvvvs 140,184,84
RT 176,22,0
RT 178,22,2048
Mvvvs 136,188,88
RT 180,22,4096
Mvvvs 140,188,92
LW 7
RT 182,22,6144
Mvvas 136,192,192
buffer_load_dwordx4 v123, s[24:27], s73 offen offset:3072 lds
Mvvas 140,192,196
RT 184,22,8192
RT 186,22,10240
Mvvas 136,196,200
RT 188,22,12288
s_add_u32 m0, s52, 32768
Mvvas 140,196,204
LW 7
RT 190,22,14336
Mvvas 136,200,208
RT 192,22,16384
s_add_u32 s73, s58, 768
Mvvas 140,200,212
RT 194,22,18432
Mvvas 136,204,216
RT 196,22,20480
Mvvas 140,204,220
LW 7
RT 198,22,22528
Mvvvz 144,176,32
buffer_load_dwordx4 v120, s[28:31], s73 offen offset:0 lds
Mvvvz 148,176,36
RT 200,22,24576
RT 202,22,26624
Mvvvs 144,180,40
RT 204,22,28672
Mvvvs 148,180,44
LW 7
RT 206,22,30720
Mvvvs 144,184,48
buffer_load_dwordx4 v121, s[28:31], s73 offen offset:1024 lds
Mvvvs 148,184,52
RT 176,22,32768
RT 178,22,34816
Mvvvs 144,188,56
RT 180,22,36864
CV 160,128,129
Mvvvs 148,188,60
LW 7
RT 182,22,38912
Mvvvs 144,192,64
buffer_load_dwordx4 v122, s[28:31], s73 offen offset:2048 lds
Mvvvs 148,192,68
RT 184,22,40960
RT 186,22,43008
Mvvvs 144,196,72
RT 188,22,45056
CV 161,130,131
CV 162,136,137
Mvvvs 148,196,76
LW 7
RT 190,22,47104
v_add_u32 v23, 49152, v27
Mvvvs 144,200,80
buffer_load_dwordx4 v123, s[28:31], s73 offen offset:3072 lds
Mvvvs 148,200,84
RT 192,23,0
RT 194,23,2048
Mvvvs 144,204,88
RT 196,23,4096
CV 163,138,139
s_add_u32 s76, s60, 131072
Mvvvs 148,204,92
LW 7
RT 198,23,6144
Mvvas 144,176,192
buffer_store_dwordx4 v[160:163], v4, s[4:7], s76 offen sc1
Mvvas 148,176,196
RT 200,23,8192
RT 202,23,10240
Mvvas 144,180,200
RT 204,23,12288
CV 164,132,133
Mvvas 148,180,204
LW 7
RT 206,23,14336
Mvvas 144,184,208
RT 176,23,16384
CV 165,134,135
Mvvas 148,184,212
RT 178,23,18432
CV 166,140,141
Mvvas 144,188,216
RT 180,23,20480
CV 167,142,143
Mvvas 148,188,220
LW 7
RT 182,23,22528
Mvvvz 152,192,32
buffer_store_dwordx4 v[164:167], v28, s[4:7], s76 offen sc1
Mvvvz 156,192,36
RT 184,23,24576
RT 186,23,26624
Mvvvs 152,196,40
RT 188,23,28672
Mvvvs 156,196,44
LW 7
RT 190,23,30720
Mvvvs 152,200,48
RT 192,23,32768
Mvvvs 156,200,52
RT 194,23,34816
Mvvvs 152,204,56
RT 196,23,36864
Mvvvs 156,204,60
LW 7
RT 198,23,38912
Mvvvs 152,176,64
RT 200,23,40960
Mvvvs 156,176,68
s_waitcnt vmcnt(10)
s_waitcnt vmcnt(19)
s_barrier
RT 202,23,43008
Mvvvs 152,180,72
RT 204,23,45056
v_add_u32_e64 v8, 8, v6
Mvvvs 156,180,76
LW 7
RT 206,23,47104
v_add_u32 v20, 98304, v24
Mvvvs 152,184,80
buffer_store_dword v8, v5, s[4:7], s71 offen sc1
Mvvvs 156,184,84
RT 176,20,0
RT 178,20,2048
Mvvvs 152,188,88
RT 180,20,4096
Mvvvs 156,188,92
LW 7
RT 182,20,6144
Mvvas 152,192,192
RT 184,20,8192
Mvvas 156,192,196
RT 186,20,10240
Mvvas 152,196,200
RT 188,20,12288
Mvvas 156,196,204
LW 7
RT 190,20,14336
Mvvas 152,200,208
RT 192,20,16384
Mvvas 156,200,212
RT 194,20,18432
Mvvas 152,204,216
RT 196,20,20480
Mvvas 156,204,220
LW 7
RT 198,20,22528
Mvvvz 128,176,32
RT 200,20,24576
Mvvvz 132,176,36
RT 202,20,26624
Mvvvs 128,180,40
RT 204,20,28672
Mvvvs 132,180,44
LW 7
RT 206,20,30720
Mvvvs 128,184,48
RT 176,20,32768
Mvvvs 132,184,52
RT 178,20,34816
Mvvvs 128,188,56
RT 180,20,36864
CV 168,144,145
Mvvvs 132,188,60
LW 7
RT 182,20,38912
Mvvvs 128,192,64
RT 184,20,40960
CV 169,146,147
Mvvvs 132,192,68
RT 186,20,43008
CV 170,152,153
Mvvvs 128,196,72
RT 188,20,45056
CV 171,154,155
Mvvvs 132,196,76
LW 7
RT 190,20,47104
v_add_u32 v21, 98304, v25
Mvvvs 128,200,80
RT 192,21,0
s_add_u32 s76, s60, 147456
Mvvvs 132,200,84
RT 194,21,2048
Mvvvs 128,204,88
RT 196,21,4096
Mvvvs 132,204,92
LW 7
RT 198,21,6144
Mvvas 128,176,192
buffer_store_dwordx4 v[168:171], v4, s[4:7], s76 offen sc1
Mvvas 132,176,196
RT 200,21,8192
RT 202,21,10240
Mvvas 128,180,200
RT 204,21,12288
CV 172,148,149
Mvvas 132,180,204
LW 7
RT 206,21,14336
Mvvas 128,184,208
RT 176,21,16384
CV 173,150,151
Mvvas 132,184,212
RT 178,21,18432
CV 174,156,157
Mvvas 128,188,216
RT 180,21,20480
CV 175,158,159
Mvvas 132,188,220
LW 7
RT 182,21,22528
Mvvvz 136,192,32
buffer_store_dwordx4 v[172:175], v28, s[4:7], s76 offen sc1
Mvvvz 140,192,36
RT 184,21,24576
RT 186,21,26624
Mvvvs 136,196,40
RT 188,21,28672
Mvvvs 140,196,44
LW 7
RT 190,21,30720
Mvvvs 136,200,48
RT 192,21,32768
Mvvvs 140,200,52
RT 194,21,34816
Mvvvs 136,204,56
RT 196,21,36864
Mvvvs 140,204,60
LW 7
RT 198,21,38912
Mvvvs 136,176,64
RT 200,21,40960
Mvvvs 140,176,68
RT 202,21,43008
Mvvvs 136,180,72
RT 204,21,45056
Mvvvs 140,180,76
LW 7
RT 206,21,47104
v_add_u32 v22, 98304, v26
Mvvvs 136,184,80
RT 176,22,0
Mvvvs 140,184,84
RT 178,22,2048
Mvvvs 136,188,88
RT 180,22,4096
Mvvvs 140,188,92
LW 7
RT 182,22,6144
Mvvas 136,192,192
RT 184,22,8192
Mvvas 140,192,196
RT 186,22,10240
Mvvas 136,196,200
RT 188,22,12288
Mvvas 140,196,204
LW 7
RT 190,22,14336
Mvvas 136,200,208
RT 192,22,16384
Mvvas 140,200,212
RT 194,22,18432
Mvvas 136,204,216
RT 196,22,20480
Mvvas 140,204,220
LW 7
RT 198,22,22528
Mvvvz 144,176,32
RT 200,22,24576
Mvvvz 148,176,36
RT 202,22,26624
Mvvvs 144,180,40
RT 204,22,28672
Mvvvs 148,180,44
LW 7
RT 206,22,30720
Mvvvs 144,184,48
RT 176,22,32768
Mvvvs 148,184,52
RT 178,22,34816
Mvvvs 144,188,56
RT 180,22,36864
CV 160,128,129
Mvvvs 148,188,60
LW 7
RT 182,22,38912
Mvvvs 144,192,64
RT 184,22,40960
CV 161,130,131
Mvvvs 148,192,68
RT 186,22,43008
CV 162,136,137
Mvvvs 144,196,72
RT 188,22,45056
CV 163,138,139
Mvvvs 148,196,76
LW 7
RT 190,22,47104
v_add_u32 v23, 98304, v27
Mvvvs 144,200,80
RT 192,23,0
s_add_u32 s76, s60, 163840
Mvvvs 148,200,84
RT 194,23,2048
Mvvvs 144,204,88
RT 196,23,4096
Mvvvs 148,204,92
LW 7
RT 198,23,6144
Mvvas 144,176,192
buffer_store_dwordx4 v[160:163], v4, s[4:7], s76 offen sc1
Mvvas 148,176,196
RT 200,23,8192
RT 202,23,10240
Mvvas 144,180,200
RT 204,23,12288
CV 164,132,133
Mvvas 148,180,204
LW 7
RT 206,23,14336
Mvvas 144,184,208
RT 176,23,16384
CV 165,134,135
Mvvas 148,184,212
RT 178,23,18432
CV 166,140,141
Mvvas 144,188,216
RT 180,23,20480
CV 167,142,143
Mvvas 148,188,220
LW 7
RT 182,23,22528
Mvvvz 152,192,32
buffer_store_dwordx4 v[164:167], v28, s[4:7], s76 offen sc1
Mvvvz 156,192,36
RT 184,23,24576
RT 186,23,26624
Mvvvs 152,196,40
RT 188,23,28672
Mvvvs 156,196,44
LW 7
RT 190,23,30720
Mvvvs 152,200,48
RT 192,23,32768
Mvvvs 156,200,52
RT 194,23,34816
Mvvvs 152,204,56
RT 196,23,36864
Mvvvs 156,204,60
LW 7
RT 198,23,38912
Mvvvs 152,176,64
RT 200,23,40960
Mvvvs 156,176,68
s_waitcnt vmcnt(2)
s_waitcnt vmcnt(7)
s_barrier
RT 202,23,43008
Mvvvs 152,180,72
RT 204,23,45056
v_add_u32 v9, 10, v6
Mvvvs 156,180,76
LW 7
RT 206,23,47104
v_add_u32 v20, 0, v24
Mvvvs 152,184,80
buffer_store_dword v9, v5, s[4:7], s71 offen sc1
Mvvvs 156,184,84
RT 176,20,0
RT 178,20,2048
Mvvvs 152,188,88
RT 180,20,4096
Mvvvs 156,188,92
LW 7
RT 182,20,6144
Mvvas 152,192,192
RT 184,20,8192
Mvvas 156,192,196
RT 186,20,10240
Mvvas 152,196,200
RT 188,20,12288
Mvvas 156,196,204
LW 7
RT 190,20,14336
Mvvas 152,200,208
RT 192,20,16384
Mvvas 156,200,212
RT 194,20,18432
Mvvas 152,204,216
RT 196,20,20480
Mvvas 156,204,220
LW 7
RT 198,20,22528
Mvvvz 128,176,32
RT 200,20,24576
Mvvvz 132,176,36
RT 202,20,26624
Mvvvs 128,180,40
RT 204,20,28672
Mvvvs 132,180,44
LW 7
RT 206,20,30720
Mvvvs 128,184,48
RT 176,20,32768
Mvvvs 132,184,52
RT 178,20,34816
Mvvvs 128,188,56
RT 180,20,36864
CV 168,144,145
Mvvvs 132,188,60
LW 7
RT 182,20,38912
Mvvvs 128,192,64
RT 184,20,40960
CV 169,146,147
Mvvvs 132,192,68
RT 186,20,43008
CV 170,152,153
Mvvvs 128,196,72
RT 188,20,45056
CV 171,154,155
Mvvvs 132,196,76
LW 7
RT 190,20,47104
v_add_u32_e64 v21, 0, v25
Mvvvs 128,200,80
RT 192,21,0
s_add_u32 s76, s60, 180224
Mvvvs 132,200,84
RT 194,21,2048
Mvvvs 128,204,88
RT 196,21,4096
Mvvvs 132,204,92
LW 7
RT 198,21,6144
Mvvas 128,176,192
buffer_store_dwordx4 v[168:171], v4, s[4:7], s76 offen sc1
Mvvas 132,176,196
RT 200,21,8192
RT 202,21,10240
Mvvas 128,180,200
RT 204,21,12288
CV 172,148,149
Mvvas 132,180,204
LW 7
RT 206,21,14336
Mvvas 128,184,208
RT 176,21,16384
CV 173,150,151
Mvvas 132,184,212
RT 178,21,18432
CV 174,156,157
Mvvas 128,188,216
RT 180,21,20480
CV 175,158,159
Mvvas 132,188,220
LW 7
RT 182,21,22528
Mvvvz 136,192,32
buffer_store_dwordx4 v[172:175], v28, s[4:7], s76 offen sc1
Mvvvz 140,192,36
RT 184,21,24576
RT 186,21,26624
Mvvvs 136,196,40
RT 188,21,28672
Mvvvs 140,196,44
LW 7
RT 190,21,30720
Mvvvs 136,200,48
RT 192,21,32768
Mvvvs 140,200,52
RT 194,21,34816
Mvvvs 136,204,56
RT 196,21,36864
Mvvvs 140,204,60
LW 7
RT 198,21,38912
Mvvvs 136,176,64
RT 200,21,40960
Mvvvs 140,176,68
RT 202,21,43008
Mvvvs 136,180,72
RT 204,21,45056
Mvvvs 140,180,76
LW 7
RT 206,21,47104
v_add_u32_e64 v22, 0, v26
Mvvvs 136,184,80
RT 176,22,0
Mvvvs 140,184,84
RT 178,22,2048
Mvvvs 136,188,88
RT 180,22,4096
Mvvvs 140,188,92
LW 7
RT 182,22,6144
Mvvas 136,192,192
RT 184,22,8192
Mvvas 140,192,196
RT 186,22,10240
Mvvas 136,196,200
RT 188,22,12288
Mvvas 140,196,204
LW 7
RT 190,22,14336
Mvvas 136,200,208
RT 192,22,16384
Mvvas 140,200,212
RT 194,22,18432
Mvvas 136,204,216
RT 196,22,20480
Mvvas 140,204,220
LW 7
RT 198,22,22528
Mvvvz 144,176,32
RT 200,22,24576
Mvvvz 148,176,36
RT 202,22,26624
Mvvvs 144,180,40
RT 204,22,28672
Mvvvs 148,180,44
LW 7
RT 206,22,30720
Mvvvs 144,184,48
RT 176,22,32768
Mvvvs 148,184,52
RT 178,22,34816
Mvvvs 144,188,56
RT 180,22,36864
CV 160,128,129
Mvvvs 148,188,60
LW 7
RT 182,22,38912
Mvvvs 144,192,64
RT 184,22,40960
CV 161,130,131
Mvvvs 148,192,68
RT 186,22,43008
CV 162,136,137
Mvvvs 144,196,72
RT 188,22,45056
CV 163,138,139
Mvvvs 148,196,76
LW 7
RT 190,22,47104
v_add_u32_e64 v23, 0, v27
Mvvvs 144,200,80
RT 192,23,0
s_add_u32 s76, s60, 196608
Mvvvs 148,200,84
RT 194,23,2048
Mvvvs 144,204,88
RT 196,23,4096
Mvvvs 148,204,92
LW 7
RT 198,23,6144
Mvvas 144,176,192
buffer_store_dwordx4 v[160:163], v4, s[4:7], s76 offen sc1
Mvvas 148,176,196
RT 200,23,8192
RT 202,23,10240
Mvvas 144,180,200
RT 204,23,12288
CV 164,132,133
Mvvas 148,180,204
LW 7
RT 206,23,14336
Mvvas 144,184,208
RT 176,23,16384
CV 165,134,135
Mvvas 148,184,212
RT 178,23,18432
CV 166,140,141
Mvvas 144,188,216
RT 180,23,20480
CV 167,142,143
Mvvas 148,188,220
LW 7
RT 182,23,22528
Mvvvz 152,192,32
buffer_store_dwordx4 v[164:167], v28, s[4:7], s76 offen sc1
Mvvvz 156,192,36
RT 184,23,24576
RT 186,23,26624
Mvvvs 152,196,40
RT 188,23,28672
Mvvvs 156,196,44
LW 7
RT 190,23,30720
Mvvvs 152,200,48
RT 192,23,32768
Mvvvs 156,200,52
RT 194,23,34816
Mvvvs 152,204,56
RT 196,23,36864
Mvvvs 156,204,60
LW 7
RT 198,23,38912
Mvvvs 152,176,64
RT 200,23,40960
Mvvvs 156,176,68
s_waitcnt vmcnt(2)
s_barrier
RT 202,23,43008
Mvvvs 152,180,72
RT 204,23,45056
v_add_u32 v8, 12, v6
Mvvvs 156,180,76
LW 7
RT 206,23,47104
Mvvvs 152,184,80
buffer_store_dword v8, v5, s[4:7], s71 offen sc1
Mvvvs 156,184,84
Mvvvs 152,188,88
Mvvvs 156,188,92
LW 4
Mvvas 152,192,192
Mvvas 156,192,196
Mvvas 152,196,200
Mvvas 156,196,204
LW 0
Mvvas 152,200,208
Mvvas 156,200,212
Mvvas 152,204,216
Mvvas 156,204,220
s_nop 7
CV 168,144,145
CV 169,146,147
CV 170,152,153
CV 171,154,155
s_add_u32 s76, s60, 212992
buffer_store_dwordx4 v[168:171], v4, s[4:7], s76 offen sc1
CV 172,148,149
CV 173,150,151
CV 174,156,157
CV 175,158,159
buffer_store_dwordx4 v[172:175], v28, s[4:7], s76 offen sc1
s_branch EV_86
OD_85:
v_lshrrev_b32 v2, 2, v1
v_bfe_u32 v3, v1, 3, 2
v_and_b32 v8, 3, v1
v_lshlrev_b32 v8, 3, v8
v_lshl_add_u32 v8, v2, 7, v8
v_xor_b32_e64 v2, 0, v3
v_lshl_add_u32 v24, v2, 5, v8
v_xor_b32_e64 v2, 1, v3
v_lshl_add_u32 v25, v2, 5, v8
v_xor_b32_e64 v2, 2, v3
v_lshl_add_u32 v26, v2, 5, v8
v_xor_b32_e64 v2, 3, v3
v_lshl_add_u32 v27, v2, 5, v8
s_lshl_b32 s72, s48, 3
s_add_u32 s72, s72, s44
s_mul_i32 s72, s72, 229376
s_lshl_b32 s73, s45, 10
s_add_u32 s72, s72, s73
s_add_u32 s60, s72, 0x4000000
s_mul_i32 s72, s3, 229376
v_add_u32 v28, s72, v4
s_lshl_b32 s70, s48, 12
s_add_u32 s70, s70, 0x6140000
s_lshl_b32 s71, s45, 2
s_add_u32 s71, s71, s70
s_waitcnt vmcnt(12)
s_barrier
v_add_u32_e64 v20, 0, v24
RT 176,20,0
RT 178,20,2048
RT 180,20,4096
RT 182,20,6144
RT 184,20,8192
RT 186,20,10240
RT 188,20,12288
RT 190,20,14336
RT 192,20,16384
RT 194,20,18432
RT 196,20,20480
RT 198,20,22528
LW 8
Mvvvz 128,176,32
RT 200,20,24576
s_lshl_b32 s72, s52, 1
Mvvvz 132,176,36
RT 202,20,26624
s_add_u32 m0, s72, 98304
Mvvvs 128,180,40
RT 204,20,28672
s_add_u32 s73, s57, 256
Mvvvs 132,180,44
LW 7
RT 206,20,30720
Mvvvs 128,184,48
buffer_load_dwordx4 v120, s[24:27], s73 offen offset:0 lds
Mvvvs 132,184,52
RT 176,20,32768
RT 178,20,34816
Mvvvs 128,188,56
RT 180,20,36864
buffer_load_dwordx4 v121, s[24:27], s73 offen offset:1024 lds
Mvvvs 132,188,60
LW 7
RT 182,20,38912
Mvvvs 128,192,64
RT 184,20,40960
Mvvvs 132,192,68
RT 186,20,43008
v_add_u32_e64 v21, 0, v25
Mvvvs 128,196,72
RT 188,21,0
Mvvvs 132,196,76
LW 7
RT 190,21,2048
Mvvvs 128,200,80
buffer_load_dwordx4 v122, s[24:27], s73 offen offset:2048 lds
Mvvvs 132,200,84
RT 192,21,4096
RT 194,21,6144
Mvvvs 128,204,88
RT 196,21,8192
Mvvvs 132,204,92
LW 7
RT 198,21,10240
Mvvas 128,176,192
buffer_load_dwordx4 v123, s[24:27], s73 offen offset:3072 lds
Mvvas 132,176,196
RT 200,21,12288
RT 202,21,14336
Mvvas 128,180,200
RT 204,21,16384
s_add_u32 m0, s72, 102400
Mvvas 132,180,204
LW 7
RT 206,21,18432
Mvvas 128,184,208
RT 176,21,20480
s_add_u32 s73, s57, 28928
Mvvas 132,184,212
RT 178,21,22528
buffer_load_dwordx4 v120, s[24:27], s73 offen offset:0 lds
Mvvvz 136,188,32
RT 180,21,24576
Mvvvz 140,188,36
LW 7
RT 182,21,26624
Mvvvs 136,192,40
buffer_load_dwordx4 v121, s[24:27], s73 offen offset:1024 lds
Mvvvs 140,192,44
RT 184,21,28672
RT 186,21,30720
Mvvvs 136,196,48
RT 188,21,32768
Mvvvs 140,196,52
LW 7
RT 190,21,34816
Mvvvs 136,200,56
buffer_load_dwordx4 v122, s[24:27], s73 offen offset:2048 lds
Mvvvs 140,200,60
RT 192,21,36864
RT 194,21,38912
Mvvvs 136,204,64
RT 196,21,40960
Mvvvs 140,204,68
LW 7
RT 198,21,43008
v_add_u32_e64 v22, 0, v26
Mvvvs 136,176,72
buffer_load_dwordx4 v123, s[24:27], s73 offen offset:3072 lds
Mvvvs 140,176,76
RT 200,22,0
RT 202,22,2048
Mvvvs 136,180,80
RT 204,22,4096
s_add_u32 m0, s52, 131072
Mvvvs 140,180,84
LW 7
RT 206,22,6144
Mvvvs 136,184,88
RT 176,22,8192
s_add_u32 s73, s58, 256
Mvvvs 140,184,92
RT 178,22,10240
Mvvas 136,188,192
RT 180,22,12288
Mvvas 140,188,196
LW 7
RT 182,22,14336
Mvvas 136,192,200
buffer_load_dwordx4 v120, s[28:31], s73 offen offset:0 lds
Mvvas 140,192,204
RT 184,22,16384
RT 186,22,18432
Mvvas 136,196,208
RT 188,22,20480
buffer_load_dwordx4 v121, s[28:31], s73 offen offset:1024 lds
Mvvas 140,196,212
LW 7
RT 190,22,22528
Mvvvz 144,200,32
buffer_load_dwordx4 v122, s[28:31], s73 offen offset:2048 lds
Mvvvz 148,200,36
RT 192,22,24576
RT 194,22,26624
Mvvvs 144,204,40
RT 196,22,28672
Mvvvs 148,204,44
LW 7
RT 198,22,30720
Mvvvs 144,176,48
buffer_load_dwordx4 v123, s[28:31], s73 offen offset:3072 lds
Mvvvs 148,176,52
RT 200,22,32768
RT 202,22,34816
Mvvvs 144,180,56
RT 204,22,36864
CV 160,128,129
Mvvvs 148,180,60
LW 7
RT 206,22,38912
Mvvvs 144,184,64
RT 176,22,40960
CV 161,130,131
Mvvvs 148,184,68
RT 178,22,43008
v_add_u32 v23, 0, v27
Mvvvs 144,188,72
RT 180,23,0
CV 162,136,137
Mvvvs 148,188,76
LW 7
RT 182,23,2048
Mvvvs 144,192,80
RT 184,23,4096
CV 163,138,139
Mvvvs 148,192,84
RT 186,23,6144
s_add_u32 s76, s60, 0
Mvvvs 144,196,88
RT 188,23,8192
Mvvvs 148,196,92
LW 7
RT 190,23,10240
Mvvas 144,200,192
buffer_store_dwordx4 v[160:163], v4, s[4:7], s76 offen sc1
Mvvas 148,200,196
RT 192,23,12288
RT 194,23,14336
Mvvas 144,204,200
RT 196,23,16384
CV 164,132,133
Mvvas 148,204,204
LW 7
RT 198,23,18432
Mvvas 144,176,208
RT 200,23,20480
CV 165,134,135
Mvvas 148,176,212
RT 202,23,22528
CV 166,140,141
Mvvvz 152,180,32
RT 204,23,24576
CV 167,142,143
Mvvvz 156,180,36
LW 7
RT 206,23,26624
Mvvvs 152,184,40
buffer_store_dwordx4 v[164:167], v28, s[4:7], s76 offen sc1
Mvvvs 156,184,44
RT 176,23,28672
RT 178,23,30720
Mvvvs 152,188,48
RT 180,23,32768
Mvvvs 156,188,52
LW 7
RT 182,23,34816
Mvvvs 152,192,56
RT 184,23,36864
Mvvvs 156,192,60
s_waitcnt vmcnt(14)
s_barrier
RT 186,23,38912
Mvvvs 152,196,64
RT 188,23,40960
Mvvvs 156,196,68
LW 7
RT 190,23,43008
v_add_u32 v20, 49152, v24
Mvvvs 152,200,72
RT 192,20,0
Mvvvs 156,200,76
RT 194,20,2048
Mvvvs 152,204,80
RT 196,20,4096
Mvvvs 156,204,84
LW 7
RT 198,20,6144
Mvvvs 152,176,88
RT 200,20,8192
Mvvvs 156,176,92
RT 202,20,10240
Mvvas 152,180,192
RT 204,20,12288
Mvvas 156,180,196
LW 7
RT 206,20,14336
Mvvas 152,184,200
RT 176,20,16384
Mvvas 156,184,204
RT 178,20,18432
Mvvas 152,188,208
RT 180,20,20480
Mvvas 156,188,212
LW 7
RT 182,20,22528
Mvvvz 128,192,32
RT 184,20,24576
Mvvvz 132,192,36
s_barrier
RT 186,20,26624
Mvvvs 128,196,40
RT 188,20,28672
s_lshl_b32 s72, s52, 1
Mvvvs 132,196,44
LW 7
RT 190,20,30720
Mvvvs 128,200,48
RT 192,20,32768
s_add_u32 m0, s72, 0
Mvvvs 132,200,52
RT 194,20,34816
s_add_u32 s73, s57, 384
Mvvvs 128,204,56
RT 196,20,36864
buffer_load_dwordx4 v120, s[24:27], s73 offen offset:0 lds
Mvvvs 132,204,60
LW 7
RT 198,20,38912
Mvvvs 128,176,64
RT 200,20,40960
CV 168,144,145
Mvvvs 132,176,68
RT 202,20,43008
v_add_u32 v21, 49152, v25
Mvvvs 128,180,72
RT 204,21,0
CV 169,146,147
CV 170,152,153
Mvvvs 132,180,76
LW 7
RT 206,21,2048
Mvvvs 128,184,80
buffer_load_dwordx4 v121, s[24:27], s73 offen offset:1024 lds
Mvvvs 132,184,84
RT 176,21,4096
RT 178,21,6144
Mvvvs 128,188,88
RT 180,21,8192
CV 171,154,155
s_add_u32 s76, s60, 16384
Mvvvs 132,188,92
LW 7
RT 182,21,10240
buffer_store_dwordx4 v[168:171], v4, s[4:7], s76 offen sc1
Mvvas 128,192,192
buffer_load_dwordx4 v122, s[24:27], s73 offen offset:2048 lds
Mvvas 132,192,196
RT 184,21,12288
RT 186,21,14336
Mvvas 128,196,200
RT 188,21,16384
CV 172,148,149
CV 173,150,151
Mvvas 132,196,204
LW 7
RT 190,21,18432
CV 174,156,157
Mvvas 128,200,208
buffer_load_dwordx4 v123, s[24:27], s73 offen offset:3072 lds
Mvvas 132,200,212
RT 192,21,20480
RT 194,21,22528
Mvvvz 136,204,32
RT 196,21,24576
s_add_u32 m0, s72, 4096
CV 175,158,159
Mvvvz 140,204,36
LW 7
RT 198,21,26624
Mvvvs 136,176,40
RT 200,21,28672
s_add_u32 s73, s57, 29056
Mvvvs 140,176,44
RT 202,21,30720
buffer_store_dwordx4 v[172:175], v28, s[4:7], s76 offen sc1
Mvvvs 136,180,48
RT 204,21,32768
Mvvvs 140,180,52
LW 7
RT 206,21,34816
Mvvvs 136,184,56
buffer_load_dwordx4 v120, s[24:27], s73 offen offset:0 lds
Mvvvs 140,184,60
RT 176,21,36864
RT 178,21,38912
Mvvvs 136,188,64
RT 180,21,40960
Mvvvs 140,188,68
LW 7
RT 182,21,43008
v_add_u32 v22, 49152, v26
Mvvvs 136,192,72
buffer_load_dwordx4 v121, s[24:27], s73 offen offset:1024 lds
Mvvvs 140,192,76
RT 184,22,0
RT 186,22,2048
Mvvvs 136,196,80
RT 188,22,4096
Mvvvs 140,196,84
LW 7
RT 190,22,6144
Mvvvs 136,200,88
buffer_load_dwordx4 v122, s[24:27], s73 offen offset:2048 lds
Mvvvs 140,200,92
RT 192,22,8192
RT 194,22,10240
Mvvas 136,204,192
RT 196,22,12288
Mvvas 140,204,196
LW 7
RT 198,22,14336
Mvvas 136,176,200
buffer_load_dwordx4 v123, s[24:27], s73 offen offset:3072 lds
Mvvas 140,176,204
RT 200,22,16384
RT 202,22,18432
Mvvas 136,180,208
RT 204,22,20480
s_add_u32 m0, s52, 32768
Mvvas 140,180,212
LW 7
RT 206,22,22528
Mvvvz 144,184,32
RT 176,22,24576
s_add_u32 s73, s58, 384
Mvvvz 148,184,36
RT 178,22,26624
Mvvvs 144,188,40
RT 180,22,28672
Mvvvs 148,188,44
LW 7
RT 182,22,30720
Mvvvs 144,192,48
buffer_load_dwordx4 v120, s[28:31], s73 offen offset:0 lds
Mvvvs 148,192,52
RT 184,22,32768
RT 186,22,34816
Mvvvs 144,196,56
RT 188,22,36864
buffer_load_dwordx4 v121, s[28:31], s73 offen offset:1024 lds
Mvvvs 148,196,60
LW 7
RT 190,22,38912
Mvvvs 144,200,64
RT 192,22,40960
CV 160,128,129
Mvvvs 148,200,68
RT 194,22,43008
v_add_u32 v23, 49152, v27
Mvvvs 144,204,72
RT 196,23,0
CV 161,130,131
CV 162,136,137
Mvvvs 148,204,76
LW 7
RT 198,23,2048
Mvvvs 144,176,80
buffer_load_dwordx4 v122, s[28:31], s73 offen offset:2048 lds
Mvvvs 148,176,84
RT 200,23,4096
RT 202,23,6144
Mvvvs 144,180,88
RT 204,23,8192
CV 163,138,139
s_add_u32 s76, s60, 32768
Mvvvs 148,180,92
LW 7
RT 206,23,10240
buffer_store_dwordx4 v[160:163], v4, s[4:7], s76 offen sc1
Mvvas 144,184,192
buffer_load_dwordx4 v123, s[28:31], s73 offen offset:3072 lds
Mvvas 148,184,196
RT 176,23,12288
RT 178,23,14336
Mvvas 144,188,200
RT 180,23,16384
CV 164,132,133
Mvvas 148,188,204
LW 7
RT 182,23,18432
Mvvas 144,192,208
RT 184,23,20480
CV 165,134,135
Mvvas 148,192,212
RT 186,23,22528
CV 166,140,141
Mvvvz 152,196,32
RT 188,23,24576
CV 167,142,143
Mvvvz 156,196,36
LW 7
RT 190,23,26624
Mvvvs 152,200,40
buffer_store_dwordx4 v[164:167], v28, s[4:7], s76 offen sc1
Mvvvs 156,200,44
RT 192,23,28672
RT 194,23,30720
Mvvvs 152,204,48
RT 196,23,32768
Mvvvs 156,204,52
LW 7
RT 198,23,34816
Mvvvs 152,176,56
RT 200,23,36864
Mvvvs 156,176,60
s_waitcnt vmcnt(10)
s_waitcnt vmcnt(18)
s_barrier
RT 202,23,38912
Mvvvs 152,180,64
RT 204,23,40960
v_add_u32_e64 v9, 2, v6
Mvvvs 156,180,68
LW 7
RT 206,23,43008
v_add_u32 v20, 98304, v24
Mvvvs 152,184,72
buffer_store_dword v9, v5, s[4:7], s71 offen sc1
Mvvvs 156,184,76
RT 176,20,0
RT 178,20,2048
Mvvvs 152,188,80
RT 180,20,4096
Mvvvs 156,188,84
LW 7
RT 182,20,6144
Mvvvs 152,192,88
RT 184,20,8192
Mvvvs 156,192,92
RT 186,20,10240
Mvvas 152,196,192
RT 188,20,12288
Mvvas 156,196,196
LW 7
RT 190,20,14336
Mvvas 152,200,200
RT 192,20,16384
Mvvas 156,200,204
RT 194,20,18432
Mvvas 152,204,208
RT 196,20,20480
Mvvas 156,204,212
LW 7
RT 198,20,22528
Mvvvz 128,176,32
RT 200,20,24576
Mvvvz 132,176,36
s_barrier
RT 202,20,26624
Mvvvs 128,180,40
RT 204,20,28672
s_lshl_b32 s72, s52, 1
Mvvvs 132,180,44
LW 7
RT 206,20,30720
Mvvvs 128,184,48
RT 176,20,32768
s_add_u32 m0, s72, 49152
Mvvvs 132,184,52
RT 178,20,34816
s_add_u32 s73, s57, 512
Mvvvs 128,188,56
RT 180,20,36864
buffer_load_dwordx4 v120, s[24:27], s73 offen offset:0 lds
Mvvvs 132,188,60
LW 7
RT 182,20,38912
Mvvvs 128,192,64
RT 184,20,40960
CV 168,144,145
Mvvvs 132,192,68
RT 186,20,43008
v_add_u32 v21, 98304, v25
Mvvvs 128,196,72
RT 188,21,0
CV 169,146,147
CV 170,152,153
Mvvvs 132,196,76
LW 7
RT 190,21,2048
Mvvvs 128,200,80
buffer_load_dwordx4 v121, s[24:27], s73 offen offset:1024 lds
Mvvvs 132,200,84
RT 192,21,4096
RT 194,21,6144
Mvvvs 128,204,88
RT 196,21,8192
CV 171,154,155
s_add_u32 s76, s60, 49152
Mvvvs 132,204,92
LW 7
RT 198,21,10240
buffer_store_dwordx4 v[168:171], v4, s[4:7], s76 offen sc1
Mvvas 128,176,192
buffer_load_dwordx4 v122, s[24:27], s73 offen offset:2048 lds
Mvvas 132,176,196
RT 200,21,12288
RT 202,21,14336
Mvvas 128,180,200
RT 204,21,16384
CV 172,148,149
CV 173,150,151
Mvvas 132,180,204
LW 7
RT 206,21,18432
CV 174,156,157
Mvvas 128,184,208
buffer_load_dwordx4 v123, s[24:27], s73 offen offset:3072 lds
Mvvas 132,184,212
RT 176,21,20480
RT 178,21,22528
Mvvvz 136,188,32
RT 180,21,24576
s_add_u32 m0, s72, 53248
CV 175,158,159
Mvvvz 140,188,36
LW 7
RT 182,21,26624
Mvvvs 136,192,40
RT 184,21,28672
s_add_u32 s73, s57, 29184
Mvvvs 140,192,44
RT 186,21,30720
buffer_store_dwordx4 v[172:175], v28, s[4:7], s76 offen sc1
Mvvvs 136,196,48
RT 188,21,32768
Mvvvs 140,196,52
LW 7
RT 190,21,34816
Mvvvs 136,200,56
buffer_load_dwordx4 v120, s[24:27], s73 offen offset:0 lds
Mvvvs 140,200,60
RT 192,21,36864
RT 194,21,38912
Mvvvs 136,204,64
RT 196,21,40960
Mvvvs 140,204,68
LW 7
RT 198,21,43008
v_add_u32 v22, 98304, v26
Mvvvs 136,176,72
buffer_load_dwordx4 v121, s[24:27], s73 offen offset:1024 lds
Mvvvs 140,176,76
RT 200,22,0
RT 202,22,2048
Mvvvs 136,180,80
RT 204,22,4096
Mvvvs 140,180,84
LW 7
RT 206,22,6144
Mvvvs 136,184,88
buffer_load_dwordx4 v122, s[24:27], s73 offen offset:2048 lds
Mvvvs 140,184,92
RT 176,22,8192
RT 178,22,10240
Mvvas 136,188,192
RT 180,22,12288
Mvvas 140,188,196
LW 7
RT 182,22,14336
Mvvas 136,192,200
buffer_load_dwordx4 v123, s[24:27], s73 offen offset:3072 lds
Mvvas 140,192,204
RT 184,22,16384
RT 186,22,18432
Mvvas 136,196,208
RT 188,22,20480
s_add_u32 m0, s52, 81920
Mvvas 140,196,212
LW 7
RT 190,22,22528
Mvvvz 144,200,32
RT 192,22,24576
s_add_u32 s73, s58, 512
Mvvvz 148,200,36
RT 194,22,26624
Mvvvs 144,204,40
RT 196,22,28672
Mvvvs 148,204,44
LW 7
RT 198,22,30720
Mvvvs 144,176,48
buffer_load_dwordx4 v120, s[28:31], s73 offen offset:0 lds
Mvvvs 148,176,52
RT 200,22,32768
RT 202,22,34816
Mvvvs 144,180,56
RT 204,22,36864
buffer_load_dwordx4 v121, s[28:31], s73 offen offset:1024 lds
Mvvvs 148,180,60
LW 7
RT 206,22,38912
Mvvvs 144,184,64
RT 176,22,40960
CV 160,128,129
Mvvvs 148,184,68
RT 178,22,43008
v_add_u32 v23, 98304, v27
Mvvvs 144,188,72
RT 180,23,0
CV 161,130,131
CV 162,136,137
Mvvvs 148,188,76
LW 7
RT 182,23,2048
Mvvvs 144,192,80
buffer_load_dwordx4 v122, s[28:31], s73 offen offset:2048 lds
Mvvvs 148,192,84
RT 184,23,4096
RT 186,23,6144
Mvvvs 144,196,88
RT 188,23,8192
CV 163,138,139
s_add_u32 s76, s60, 65536
Mvvvs 148,196,92
LW 7
RT 190,23,10240
buffer_store_dwordx4 v[160:163], v4, s[4:7], s76 offen sc1
Mvvas 144,200,192
buffer_load_dwordx4 v123, s[28:31], s73 offen offset:3072 lds
Mvvas 148,200,196
RT 192,23,12288
RT 194,23,14336
Mvvas 144,204,200
RT 196,23,16384
CV 164,132,133
Mvvas 148,204,204
LW 7
RT 198,23,18432
Mvvas 144,176,208
RT 200,23,20480
CV 165,134,135
Mvvas 148,176,212
RT 202,23,22528
CV 166,140,141
Mvvvz 152,180,32
RT 204,23,24576
CV 167,142,143
Mvvvz 156,180,36
LW 7
RT 206,23,26624
Mvvvs 152,184,40
buffer_store_dwordx4 v[164:167], v28, s[4:7], s76 offen sc1
Mvvvs 156,184,44
RT 176,23,28672
RT 178,23,30720
Mvvvs 152,188,48
RT 180,23,32768
Mvvvs 156,188,52
LW 7
RT 182,23,34816
Mvvvs 152,192,56
RT 184,23,36864
Mvvvs 156,192,60
s_waitcnt vmcnt(10)
s_waitcnt vmcnt(18)
s_barrier
RT 186,23,38912
Mvvvs 152,196,64
RT 188,23,40960
v_add_u32 v8, 4, v6
Mvvvs 156,196,68
LW 7
RT 190,23,43008
v_add_u32 v20, 0, v24
Mvvvs 152,200,72
buffer_store_dword v8, v5, s[4:7], s71 offen sc1
Mvvvs 156,200,76
RT 192,20,0
RT 194,20,2048
Mvvvs 152,204,80
RT 196,20,4096
Mvvvs 156,204,84
LW 7
RT 198,20,6144
Mvvvs 152,176,88
RT 200,20,8192
Mvvvs 156,176,92
RT 202,20,10240
Mvvas 152,180,192
RT 204,20,12288
Mvvas 156,180,196
LW 7
RT 206,20,14336
Mvvas 152,184,200
RT 176,20,16384
Mvvas 156,184,204
RT 178,20,18432
Mvvas 152,188,208
RT 180,20,20480
Mvvas 156,188,212
LW 7
RT 182,20,22528
Mvvvz 128,192,32
RT 184,20,24576
Mvvvz 132,192,36
s_barrier
RT 186,20,26624
Mvvvs 128,196,40
RT 188,20,28672
s_lshl_b32 s72, s52, 1
Mvvvs 132,196,44
LW 7
RT 190,20,30720
Mvvvs 128,200,48
RT 192,20,32768
s_add_u32 m0, s72, 98304
Mvvvs 132,200,52
RT 194,20,34816
s_add_u32 s73, s57, 640
Mvvvs 128,204,56
RT 196,20,36864
buffer_load_dwordx4 v120, s[24:27], s73 offen offset:0 lds
Mvvvs 132,204,60
LW 7
RT 198,20,38912
Mvvvs 128,176,64
RT 200,20,40960
CV 168,144,145
Mvvvs 132,176,68
RT 202,20,43008
v_add_u32 v21, 0, v25
Mvvvs 128,180,72
RT 204,21,0
CV 169,146,147
CV 170,152,153
Mvvvs 132,180,76
LW 7
RT 206,21,2048
Mvvvs 128,184,80
buffer_load_dwordx4 v121, s[24:27], s73 offen offset:1024 lds
Mvvvs 132,184,84
RT 176,21,4096
RT 178,21,6144
Mvvvs 128,188,88
RT 180,21,8192
CV 171,154,155
s_add_u32 s76, s60, 81920
Mvvvs 132,188,92
LW 7
RT 182,21,10240
buffer_store_dwordx4 v[168:171], v4, s[4:7], s76 offen sc1
Mvvas 128,192,192
buffer_load_dwordx4 v122, s[24:27], s73 offen offset:2048 lds
Mvvas 132,192,196
RT 184,21,12288
RT 186,21,14336
Mvvas 128,196,200
RT 188,21,16384
CV 172,148,149
CV 173,150,151
Mvvas 132,196,204
LW 7
RT 190,21,18432
CV 174,156,157
Mvvas 128,200,208
buffer_load_dwordx4 v123, s[24:27], s73 offen offset:3072 lds
Mvvas 132,200,212
RT 192,21,20480
RT 194,21,22528
Mvvvz 136,204,32
RT 196,21,24576
s_add_u32 m0, s72, 102400
CV 175,158,159
Mvvvz 140,204,36
LW 7
RT 198,21,26624
Mvvvs 136,176,40
RT 200,21,28672
s_add_u32 s73, s57, 29312
Mvvvs 140,176,44
RT 202,21,30720
buffer_store_dwordx4 v[172:175], v28, s[4:7], s76 offen sc1
Mvvvs 136,180,48
RT 204,21,32768
Mvvvs 140,180,52
LW 7
RT 206,21,34816
Mvvvs 136,184,56
buffer_load_dwordx4 v120, s[24:27], s73 offen offset:0 lds
Mvvvs 140,184,60
RT 176,21,36864
RT 178,21,38912
Mvvvs 136,188,64
RT 180,21,40960
Mvvvs 140,188,68
LW 7
RT 182,21,43008
v_add_u32_e64 v22, 0, v26
Mvvvs 136,192,72
buffer_load_dwordx4 v121, s[24:27], s73 offen offset:1024 lds
Mvvvs 140,192,76
RT 184,22,0
RT 186,22,2048
Mvvvs 136,196,80
RT 188,22,4096
Mvvvs 140,196,84
LW 7
RT 190,22,6144
Mvvvs 136,200,88
buffer_load_dwordx4 v122, s[24:27], s73 offen offset:2048 lds
Mvvvs 140,200,92
RT 192,22,8192
RT 194,22,10240
Mvvas 136,204,192
RT 196,22,12288
Mvvas 140,204,196
LW 7
RT 198,22,14336
Mvvas 136,176,200
buffer_load_dwordx4 v123, s[24:27], s73 offen offset:3072 lds
Mvvas 140,176,204
RT 200,22,16384
RT 202,22,18432
Mvvas 136,180,208
RT 204,22,20480
s_add_u32 m0, s52, 131072
Mvvas 140,180,212
LW 7
RT 206,22,22528
Mvvvz 144,184,32
RT 176,22,24576
s_add_u32 s73, s58, 640
Mvvvz 148,184,36
RT 178,22,26624
Mvvvs 144,188,40
RT 180,22,28672
Mvvvs 148,188,44
LW 7
RT 182,22,30720
Mvvvs 144,192,48
buffer_load_dwordx4 v120, s[28:31], s73 offen offset:0 lds
Mvvvs 148,192,52
RT 184,22,32768
RT 186,22,34816
Mvvvs 144,196,56
RT 188,22,36864
buffer_load_dwordx4 v121, s[28:31], s73 offen offset:1024 lds
Mvvvs 148,196,60
LW 7
RT 190,22,38912
Mvvvs 144,200,64
RT 192,22,40960
CV 160,128,129
Mvvvs 148,200,68
RT 194,22,43008
v_add_u32 v23, 0, v27
Mvvvs 144,204,72
RT 196,23,0
CV 161,130,131
CV 162,136,137
Mvvvs 148,204,76
LW 7
RT 198,23,2048
Mvvvs 144,176,80
buffer_load_dwordx4 v122, s[28:31], s73 offen offset:2048 lds
Mvvvs 148,176,84
RT 200,23,4096
RT 202,23,6144
Mvvvs 144,180,88
RT 204,23,8192
CV 163,138,139
s_add_u32 s76, s60, 98304
Mvvvs 148,180,92
LW 7
RT 206,23,10240
buffer_store_dwordx4 v[160:163], v4, s[4:7], s76 offen sc1
Mvvas 144,184,192
buffer_load_dwordx4 v123, s[28:31], s73 offen offset:3072 lds
Mvvas 148,184,196
RT 176,23,12288
RT 178,23,14336
Mvvas 144,188,200
RT 180,23,16384
CV 164,132,133
Mvvas 148,188,204
LW 7
RT 182,23,18432
Mvvas 144,192,208
RT 184,23,20480
CV 165,134,135
Mvvas 148,192,212
RT 186,23,22528
CV 166,140,141
Mvvvz 152,196,32
RT 188,23,24576
CV 167,142,143
Mvvvz 156,196,36
LW 7
RT 190,23,26624
Mvvvs 152,200,40
buffer_store_dwordx4 v[164:167], v28, s[4:7], s76 offen sc1
Mvvvs 156,200,44
RT 192,23,28672
RT 194,23,30720
Mvvvs 152,204,48
RT 196,23,32768
Mvvvs 156,204,52
LW 7
RT 198,23,34816
Mvvvs 152,176,56
RT 200,23,36864
Mvvvs 156,176,60
s_waitcnt vmcnt(10)
s_waitcnt vmcnt(18)
s_barrier
RT 202,23,38912
Mvvvs 152,180,64
RT 204,23,40960
v_add_u32_e64 v9, 6, v6
Mvvvs 156,180,68
LW 7
RT 206,23,43008
v_add_u32 v20, 49152, v24
Mvvvs 152,184,72
buffer_store_dword v9, v5, s[4:7], s71 offen sc1
Mvvvs 156,184,76
RT 176,20,0
RT 178,20,2048
Mvvvs 152,188,80
RT 180,20,4096
Mvvvs 156,188,84
LW 7
RT 182,20,6144
Mvvvs 152,192,88
RT 184,20,8192
Mvvvs 156,192,92
RT 186,20,10240
Mvvas 152,196,192
RT 188,20,12288
Mvvas 156,196,196
LW 7
RT 190,20,14336
Mvvas 152,200,200
RT 192,20,16384
Mvvas 156,200,204
RT 194,20,18432
Mvvas 152,204,208
RT 196,20,20480
Mvvas 156,204,212
LW 7
RT 198,20,22528
Mvvvz 128,176,32
RT 200,20,24576
Mvvvz 132,176,36
s_barrier
RT 202,20,26624
Mvvvs 128,180,40
RT 204,20,28672
s_lshl_b32 s72, s52, 1
Mvvvs 132,180,44
LW 7
RT 206,20,30720
Mvvvs 128,184,48
RT 176,20,32768
s_add_u32 m0, s72, 0
Mvvvs 132,184,52
RT 178,20,34816
s_add_u32 s73, s57, 768
Mvvvs 128,188,56
RT 180,20,36864
buffer_load_dwordx4 v120, s[24:27], s73 offen offset:0 lds
Mvvvs 132,188,60
LW 7
RT 182,20,38912
Mvvvs 128,192,64
RT 184,20,40960
CV 168,144,145
Mvvvs 132,192,68
RT 186,20,43008
v_add_u32 v21, 49152, v25
Mvvvs 128,196,72
RT 188,21,0
CV 169,146,147
CV 170,152,153
Mvvvs 132,196,76
LW 7
RT 190,21,2048
Mvvvs 128,200,80
buffer_load_dwordx4 v121, s[24:27], s73 offen offset:1024 lds
Mvvvs 132,200,84
RT 192,21,4096
RT 194,21,6144
Mvvvs 128,204,88
RT 196,21,8192
CV 171,154,155
s_add_u32 s76, s60, 114688
Mvvvs 132,204,92
LW 7
RT 198,21,10240
buffer_store_dwordx4 v[168:171], v4, s[4:7], s76 offen sc1
Mvvas 128,176,192
buffer_load_dwordx4 v122, s[24:27], s73 offen offset:2048 lds
Mvvas 132,176,196
RT 200,21,12288
RT 202,21,14336
Mvvas 128,180,200
RT 204,21,16384
CV 172,148,149
CV 173,150,151
Mvvas 132,180,204
LW 7
RT 206,21,18432
CV 174,156,157
Mvvas 128,184,208
buffer_load_dwordx4 v123, s[24:27], s73 offen offset:3072 lds
Mvvas 132,184,212
RT 176,21,20480
RT 178,21,22528
Mvvvz 136,188,32
RT 180,21,24576
s_add_u32 m0, s72, 4096
CV 175,158,159
Mvvvz 140,188,36
LW 7
RT 182,21,26624
Mvvvs 136,192,40
RT 184,21,28672
s_add_u32 s73, s57, 29440
Mvvvs 140,192,44
RT 186,21,30720
buffer_store_dwordx4 v[172:175], v28, s[4:7], s76 offen sc1
Mvvvs 136,196,48
RT 188,21,32768
Mvvvs 140,196,52
LW 7
RT 190,21,34816
Mvvvs 136,200,56
buffer_load_dwordx4 v120, s[24:27], s73 offen offset:0 lds
Mvvvs 140,200,60
RT 192,21,36864
RT 194,21,38912
Mvvvs 136,204,64
RT 196,21,40960
Mvvvs 140,204,68
LW 7
RT 198,21,43008
v_add_u32 v22, 49152, v26
Mvvvs 136,176,72
buffer_load_dwordx4 v121, s[24:27], s73 offen offset:1024 lds
Mvvvs 140,176,76
RT 200,22,0
RT 202,22,2048
Mvvvs 136,180,80
RT 204,22,4096
Mvvvs 140,180,84
LW 7
RT 206,22,6144
Mvvvs 136,184,88
buffer_load_dwordx4 v122, s[24:27], s73 offen offset:2048 lds
Mvvvs 140,184,92
RT 176,22,8192
RT 178,22,10240
Mvvas 136,188,192
RT 180,22,12288
Mvvas 140,188,196
LW 7
RT 182,22,14336
Mvvas 136,192,200
buffer_load_dwordx4 v123, s[24:27], s73 offen offset:3072 lds
Mvvas 140,192,204
RT 184,22,16384
RT 186,22,18432
Mvvas 136,196,208
RT 188,22,20480
s_add_u32 m0, s52, 32768
Mvvas 140,196,212
LW 7
RT 190,22,22528
Mvvvz 144,200,32
RT 192,22,24576
s_add_u32 s73, s58, 768
Mvvvz 148,200,36
RT 194,22,26624
Mvvvs 144,204,40
RT 196,22,28672
Mvvvs 148,204,44
LW 7
RT 198,22,30720
Mvvvs 144,176,48
buffer_load_dwordx4 v120, s[28:31], s73 offen offset:0 lds
Mvvvs 148,176,52
RT 200,22,32768
RT 202,22,34816
Mvvvs 144,180,56
RT 204,22,36864
buffer_load_dwordx4 v121, s[28:31], s73 offen offset:1024 lds
Mvvvs 148,180,60
LW 7
RT 206,22,38912
Mvvvs 144,184,64
RT 176,22,40960
CV 160,128,129
Mvvvs 148,184,68
RT 178,22,43008
v_add_u32 v23, 49152, v27
Mvvvs 144,188,72
RT 180,23,0
CV 161,130,131
CV 162,136,137
Mvvvs 148,188,76
LW 7
RT 182,23,2048
Mvvvs 144,192,80
buffer_load_dwordx4 v122, s[28:31], s73 offen offset:2048 lds
Mvvvs 148,192,84
RT 184,23,4096
RT 186,23,6144
Mvvvs 144,196,88
RT 188,23,8192
CV 163,138,139
s_add_u32 s76, s60, 131072
Mvvvs 148,196,92
LW 7
RT 190,23,10240
buffer_store_dwordx4 v[160:163], v4, s[4:7], s76 offen sc1
Mvvas 144,200,192
buffer_load_dwordx4 v123, s[28:31], s73 offen offset:3072 lds
Mvvas 148,200,196
RT 192,23,12288
RT 194,23,14336
Mvvas 144,204,200
RT 196,23,16384
CV 164,132,133
Mvvas 148,204,204
LW 7
RT 198,23,18432
Mvvas 144,176,208
RT 200,23,20480
CV 165,134,135
Mvvas 148,176,212
RT 202,23,22528
CV 166,140,141
Mvvvz 152,180,32
RT 204,23,24576
CV 167,142,143
Mvvvz 156,180,36
LW 7
RT 206,23,26624
Mvvvs 152,184,40
buffer_store_dwordx4 v[164:167], v28, s[4:7], s76 offen sc1
Mvvvs 156,184,44
RT 176,23,28672
RT 178,23,30720
Mvvvs 152,188,48
RT 180,23,32768
Mvvvs 156,188,52
LW 7
RT 182,23,34816
Mvvvs 152,192,56
RT 184,23,36864
Mvvvs 156,192,60
s_waitcnt vmcnt(10)
s_waitcnt vmcnt(18)
s_barrier
RT 186,23,38912
Mvvvs 152,196,64
RT 188,23,40960
v_add_u32_e64 v8, 8, v6
Mvvvs 156,196,68
LW 7
RT 190,23,43008
v_add_u32 v20, 98304, v24
Mvvvs 152,200,72
buffer_store_dword v8, v5, s[4:7], s71 offen sc1
Mvvvs 156,200,76
RT 192,20,0
RT 194,20,2048
Mvvvs 152,204,80
RT 196,20,4096
Mvvvs 156,204,84
LW 7
RT 198,20,6144
Mvvvs 152,176,88
RT 200,20,8192
Mvvvs 156,176,92
RT 202,20,10240
Mvvas 152,180,192
RT 204,20,12288
Mvvas 156,180,196
LW 7
RT 206,20,14336
Mvvas 152,184,200
RT 176,20,16384
Mvvas 156,184,204
RT 178,20,18432
Mvvas 152,188,208
RT 180,20,20480
Mvvas 156,188,212
LW 7
RT 182,20,22528
Mvvvz 128,192,32
RT 184,20,24576
Mvvvz 132,192,36
RT 186,20,26624
Mvvvs 128,196,40
RT 188,20,28672
Mvvvs 132,196,44
LW 7
RT 190,20,30720
Mvvvs 128,200,48
RT 192,20,32768
Mvvvs 132,200,52
RT 194,20,34816
Mvvvs 128,204,56
RT 196,20,36864
CV 168,144,145
Mvvvs 132,204,60
LW 7
RT 198,20,38912
Mvvvs 128,176,64
RT 200,20,40960
CV 169,146,147
Mvvvs 132,176,68
RT 202,20,43008
v_add_u32 v21, 98304, v25
Mvvvs 128,180,72
RT 204,21,0
CV 170,152,153
Mvvvs 132,180,76
LW 7
RT 206,21,2048
Mvvvs 128,184,80
RT 176,21,4096
CV 171,154,155
Mvvvs 132,184,84
RT 178,21,6144
s_add_u32 s76, s60, 147456
Mvvvs 128,188,88
RT 180,21,8192
Mvvvs 132,188,92
LW 7
RT 182,21,10240
Mvvas 128,192,192
buffer_store_dwordx4 v[168:171], v4, s[4:7], s76 offen sc1
Mvvas 132,192,196
RT 184,21,12288
RT 186,21,14336
Mvvas 128,196,200
RT 188,21,16384
CV 172,148,149
Mvvas 132,196,204
LW 7
RT 190,21,18432
Mvvas 128,200,208
RT 192,21,20480
CV 173,150,151
Mvvas 132,200,212
RT 194,21,22528
CV 174,156,157
Mvvvz 136,204,32
RT 196,21,24576
CV 175,158,159
Mvvvz 140,204,36
LW 7
RT 198,21,26624
Mvvvs 136,176,40
buffer_store_dwordx4 v[172:175], v28, s[4:7], s76 offen sc1
Mvvvs 140,176,44
RT 200,21,28672
RT 202,21,30720
Mvvvs 136,180,48
RT 204,21,32768
Mvvvs 140,180,52
LW 7
RT 206,21,34816
Mvvvs 136,184,56
RT 176,21,36864
Mvvvs 140,184,60
RT 178,21,38912
Mvvvs 136,188,64
RT 180,21,40960
Mvvvs 140,188,68
LW 7
RT 182,21,43008
v_add_u32 v22, 98304, v26
Mvvvs 136,192,72
RT 184,22,0
Mvvvs 140,192,76
RT 186,22,2048
Mvvvs 136,196,80
RT 188,22,4096
Mvvvs 140,196,84
LW 7
RT 190,22,6144
Mvvvs 136,200,88
RT 192,22,8192
Mvvvs 140,200,92
RT 194,22,10240
Mvvas 136,204,192
RT 196,22,12288
Mvvas 140,204,196
LW 7
RT 198,22,14336
Mvvas 136,176,200
RT 200,22,16384
Mvvas 140,176,204
RT 202,22,18432
Mvvas 136,180,208
RT 204,22,20480
Mvvas 140,180,212
LW 7
RT 206,22,22528
Mvvvz 144,184,32
RT 176,22,24576
Mvvvz 148,184,36
RT 178,22,26624
Mvvvs 144,188,40
RT 180,22,28672
Mvvvs 148,188,44
LW 7
RT 182,22,30720
Mvvvs 144,192,48
RT 184,22,32768
Mvvvs 148,192,52
RT 186,22,34816
Mvvvs 144,196,56
RT 188,22,36864
CV 160,128,129
Mvvvs 148,196,60
LW 7
RT 190,22,38912
Mvvvs 144,200,64
RT 192,22,40960
CV 161,130,131
Mvvvs 148,200,68
RT 194,22,43008
v_add_u32 v23, 98304, v27
Mvvvs 144,204,72
RT 196,23,0
CV 162,136,137
Mvvvs 148,204,76
LW 7
RT 198,23,2048
Mvvvs 144,176,80
RT 200,23,4096
CV 163,138,139
Mvvvs 148,176,84
RT 202,23,6144
s_add_u32 s76, s60, 163840
Mvvvs 144,180,88
RT 204,23,8192
Mvvvs 148,180,92
LW 7
RT 206,23,10240
Mvvas 144,184,192
buffer_store_dwordx4 v[160:163], v4, s[4:7], s76 offen sc1
Mvvas 148,184,196
RT 176,23,12288
RT 178,23,14336
Mvvas 144,188,200
RT 180,23,16384
CV 164,132,133
Mvvas 148,188,204
LW 7
RT 182,23,18432
Mvvas 144,192,208
RT 184,23,20480
CV 165,134,135
Mvvas 148,192,212
RT 186,23,22528
CV 166,140,141
Mvvvz 152,196,32
RT 188,23,24576
CV 167,142,143
Mvvvz 156,196,36
LW 7
RT 190,23,26624
Mvvvs 152,200,40
buffer_store_dwordx4 v[164:167], v28, s[4:7], s76 offen sc1
Mvvvs 156,200,44
RT 192,23,28672
RT 194,23,30720
Mvvvs 152,204,48
RT 196,23,32768
Mvvvs 156,204,52
LW 7
RT 198,23,34816
Mvvvs 152,176,56
RT 200,23,36864
Mvvvs 156,176,60
s_waitcnt vmcnt(2)
s_waitcnt vmcnt(6)
s_barrier
RT 202,23,38912
Mvvvs 152,180,64
RT 204,23,40960
v_add_u32 v9, 10, v6
Mvvvs 156,180,68
LW 7
RT 206,23,43008
v_add_u32 v20, 0, v24
Mvvvs 152,184,72
buffer_store_dword v9, v5, s[4:7], s71 offen sc1
Mvvvs 156,184,76
RT 176,20,0
RT 178,20,2048
Mvvvs 152,188,80
RT 180,20,4096
Mvvvs 156,188,84
LW 7
RT 182,20,6144
Mvvvs 152,192,88
RT 184,20,8192
Mvvvs 156,192,92
RT 186,20,10240
Mvvas 152,196,192
RT 188,20,12288
Mvvas 156,196,196
LW 7
RT 190,20,14336
Mvvas 152,200,200
RT 192,20,16384
Mvvas 156,200,204
RT 194,20,18432
Mvvas 152,204,208
RT 196,20,20480
Mvvas 156,204,212
LW 7
RT 198,20,22528
Mvvvz 128,176,32
RT 200,20,24576
Mvvvz 132,176,36
RT 202,20,26624
Mvvvs 128,180,40
RT 204,20,28672
Mvvvs 132,180,44
LW 7
RT 206,20,30720
Mvvvs 128,184,48
RT 176,20,32768
Mvvvs 132,184,52
RT 178,20,34816
Mvvvs 128,188,56
RT 180,20,36864
CV 168,144,145
Mvvvs 132,188,60
LW 7
RT 182,20,38912
Mvvvs 128,192,64
RT 184,20,40960
CV 169,146,147
Mvvvs 132,192,68
RT 186,20,43008
v_add_u32 v21, 0, v25
Mvvvs 128,196,72
RT 188,21,0
CV 170,152,153
Mvvvs 132,196,76
LW 7
RT 190,21,2048
Mvvvs 128,200,80
RT 192,21,4096
CV 171,154,155
Mvvvs 132,200,84
RT 194,21,6144
s_add_u32 s76, s60, 180224
Mvvvs 128,204,88
RT 196,21,8192
Mvvvs 132,204,92
LW 7
RT 198,21,10240
Mvvas 128,176,192
buffer_store_dwordx4 v[168:171], v4, s[4:7], s76 offen sc1
Mvvas 132,176,196
RT 200,21,12288
RT 202,21,14336
Mvvas 128,180,200
RT 204,21,16384
CV 172,148,149
Mvvas 132,180,204
LW 7
RT 206,21,18432
Mvvas 128,184,208
RT 176,21,20480
CV 173,150,151
Mvvas 132,184,212
RT 178,21,22528
CV 174,156,157
Mvvvz 136,188,32
RT 180,21,24576
CV 175,158,159
Mvvvz 140,188,36
LW 7
RT 182,21,26624
Mvvvs 136,192,40
buffer_store_dwordx4 v[172:175], v28, s[4:7], s76 offen sc1
Mvvvs 140,192,44
RT 184,21,28672
RT 186,21,30720
Mvvvs 136,196,48
RT 188,21,32768
Mvvvs 140,196,52
LW 7
RT 190,21,34816
Mvvvs 136,200,56
RT 192,21,36864
Mvvvs 140,200,60
RT 194,21,38912
Mvvvs 136,204,64
RT 196,21,40960
Mvvvs 140,204,68
LW 7
RT 198,21,43008
v_add_u32_e64 v22, 0, v26
Mvvvs 136,176,72
RT 200,22,0
Mvvvs 140,176,76
RT 202,22,2048
Mvvvs 136,180,80
RT 204,22,4096
Mvvvs 140,180,84
LW 7
RT 206,22,6144
Mvvvs 136,184,88
RT 176,22,8192
Mvvvs 140,184,92
RT 178,22,10240
Mvvas 136,188,192
RT 180,22,12288
Mvvas 140,188,196
LW 7
RT 182,22,14336
Mvvas 136,192,200
RT 184,22,16384
Mvvas 140,192,204
RT 186,22,18432
Mvvas 136,196,208
RT 188,22,20480
Mvvas 140,196,212
LW 7
RT 190,22,22528
Mvvvz 144,200,32
RT 192,22,24576
Mvvvz 148,200,36
RT 194,22,26624
Mvvvs 144,204,40
RT 196,22,28672
Mvvvs 148,204,44
LW 7
RT 198,22,30720
Mvvvs 144,176,48
RT 200,22,32768
Mvvvs 148,176,52
RT 202,22,34816
Mvvvs 144,180,56
RT 204,22,36864
CV 160,128,129
Mvvvs 148,180,60
LW 7
RT 206,22,38912
Mvvvs 144,184,64
RT 176,22,40960
CV 161,130,131
Mvvvs 148,184,68
RT 178,22,43008
v_add_u32 v23, 0, v27
Mvvvs 144,188,72
RT 180,23,0
CV 162,136,137
Mvvvs 148,188,76
LW 7
RT 182,23,2048
Mvvvs 144,192,80
RT 184,23,4096
CV 163,138,139
Mvvvs 148,192,84
RT 186,23,6144
s_add_u32 s76, s60, 196608
Mvvvs 144,196,88
RT 188,23,8192
Mvvvs 148,196,92
LW 7
RT 190,23,10240
Mvvas 144,200,192
buffer_store_dwordx4 v[160:163], v4, s[4:7], s76 offen sc1
Mvvas 148,200,196
RT 192,23,12288
RT 194,23,14336
Mvvas 144,204,200
RT 196,23,16384
CV 164,132,133
Mvvas 148,204,204
LW 7
RT 198,23,18432
Mvvas 144,176,208
RT 200,23,20480
CV 165,134,135
Mvvas 148,176,212
RT 202,23,22528
CV 166,140,141
Mvvvz 152,180,32
RT 204,23,24576
CV 167,142,143
Mvvvz 156,180,36
LW 7
RT 206,23,26624
Mvvvs 152,184,40
buffer_store_dwordx4 v[164:167], v28, s[4:7], s76 offen sc1
Mvvvs 156,184,44
RT 176,23,28672
RT 178,23,30720
Mvvvs 152,188,48
RT 180,23,32768
Mvvvs 156,188,52
LW 7
RT 182,23,34816
Mvvvs 152,192,56
RT 184,23,36864
Mvvvs 156,192,60
s_waitcnt vmcnt(2)
s_barrier
RT 186,23,38912
Mvvvs 152,196,64
RT 188,23,40960
v_add_u32 v8, 12, v6
Mvvvs 156,196,68
LW 7
RT 190,23,43008
Mvvvs 152,200,72
buffer_store_dword v8, v5, s[4:7], s71 offen sc1
Mvvvs 156,200,76
Mvvvs 152,204,80
Mvvvs 156,204,84
LW 4
Mvvvs 152,176,88
Mvvvs 156,176,92
Mvvas 152,180,192
Mvvas 156,180,196
LW 0
Mvvas 152,184,200
Mvvas 156,184,204
Mvvas 152,188,208
Mvvas 156,188,212
s_nop 7
CV 168,144,145
CV 169,146,147
CV 170,152,153
CV 171,154,155
s_add_u32 s76, s60, 212992
buffer_store_dwordx4 v[168:171], v4, s[4:7], s76 offen sc1
CV 172,148,149
CV 173,150,151
CV 174,156,157
CV 175,158,159
buffer_store_dwordx4 v[172:175], v28, s[4:7], s76 offen sc1
EV_86:
s_load_dwordx4 s[76:79], s[0:1], 80
buffer_load_dword v7, v30, s[4:7], s70 offen sc1
s_waitcnt vmcnt(0)
s_barrier
v_add_u32_e64 v8, 14, v6
buffer_store_dword v8, v5, s[4:7], s71 offen sc1
LW 0
s_mov_b32 s12, s76
s_mov_b32 s13, s77
s_mov_b32 s14, 0x380
s_mov_b32 s15, 0x00020000
s_mov_b32 s8, s78
s_mov_b32 s9, s79
s_mov_b32 s10, 0x1c0000
s_mov_b32 s11, 0x00020000
s_add_u32 s57, s70, 0x10000
s_mov_b32 s59, 0
s_mov_b32 s60, 0xffff0000
v_and_b32_e64 v10, 15, v1
v_mul_u32_u24 v10, 896, v10
v_lshrrev_b32 v11, 4, v1
v_lshlrev_b32 v11, 3, v11
v_add_u32 v10, v10, v11
s_mov_b32 s61, 0
s_cmp_lg_u32 s44, 0
s_cbranch_scc1 RL_87
s_mov_b32 s75, 1
s_mov_b32 s73, 0
s_sub_u32 s74, 14, s75
s_branch RP_94
RP_92:
buffer_load_dword v7, v30, s[4:7], s70 offen sc1
s_waitcnt vmcnt(0)
RP_94:
v_sub_u32 v2, v7, v6
v_subrev_u32 v2, s75, v2
v_cmp_ge_u32 vcc, s74, v2
s_and_b32 s72, vcc_lo, 0xffff
s_cmp_eq_u32 s72, 0xffff
s_cbranch_scc1 RP_93
s_sleep 3
s_add_u32 s73, s73, 1
s_cmp_lt_u32 s73, 20000
s_cbranch_scc1 RP_92
RP_93:
RL_87:
v_mov_b32 v12, s59
s_cmp_lg_u32 s44, 0
s_cbranch_scc1 RS_88
s_cmp_lg_u32 s61, 0
s_cbranch_scc1 RV_91
v_mov_b32 v13, 1
buffer_atomic_add v13, v5, s[4:7], s57 offen sc0 sc1
buffer_load_dword v7, v30, s[4:7], s70 offen sc1
s_waitcnt vmcnt(0)
RV_91:
v_readfirstlane_b32 s58, v13
s_cmp_ge_u32 s58, 28
s_cbranch_scc1 RW_89
s_lshr_b32 s75, s58, 1
s_add_u32 s75, s75, 1
s_mov_b32 s73, 0
s_sub_u32 s74, 14, s75
s_branch RP_97
RP_95:
buffer_load_dword v7, v30, s[4:7], s70 offen sc1
s_waitcnt vmcnt(0)
RP_97:
v_sub_u32 v2, v7, v6
v_subrev_u32_e64 v2, s75, v2
v_cmp_ge_u32 vcc, s74, v2
s_and_b32 s72, vcc_lo, 0xffff
s_cmp_eq_u32 s72, 0xffff
s_cbranch_scc1 RP_96
s_sleep 3
s_add_u32 s73, s73, 1
s_cmp_lt_u32 s73, 20000
s_cbranch_scc1 RP_95
RP_96:
RW_89:
v_mov_b32_e64 v3, s58
ds_write_b32 v12, v3
LW 0
RS_88:
s_barrier
ds_read_b32 v3, v12
LW 0
v_readfirstlane_b32 s58, v3
s_xor_b32 s59, s59, 4
s_cmp_ge_u32 s58, 28
s_cbranch_scc1 RF_90
s_and_b32 s72, s58, 1
s_lshl_b32 s72, s72, 2
s_add_u32 s72, s72, s44
s_lshl_b32 s73, s48, 3
s_add_u32 s72, s72, s73
s_lshr_b32 s73, s58, 1
s_mul_i32 s74, s72, 14
s_add_u32 s74, s74, s73
s_lshl_b32 s74, s74, 14
s_add_u32 s74, s74, 0x4000000
buffer_load_dwordx4 v[32:35], v4, s[4:7], s74 offen offset:0 sc1
buffer_load_dwordx4 v[36:39], v4, s[4:7], s74 offen offset:1024 sc1
buffer_load_dwordx4 v[40:43], v4, s[4:7], s74 offen offset:2048 sc1
buffer_load_dwordx4 v[44:47], v4, s[4:7], s74 offen offset:3072 sc1
s_add_u32 s74, s74, 4096
buffer_load_dwordx4 v[48:51], v4, s[4:7], s74 offen offset:0 sc1
buffer_load_dwordx4 v[52:55], v4, s[4:7], s74 offen offset:1024 sc1
buffer_load_dwordx4 v[56:59], v4, s[4:7], s74 offen offset:2048 sc1
buffer_load_dwordx4 v[60:63], v4, s[4:7], s74 offen offset:3072 sc1
s_add_u32 s74, s74, 4096
buffer_load_dwordx4 v[64:67], v4, s[4:7], s74 offen offset:0 sc1
buffer_load_dwordx4 v[68:71], v4, s[4:7], s74 offen offset:1024 sc1
buffer_load_dwordx4 v[72:75], v4, s[4:7], s74 offen offset:2048 sc1
buffer_load_dwordx4 v[76:79], v4, s[4:7], s74 offen offset:3072 sc1
s_add_u32 s74, s74, 4096
buffer_load_dwordx4 v[80:83], v4, s[4:7], s74 offen offset:0 sc1
buffer_load_dwordx4 v[84:87], v4, s[4:7], s74 offen offset:1024 sc1
buffer_load_dwordx4 v[88:91], v4, s[4:7], s74 offen offset:2048 sc1
buffer_load_dwordx4 v[92:95], v4, s[4:7], s74 offen offset:3072 sc1
s_mul_i32 s72, s72, 14336
s_lshl_b32 s73, s73, 6
s_add_u32 s72, s72, s73
buffer_load_dwordx2 v[96:97], v10, s[36:39], s72 offen
buffer_load_dwordx2 v[98:99], v10, s[36:39], s72 offen offset:32
buffer_load_dwordx2 v[100:101], v11, s[12:15], s73 offen
buffer_load_dwordx2 v[102:103], v11, s[12:15], s73 offen offset:32
s_cmp_lt_u32 s58, 0
s_cselect_b32 s61, 1, 0
s_cbranch_scc0 RN_98
v_mov_b32 v13, 1
buffer_atomic_add v13, v5, s[4:7], s57 offen sc0 sc1
buffer_load_dword v7, v30, s[4:7], s70 offen sc1
RN_98:
s_waitcnt vmcnt(19)
v_lshlrev_b32 v16, 16, v32
v_and_b32 v17, s60, v32
v_lshlrev_b32 v18, 16, v33
v_and_b32 v19, s60, v33
v_lshlrev_b32 v20, 16, v34
v_and_b32 v21, s60, v34
v_lshlrev_b32 v22, 16, v35
v_and_b32 v23, s60, v35
s_waitcnt vmcnt(18)
v_lshlrev_b32 v14, 16, v36
v_and_b32 v15, s60, v36
v_add_f32 v16, v16, v14
v_add_f32 v17, v17, v15
v_lshlrev_b32 v14, 16, v37
v_and_b32 v15, s60, v37
v_add_f32 v18, v18, v14
v_add_f32 v19, v19, v15
v_lshlrev_b32 v14, 16, v38
v_and_b32 v15, s60, v38
v_add_f32 v20, v20, v14
v_add_f32 v21, v21, v15
v_lshlrev_b32 v14, 16, v39
v_and_b32 v15, s60, v39
v_add_f32 v22, v22, v14
v_add_f32 v23, v23, v15
s_waitcnt vmcnt(17)
v_lshlrev_b32 v14, 16, v40
v_and_b32 v15, s60, v40
v_add_f32 v16, v16, v14
v_add_f32 v17, v17, v15
v_lshlrev_b32 v14, 16, v41
v_and_b32 v15, s60, v41
v_add_f32 v18, v18, v14
v_add_f32 v19, v19, v15
v_lshlrev_b32 v14, 16, v42
v_and_b32 v15, s60, v42
v_add_f32 v20, v20, v14
v_add_f32 v21, v21, v15
v_lshlrev_b32 v14, 16, v43
v_and_b32 v15, s60, v43
v_add_f32 v22, v22, v14
v_add_f32 v23, v23, v15
s_waitcnt vmcnt(16)
v_lshlrev_b32 v14, 16, v44
v_and_b32 v15, s60, v44
v_add_f32 v16, v16, v14
v_add_f32 v17, v17, v15
v_lshlrev_b32 v14, 16, v45
v_and_b32 v15, s60, v45
v_add_f32 v18, v18, v14
v_add_f32 v19, v19, v15
v_lshlrev_b32 v14, 16, v46
v_and_b32 v15, s60, v46
v_add_f32 v20, v20, v14
v_add_f32 v21, v21, v15
v_lshlrev_b32 v14, 16, v47
v_and_b32 v15, s60, v47
v_add_f32 v22, v22, v14
v_add_f32 v23, v23, v15
s_waitcnt vmcnt(15)
v_lshlrev_b32 v14, 16, v48
v_and_b32 v15, s60, v48
v_add_f32 v16, v16, v14
v_add_f32 v17, v17, v15
v_lshlrev_b32 v14, 16, v49
v_and_b32 v15, s60, v49
v_add_f32 v18, v18, v14
v_add_f32 v19, v19, v15
v_lshlrev_b32 v14, 16, v50
v_and_b32 v15, s60, v50
v_add_f32 v20, v20, v14
v_add_f32 v21, v21, v15
v_lshlrev_b32 v14, 16, v51
v_and_b32 v15, s60, v51
v_add_f32 v22, v22, v14
v_add_f32 v23, v23, v15
s_waitcnt vmcnt(14)
v_lshlrev_b32 v14, 16, v52
v_and_b32 v15, s60, v52
v_add_f32 v16, v16, v14
v_add_f32 v17, v17, v15
v_lshlrev_b32 v14, 16, v53
v_and_b32 v15, s60, v53
v_add_f32 v18, v18, v14
v_add_f32 v19, v19, v15
v_lshlrev_b32 v14, 16, v54
v_and_b32 v15, s60, v54
v_add_f32 v20, v20, v14
v_add_f32 v21, v21, v15
v_lshlrev_b32 v14, 16, v55
v_and_b32 v15, s60, v55
v_add_f32 v22, v22, v14
v_add_f32 v23, v23, v15
s_waitcnt vmcnt(13)
v_lshlrev_b32 v14, 16, v56
v_and_b32 v15, s60, v56
v_add_f32 v16, v16, v14
v_add_f32 v17, v17, v15
v_lshlrev_b32 v14, 16, v57
v_and_b32 v15, s60, v57
v_add_f32 v18, v18, v14
v_add_f32 v19, v19, v15
v_lshlrev_b32 v14, 16, v58
v_and_b32 v15, s60, v58
v_add_f32 v20, v20, v14
v_add_f32 v21, v21, v15
v_lshlrev_b32 v14, 16, v59
v_and_b32 v15, s60, v59
v_add_f32 v22, v22, v14
v_add_f32 v23, v23, v15
s_waitcnt vmcnt(12)
v_lshlrev_b32 v14, 16, v60
v_and_b32 v15, s60, v60
v_add_f32 v16, v16, v14
v_add_f32 v17, v17, v15
v_lshlrev_b32 v14, 16, v61
v_and_b32 v15, s60, v61
v_add_f32 v18, v18, v14
v_add_f32 v19, v19, v15
v_lshlrev_b32 v14, 16, v62
v_and_b32 v15, s60, v62
v_add_f32 v20, v20, v14
v_add_f32 v21, v21, v15
v_lshlrev_b32 v14, 16, v63
v_and_b32 v15, s60, v63
v_add_f32 v22, v22, v14
v_add_f32 v23, v23, v15
s_waitcnt vmcnt(11)
v_lshlrev_b32 v14, 16, v64
v_and_b32 v15, s60, v64
v_add_f32 v16, v16, v14
v_add_f32 v17, v17, v15
v_lshlrev_b32 v14, 16, v65
v_and_b32 v15, s60, v65
v_add_f32 v18, v18, v14
v_add_f32 v19, v19, v15
v_lshlrev_b32 v14, 16, v66
v_and_b32 v15, s60, v66
v_add_f32 v20, v20, v14
v_add_f32 v21, v21, v15
v_lshlrev_b32 v14, 16, v67
v_and_b32 v15, s60, v67
v_add_f32 v22, v22, v14
v_add_f32 v23, v23, v15
s_waitcnt vmcnt(10)
v_lshlrev_b32 v14, 16, v68
v_and_b32 v15, s60, v68
v_add_f32 v16, v16, v14
v_add_f32 v17, v17, v15
v_lshlrev_b32 v14, 16, v69
v_and_b32 v15, s60, v69
v_add_f32 v18, v18, v14
v_add_f32 v19, v19, v15
v_lshlrev_b32 v14, 16, v70
v_and_b32 v15, s60, v70
v_add_f32 v20, v20, v14
v_add_f32 v21, v21, v15
v_lshlrev_b32 v14, 16, v71
v_and_b32 v15, s60, v71
v_add_f32 v22, v22, v14
v_add_f32 v23, v23, v15
s_waitcnt vmcnt(9)
v_lshlrev_b32 v14, 16, v72
v_and_b32 v15, s60, v72
v_add_f32 v16, v16, v14
v_add_f32 v17, v17, v15
v_lshlrev_b32 v14, 16, v73
v_and_b32 v15, s60, v73
v_add_f32 v18, v18, v14
v_add_f32 v19, v19, v15
v_lshlrev_b32 v14, 16, v74
v_and_b32 v15, s60, v74
v_add_f32 v20, v20, v14
v_add_f32 v21, v21, v15
v_lshlrev_b32 v14, 16, v75
v_and_b32 v15, s60, v75
v_add_f32 v22, v22, v14
v_add_f32 v23, v23, v15
s_waitcnt vmcnt(8)
v_lshlrev_b32 v14, 16, v76
v_and_b32 v15, s60, v76
v_add_f32 v16, v16, v14
v_add_f32 v17, v17, v15
v_lshlrev_b32 v14, 16, v77
v_and_b32 v15, s60, v77
v_add_f32 v18, v18, v14
v_add_f32 v19, v19, v15
v_lshlrev_b32 v14, 16, v78
v_and_b32 v15, s60, v78
v_add_f32 v20, v20, v14
v_add_f32 v21, v21, v15
v_lshlrev_b32 v14, 16, v79
v_and_b32 v15, s60, v79
v_add_f32 v22, v22, v14
v_add_f32 v23, v23, v15
s_waitcnt vmcnt(7)
v_lshlrev_b32 v14, 16, v80
v_and_b32 v15, s60, v80
v_add_f32 v16, v16, v14
v_add_f32 v17, v17, v15
v_lshlrev_b32 v14, 16, v81
v_and_b32 v15, s60, v81
v_add_f32 v18, v18, v14
v_add_f32 v19, v19, v15
v_lshlrev_b32 v14, 16, v82
v_and_b32 v15, s60, v82
v_add_f32 v20, v20, v14
v_add_f32 v21, v21, v15
v_lshlrev_b32 v14, 16, v83
v_and_b32 v15, s60, v83
v_add_f32 v22, v22, v14
v_add_f32 v23, v23, v15
s_waitcnt vmcnt(6)
v_lshlrev_b32 v14, 16, v84
v_and_b32 v15, s60, v84
v_add_f32 v16, v16, v14
v_add_f32 v17, v17, v15
v_lshlrev_b32 v14, 16, v85
v_and_b32 v15, s60, v85
v_add_f32 v18, v18, v14
v_add_f32 v19, v19, v15
v_lshlrev_b32 v14, 16, v86
v_and_b32 v15, s60, v86
v_add_f32 v20, v20, v14
v_add_f32 v21, v21, v15
v_lshlrev_b32 v14, 16, v87
v_and_b32 v15, s60, v87
v_add_f32 v22, v22, v14
v_add_f32 v23, v23, v15
s_waitcnt vmcnt(5)
v_lshlrev_b32 v14, 16, v88
v_and_b32 v15, s60, v88
v_add_f32 v16, v16, v14
v_add_f32 v17, v17, v15
v_lshlrev_b32 v14, 16, v89
v_and_b32 v15, s60, v89
v_add_f32 v18, v18, v14
v_add_f32 v19, v19, v15
v_lshlrev_b32 v14, 16, v90
v_and_b32 v15, s60, v90
v_add_f32 v20, v20, v14
v_add_f32 v21, v21, v15
v_lshlrev_b32 v14, 16, v91
v_and_b32 v15, s60, v91
v_add_f32 v22, v22, v14
v_add_f32 v23, v23, v15
s_waitcnt vmcnt(4)
v_lshlrev_b32 v14, 16, v92
v_and_b32 v15, s60, v92
v_add_f32 v16, v16, v14
v_add_f32 v17, v17, v15
v_lshlrev_b32 v14, 16, v93
v_and_b32 v15, s60, v93
v_add_f32 v18, v18, v14
v_add_f32 v19, v19, v15
v_lshlrev_b32 v14, 16, v94
v_and_b32 v15, s60, v94
v_add_f32 v20, v20, v14
v_add_f32 v21, v21, v15
v_lshlrev_b32 v14, 16, v95
v_and_b32 v15, s60, v95
v_add_f32 v22, v22, v14
v_add_f32 v23, v23, v15
s_waitcnt vmcnt(2)
v_lshlrev_b32 v14, 16, v96
v_and_b32 v15, s60, v96
v_add_f32 v16, v16, v14
v_add_f32 v17, v17, v15
v_lshlrev_b32 v14, 16, v97
v_and_b32 v15, s60, v97
v_add_f32 v18, v18, v14
v_add_f32 v19, v19, v15
v_lshlrev_b32 v14, 16, v98
v_and_b32 v15, s60, v98
v_add_f32 v20, v20, v14
v_add_f32 v21, v21, v15
v_lshlrev_b32 v14, 16, v99
v_and_b32 v15, s60, v99
v_add_f32 v22, v22, v14
v_add_f32 v23, v23, v15
s_waitcnt vmcnt(0)
v_lshlrev_b32 v14, 16, v100
v_and_b32 v15, s60, v100
v_add_f32 v16, v16, v14
v_add_f32 v17, v17, v15
v_lshlrev_b32 v14, 16, v101
v_and_b32 v15, s60, v101
v_add_f32 v18, v18, v14
v_add_f32 v19, v19, v15
v_lshlrev_b32 v14, 16, v102
v_and_b32 v15, s60, v102
v_add_f32 v20, v20, v14
v_add_f32 v21, v21, v15
v_lshlrev_b32 v14, 16, v103
v_and_b32 v15, s60, v103
v_add_f32 v22, v22, v14
v_add_f32 v23, v23, v15
CV 24,16,17
CV 25,18,19
CV 26,20,21
CV 27,22,23
buffer_store_dwordx2 v[24:25], v10, s[8:11], s72 offen
buffer_store_dwordx2 v[26:27], v10, s[8:11], s72 offen offset:32
s_cmp_lt_u32 s58, 20
s_cbranch_scc1 RL_87
RF_90:
MEND_1:
s_endpgm
CS_36:
s_cselect_b32 s80, 1, 0
s_getpc_b64 s[84:85]
CP_99:
s_sub_u32 s84, s84, CP_99-CB_35
s_subb_u32 s85, s85, 0
s_branch RARE_27
CS_41:
s_cselect_b32 s80, 1, 0
s_getpc_b64 s[84:85]
CP_100:
s_sub_u32 s84, s84, CP_100-CB_40
s_subb_u32 s85, s85, 0
s_branch RARE_26
CS_43:
s_cselect_b32 s80, 1, 0
s_getpc_b64 s[84:85]
CP_101:
s_sub_u32 s84, s84, CP_101-CB_42
s_subb_u32 s85, s85, 0
s_branch RARE_25
CS_45:
s_cselect_b32 s80, 1, 0
s_getpc_b64 s[84:85]
CP_102:
s_sub_u32 s84, s84, CP_102-CB_44
s_subb_u32 s85, s85, 0
s_branch RARE_26
CS_47:
s_cselect_b32 s80, 1, 0
s_getpc_b64 s[84:85]
CP_103:
s_sub_u32 s84, s84, CP_103-CB_46
s_subb_u32 s85, s85, 0
s_branch RARE_25
CS_49:
s_cselect_b32 s80, 1, 0
s_getpc_b64 s[84:85]
CP_104:
s_sub_u32 s84, s84, CP_104-CB_48
s_subb_u32 s85, s85, 0
s_branch RARE_26
CS_51:
s_cselect_b32 s80, 1, 0
s_getpc_b64 s[84:85]
CP_105:
s_sub_u32 s84, s84, CP_105-CB_50
s_subb_u32 s85, s85, 0
s_branch RARE_25
CS_53:
s_cselect_b32 s80, 1, 0
s_getpc_b64 s[84:85]
CP_106:
s_sub_u32 s84, s84, CP_106-CB_52
s_subb_u32 s85, s85, 0
s_branch RARE_26
CS_62:
s_cselect_b32 s80, 1, 0
s_getpc_b64 s[84:85]
CP_107:
s_sub_u32 s84, s84, CP_107-CB_61
s_subb_u32 s85, s85, 0
s_branch RARE_27
CS_67:
s_cselect_b32 s80, 1, 0
s_getpc_b64 s[84:85]
CP_108:
s_sub_u32 s84, s84, CP_108-CB_66
s_subb_u32 s85, s85, 0
s_branch RARE_26
CS_69:
s_cselect_b32 s80, 1, 0
s_getpc_b64 s[84:85]
CP_109:
s_sub_u32 s84, s84, CP_109-CB_68
s_subb_u32 s85, s85, 0
s_branch RARE_25
CS_71:
s_cselect_b32 s80, 1, 0
s_getpc_b64 s[84:85]
CP_110:
s_sub_u32 s84, s84, CP_110-CB_70
s_subb_u32 s85, s85, 0
s_branch RARE_26
CS_73:
s_cselect_b32 s80, 1, 0
s_getpc_b64 s[84:85]
CP_111:
s_sub_u32 s84, s84, CP_111-CB_72
s_subb_u32 s85, s85, 0
s_branch RARE_25
CS_78:
s_cselect_b32 s80, 1, 0
s_getpc_b64 s[84:85]
CP_112:
s_sub_u32 s84, s84, CP_112-CB_77
s_subb_u32 s85, s85, 0
s_branch RARE_26
CS_80:
s_cselect_b32 s80, 1, 0
s_getpc_b64 s[84:85]
CP_113:
s_sub_u32 s84, s84, CP_113-CB_79
s_subb_u32 s85, s85, 0
s_branch RARE_25
CS_82:
s_cselect_b32 s80, 1, 0
s_getpc_b64 s[84:85]
CP_114:
s_sub_u32 s84, s84, CP_114-CB_81
s_subb_u32 s85, s85, 0
s_branch RARE_26
RARE_27:
s_nop 7
v_max3_f32 v22, v32, v33, v34
v_max3_f32 v22, v22, v35, v40
v_max3_f32 v22, v22, v41, v42
v_max_f32_e64 v22, v22, v43
ds_bpermute_b32 v29, v20, v22
LW 0
v_max_f32 v22, v22, v29
ds_bpermute_b32 v29, v21, v22
LW 0
v_max_f32 v22, v22, v29
v_sub_f32 v32, v32, v22
v_sub_f32 v33, v33, v22
v_sub_f32 v34, v34, v22
v_sub_f32 v35, v35, v22
v_sub_f32 v40, v40, v22
v_sub_f32 v41, v41, v22
v_sub_f32 v42, v42, v22
v_sub_f32 v43, v43, v22
v_sub_f32 v72, v72, v22
v_sub_f32 v73, v73, v22
v_sub_f32 v74, v74, v22
v_sub_f32 v75, v75, v22
v_max3_f32 v23, v36, v37, v38
v_max3_f32 v23, v23, v39, v44
v_max3_f32 v23, v23, v45, v46
v_max_f32_e64 v23, v23, v47
ds_bpermute_b32 v29, v20, v23
LW 0
v_max_f32 v23, v23, v29
ds_bpermute_b32 v29, v21, v23
LW 0
v_max_f32 v23, v23, v29
v_sub_f32 v36, v36, v23
v_sub_f32 v37, v37, v23
v_sub_f32 v38, v38, v23
v_sub_f32 v39, v39, v23
v_sub_f32 v44, v44, v23
v_sub_f32 v45, v45, v23
v_sub_f32 v46, v46, v23
v_sub_f32 v47, v47, v23
v_sub_f32 v76, v76, v23
v_sub_f32 v77, v77, v23
v_sub_f32 v78, v78, v23
v_sub_f32_e64 v79, v79, v23
s_nop 1
s_setpc_b64 s[84:85]
RARE_25:
s_nop 7
v_max3_f32 v22, v32, v33, v34
v_max3_f32 v22, v22, v35, v40
v_max3_f32 v22, v22, v41, v42
v_max_f32_e64 v22, v22, v43
ds_bpermute_b32 v29, v20, v22
LW 0
v_max_f32 v22, v22, v29
ds_bpermute_b32 v29, v21, v22
LW 0
v_max_f32 v22, v22, v29
v_max_f32 v22, 0, v22
v_sub_f32 v32, v32, v22
v_sub_f32 v33, v33, v22
v_sub_f32 v34, v34, v22
v_sub_f32 v35, v35, v22
v_sub_f32 v40, v40, v22
v_sub_f32 v41, v41, v22
v_sub_f32 v42, v42, v22
v_sub_f32 v43, v43, v22
v_sub_f32 v72, v72, v22
v_sub_f32 v73, v73, v22
v_sub_f32 v74, v74, v22
v_sub_f32_e64 v75, v75, v22
v_exp_f32 v24, -v22
s_nop 0
v_mul_f32 v80, v80, v24
v_mul_f32 v81, v81, v24
v_mul_f32 v82, v82, v24
v_mul_f32_e64 v83, v83, v24
AR 26,0
AR 27,1
AR 28,2
AR 2,3
v_mul_f32 v26, v26, v24
v_mul_f32 v27, v27, v24
v_mul_f32 v28, v28, v24
v_mul_f32 v2, v2, v24
AW 0,v26
AW 1,v27
AW 2,v28
AW 3,v2
AR 26,8
AR 27,9
AR 28,10
AR 2,11
v_mul_f32 v26, v26, v24
v_mul_f32 v27, v27, v24
v_mul_f32 v28, v28, v24
v_mul_f32 v2, v2, v24
AW 8,v26
AW 9,v27
AW 10,v28
AW 11,v2
AR 26,16
AR 27,17
AR 28,18
AR 2,19
v_mul_f32 v26, v26, v24
v_mul_f32 v27, v27, v24
v_mul_f32 v28, v28, v24
v_mul_f32 v2, v2, v24
AW 16,v26
AW 17,v27
AW 18,v28
AW 19,v2
AR 26,24
AR 27,25
AR 28,26
AR 2,27
v_mul_f32 v26, v26, v24
v_mul_f32 v27, v27, v24
v_mul_f32 v28, v28, v24
v_mul_f32 v2, v2, v24
AW 24,v26
AW 25,v27
AW 26,v28
AW 27,v2
AR 26,32
AR 27,33
AR 28,34
AR 2,35
v_mul_f32 v26, v26, v24
v_mul_f32 v27, v27, v24
v_mul_f32 v28, v28, v24
v_mul_f32 v2, v2, v24
AW 32,v26
AW 33,v27
AW 34,v28
AW 35,v2
AR 26,40
AR 27,41
AR 28,42
AR 2,43
v_mul_f32 v26, v26, v24
v_mul_f32 v27, v27, v24
v_mul_f32 v28, v28, v24
v_mul_f32 v2, v2, v24
AW 40,v26
AW 41,v27
AW 42,v28
AW 43,v2
AR 26,48
AR 27,49
AR 28,50
AR 2,51
v_mul_f32 v26, v26, v24
v_mul_f32 v27, v27, v24
v_mul_f32 v28, v28, v24
v_mul_f32 v2, v2, v24
AW 48,v26
AW 49,v27
AW 50,v28
AW 51,v2
AR 26,56
AR 27,57
AR 28,58
AR 2,59
v_mul_f32 v26, v26, v24
v_mul_f32 v27, v27, v24
v_mul_f32 v28, v28, v24
v_mul_f32 v2, v2, v24
AW 56,v26
AW 57,v27
AW 58,v28
AW 59,v2
AR 26,64
AR 27,65
AR 28,66
AR 2,67
v_mul_f32 v26, v26, v24
v_mul_f32 v27, v27, v24
v_mul_f32 v28, v28, v24
v_mul_f32 v2, v2, v24
AW 64,v26
AW 65,v27
AW 66,v28
AW 67,v2
AR 26,72
AR 27,73
AR 28,74
AR 2,75
v_mul_f32 v26, v26, v24
v_mul_f32 v27, v27, v24
v_mul_f32 v28, v28, v24
v_mul_f32 v2, v2, v24
AW 72,v26
AW 73,v27
AW 74,v28
AW 75,v2
AR 26,80
AR 27,81
AR 28,82
AR 2,83
v_mul_f32 v26, v26, v24
v_mul_f32 v27, v27, v24
v_mul_f32 v28, v28, v24
v_mul_f32 v2, v2, v24
AW 80,v26
AW 81,v27
AW 82,v28
AW 83,v2
AR 26,88
AR 27,89
AR 28,90
AR 2,91
v_mul_f32 v26, v26, v24
v_mul_f32 v27, v27, v24
v_mul_f32 v28, v28, v24
v_mul_f32 v2, v2, v24
AW 88,v26
AW 89,v27
AW 90,v28
AW 91,v2
AR 26,96
AR 27,97
AR 28,98
AR 2,99
v_mul_f32 v26, v26, v24
v_mul_f32 v27, v27, v24
v_mul_f32 v28, v28, v24
v_mul_f32 v2, v2, v24
AW 96,v26
AW 97,v27
AW 98,v28
AW 99,v2
AR 26,104
AR 27,105
AR 28,106
AR 2,107
v_mul_f32 v26, v26, v24
v_mul_f32 v27, v27, v24
v_mul_f32 v28, v28, v24
v_mul_f32 v2, v2, v24
AW 104,v26
AW 105,v27
AW 106,v28
AW 107,v2
AR 26,112
AR 27,113
AR 28,114
AR 2,115
v_mul_f32 v26, v26, v24
v_mul_f32 v27, v27, v24
v_mul_f32 v28, v28, v24
v_mul_f32 v2, v2, v24
AW 112,v26
AW 113,v27
AW 114,v28
AW 115,v2
AR 26,120
AR 27,121
AR 28,122
AR 2,123
v_mul_f32 v26, v26, v24
v_mul_f32 v27, v27, v24
v_mul_f32 v28, v28, v24
v_mul_f32 v2, v2, v24
AW 120,v26
AW 121,v27
AW 122,v28
AW 123,v2
v_max3_f32 v23, v36, v37, v38
v_max3_f32 v23, v23, v39, v44
v_max3_f32 v23, v23, v45, v46
v_max_f32_e64 v23, v23, v47
ds_bpermute_b32 v29, v20, v23
LW 0
v_max_f32 v23, v23, v29
ds_bpermute_b32 v29, v21, v23
LW 0
v_max_f32 v23, v23, v29
v_max_f32 v23, 0, v23
v_sub_f32 v36, v36, v23
v_sub_f32 v37, v37, v23
v_sub_f32 v38, v38, v23
v_sub_f32 v39, v39, v23
v_sub_f32 v44, v44, v23
v_sub_f32 v45, v45, v23
v_sub_f32 v46, v46, v23
v_sub_f32 v47, v47, v23
v_sub_f32 v76, v76, v23
v_sub_f32 v77, v77, v23
v_sub_f32 v78, v78, v23
v_sub_f32_e64 v79, v79, v23
v_exp_f32 v25, -v23
s_nop 0
v_mul_f32 v84, v84, v25
v_mul_f32 v85, v85, v25
v_mul_f32 v86, v86, v25
v_mul_f32_e64 v87, v87, v25
AR 26,4
AR 27,5
AR 28,6
AR 2,7
v_mul_f32 v26, v26, v25
v_mul_f32 v27, v27, v25
v_mul_f32 v28, v28, v25
v_mul_f32 v2, v2, v25
AW 4,v26
AW 5,v27
AW 6,v28
AW 7,v2
AR 26,12
AR 27,13
AR 28,14
AR 2,15
v_mul_f32 v26, v26, v25
v_mul_f32 v27, v27, v25
v_mul_f32 v28, v28, v25
v_mul_f32 v2, v2, v25
AW 12,v26
AW 13,v27
AW 14,v28
AW 15,v2
AR 26,20
AR 27,21
AR 28,22
AR 2,23
v_mul_f32 v26, v26, v25
v_mul_f32 v27, v27, v25
v_mul_f32 v28, v28, v25
v_mul_f32 v2, v2, v25
AW 20,v26
AW 21,v27
AW 22,v28
AW 23,v2
AR 26,28
AR 27,29
AR 28,30
AR 2,31
v_mul_f32 v26, v26, v25
v_mul_f32 v27, v27, v25
v_mul_f32 v28, v28, v25
v_mul_f32 v2, v2, v25
AW 28,v26
AW 29,v27
AW 30,v28
AW 31,v2
AR 26,36
AR 27,37
AR 28,38
AR 2,39
v_mul_f32 v26, v26, v25
v_mul_f32 v27, v27, v25
v_mul_f32 v28, v28, v25
v_mul_f32 v2, v2, v25
AW 36,v26
AW 37,v27
AW 38,v28
AW 39,v2
AR 26,44
AR 27,45
AR 28,46
AR 2,47
v_mul_f32 v26, v26, v25
v_mul_f32 v27, v27, v25
v_mul_f32 v28, v28, v25
v_mul_f32 v2, v2, v25
AW 44,v26
AW 45,v27
AW 46,v28
AW 47,v2
AR 26,52
AR 27,53
AR 28,54
AR 2,55
v_mul_f32 v26, v26, v25
v_mul_f32 v27, v27, v25
v_mul_f32 v28, v28, v25
v_mul_f32 v2, v2, v25
AW 52,v26
AW 53,v27
AW 54,v28
AW 55,v2
AR 26,60
AR 27,61
AR 28,62
AR 2,63
v_mul_f32 v26, v26, v25
v_mul_f32 v27, v27, v25
v_mul_f32 v28, v28, v25
v_mul_f32 v2, v2, v25
AW 60,v26
AW 61,v27
AW 62,v28
AW 63,v2
AR 26,68
AR 27,69
AR 28,70
AR 2,71
v_mul_f32 v26, v26, v25
v_mul_f32 v27, v27, v25
v_mul_f32 v28, v28, v25
v_mul_f32 v2, v2, v25
AW 68,v26
AW 69,v27
AW 70,v28
AW 71,v2
AR 26,76
AR 27,77
AR 28,78
AR 2,79
v_mul_f32 v26, v26, v25
v_mul_f32 v27, v27, v25
v_mul_f32 v28, v28, v25
v_mul_f32 v2, v2, v25
AW 76,v26
AW 77,v27
AW 78,v28
AW 79,v2
AR 26,84
AR 27,85
AR 28,86
AR 2,87
v_mul_f32 v26, v26, v25
v_mul_f32 v27, v27, v25
v_mul_f32 v28, v28, v25
v_mul_f32 v2, v2, v25
AW 84,v26
AW 85,v27
AW 86,v28
AW 87,v2
AR 26,92
AR 27,93
AR 28,94
AR 2,95
v_mul_f32 v26, v26, v25
v_mul_f32 v27, v27, v25
v_mul_f32 v28, v28, v25
v_mul_f32 v2, v2, v25
AW 92,v26
AW 93,v27
AW 94,v28
AW 95,v2
AR 26,100
AR 27,101
AR 28,102
AR 2,103
v_mul_f32 v26, v26, v25
v_mul_f32 v27, v27, v25
v_mul_f32 v28, v28, v25
v_mul_f32 v2, v2, v25
AW 100,v26
AW 101,v27
AW 102,v28
AW 103,v2
AR 26,108
AR 27,109
AR 28,110
AR 2,111
v_mul_f32 v26, v26, v25
v_mul_f32 v27, v27, v25
v_mul_f32 v28, v28, v25
v_mul_f32 v2, v2, v25
AW 108,v26
AW 109,v27
AW 110,v28
AW 111,v2
AR 26,116
AR 27,117
AR 28,118
AR 2,119
v_mul_f32 v26, v26, v25
v_mul_f32 v27, v27, v25
v_mul_f32 v28, v28, v25
v_mul_f32 v2, v2, v25
AW 116,v26
AW 117,v27
AW 118,v28
AW 119,v2
AR 26,124
AR 27,125
AR 28,126
AR 2,127
v_mul_f32 v26, v26, v25
v_mul_f32 v27, v27, v25
v_mul_f32 v28, v28, v25
v_mul_f32 v2, v2, v25
AW 124,v26
AW 125,v27
AW 126,v28
AW 127,v2
s_nop 1
s_cmp_lg_u32 s80, 0
s_setpc_b64 s[84:85]
RARE_26:
s_nop 7
v_max3_f32 v22, v48, v49, v50
v_max3_f32 v22, v22, v51, v56
v_max3_f32 v22, v22, v57, v58
v_max_f32_e64 v22, v22, v59
ds_bpermute_b32 v29, v20, v22
LW 0
v_max_f32 v22, v22, v29
ds_bpermute_b32 v29, v21, v22
LW 0
v_max_f32 v22, v22, v29
v_max_f32 v22, 0, v22
v_sub_f32 v48, v48, v22
v_sub_f32 v49, v49, v22
v_sub_f32 v50, v50, v22
v_sub_f32 v51, v51, v22
v_sub_f32 v56, v56, v22
v_sub_f32 v57, v57, v22
v_sub_f32 v58, v58, v22
v_sub_f32 v59, v59, v22
v_sub_f32 v72, v72, v22
v_sub_f32 v73, v73, v22
v_sub_f32 v74, v74, v22
v_sub_f32_e64 v75, v75, v22
v_exp_f32 v24, -v22
s_nop 0
v_mul_f32 v80, v80, v24
v_mul_f32 v81, v81, v24
v_mul_f32 v82, v82, v24
v_mul_f32_e64 v83, v83, v24
AR 26,0
AR 27,1
AR 28,2
AR 2,3
v_mul_f32 v26, v26, v24
v_mul_f32 v27, v27, v24
v_mul_f32 v28, v28, v24
v_mul_f32 v2, v2, v24
AW 0,v26
AW 1,v27
AW 2,v28
AW 3,v2
AR 26,8
AR 27,9
AR 28,10
AR 2,11
v_mul_f32 v26, v26, v24
v_mul_f32 v27, v27, v24
v_mul_f32 v28, v28, v24
v_mul_f32 v2, v2, v24
AW 8,v26
AW 9,v27
AW 10,v28
AW 11,v2
AR 26,16
AR 27,17
AR 28,18
AR 2,19
v_mul_f32 v26, v26, v24
v_mul_f32 v27, v27, v24
v_mul_f32 v28, v28, v24
v_mul_f32 v2, v2, v24
AW 16,v26
AW 17,v27
AW 18,v28
AW 19,v2
AR 26,24
AR 27,25
AR 28,26
AR 2,27
v_mul_f32 v26, v26, v24
v_mul_f32 v27, v27, v24
v_mul_f32 v28, v28, v24
v_mul_f32 v2, v2, v24
AW 24,v26
AW 25,v27
AW 26,v28
AW 27,v2
AR 26,32
AR 27,33
AR 28,34
AR 2,35
v_mul_f32 v26, v26, v24
v_mul_f32 v27, v27, v24
v_mul_f32 v28, v28, v24
v_mul_f32 v2, v2, v24
AW 32,v26
AW 33,v27
AW 34,v28
AW 35,v2
AR 26,40
AR 27,41
AR 28,42
AR 2,43
v_mul_f32 v26, v26, v24
v_mul_f32 v27, v27, v24
v_mul_f32 v28, v28, v24
v_mul_f32 v2, v2, v24
AW 40,v26
AW 41,v27
AW 42,v28
AW 43,v2
AR 26,48
AR 27,49
AR 28,50
AR 2,51
v_mul_f32 v26, v26, v24
v_mul_f32 v27, v27, v24
v_mul_f32 v28, v28, v24
v_mul_f32 v2, v2, v24
AW 48,v26
AW 49,v27
AW 50,v28
AW 51,v2
AR 26,56
AR 27,57
AR 28,58
AR 2,59
v_mul_f32 v26, v26, v24
v_mul_f32 v27, v27, v24
v_mul_f32 v28, v28, v24
v_mul_f32 v2, v2, v24
AW 56,v26
AW 57,v27
AW 58,v28
AW 59,v2
AR 26,64
AR 27,65
AR 28,66
AR 2,67
v_mul_f32 v26, v26, v24
v_mul_f32 v27, v27, v24
v_mul_f32 v28, v28, v24
v_mul_f32 v2, v2, v24
AW 64,v26
AW 65,v27
AW 66,v28
AW 67,v2
AR 26,72
AR 27,73
AR 28,74
AR 2,75
v_mul_f32 v26, v26, v24
v_mul_f32 v27, v27, v24
v_mul_f32 v28, v28, v24
v_mul_f32 v2, v2, v24
AW 72,v26
AW 73,v27
AW 74,v28
AW 75,v2
AR 26,80
AR 27,81
AR 28,82
AR 2,83
v_mul_f32 v26, v26, v24
v_mul_f32 v27, v27, v24
v_mul_f32 v28, v28, v24
v_mul_f32 v2, v2, v24
AW 80,v26
AW 81,v27
AW 82,v28
AW 83,v2
AR 26,88
AR 27,89
AR 28,90
AR 2,91
v_mul_f32 v26, v26, v24
v_mul_f32 v27, v27, v24
v_mul_f32 v28, v28, v24
v_mul_f32 v2, v2, v24
AW 88,v26
AW 89,v27
AW 90,v28
AW 91,v2
AR 26,96
AR 27,97
AR 28,98
AR 2,99
v_mul_f32 v26, v26, v24
v_mul_f32 v27, v27, v24
v_mul_f32 v28, v28, v24
v_mul_f32 v2, v2, v24
AW 96,v26
AW 97,v27
AW 98,v28
AW 99,v2
AR 26,104
AR 27,105
AR 28,106
AR 2,107
v_mul_f32 v26, v26, v24
v_mul_f32 v27, v27, v24
v_mul_f32 v28, v28, v24
v_mul_f32 v2, v2, v24
AW 104,v26
AW 105,v27
AW 106,v28
AW 107,v2
AR 26,112
AR 27,113
AR 28,114
AR 2,115
v_mul_f32 v26, v26, v24
v_mul_f32 v27, v27, v24
v_mul_f32 v28, v28, v24
v_mul_f32 v2, v2, v24
AW 112,v26
AW 113,v27
AW 114,v28
AW 115,v2
AR 26,120
AR 27,121
AR 28,122
AR 2,123
v_mul_f32 v26, v26, v24
v_mul_f32 v27, v27, v24
v_mul_f32 v28, v28, v24
v_mul_f32 v2, v2, v24
AW 120,v26
AW 121,v27
AW 122,v28
AW 123,v2
v_max3_f32 v23, v52, v53, v54
v_max3_f32 v23, v23, v55, v60
v_max3_f32 v23, v23, v61, v62
v_max_f32_e64 v23, v23, v63
ds_bpermute_b32 v29, v20, v23
LW 0
v_max_f32 v23, v23, v29
ds_bpermute_b32 v29, v21, v23
LW 0
v_max_f32 v23, v23, v29
v_max_f32 v23, 0, v23
v_sub_f32 v52, v52, v23
v_sub_f32 v53, v53, v23
v_sub_f32 v54, v54, v23
v_sub_f32 v55, v55, v23
v_sub_f32 v60, v60, v23
v_sub_f32 v61, v61, v23
v_sub_f32 v62, v62, v23
v_sub_f32 v63, v63, v23
v_sub_f32 v76, v76, v23
v_sub_f32 v77, v77, v23
v_sub_f32 v78, v78, v23
v_sub_f32_e64 v79, v79, v23
v_exp_f32 v25, -v23
s_nop 0
v_mul_f32 v84, v84, v25
v_mul_f32 v85, v85, v25
v_mul_f32 v86, v86, v25
v_mul_f32_e64 v87, v87, v25
AR 26,4
AR 27,5
AR 28,6
AR 2,7
v_mul_f32 v26, v26, v25
v_mul_f32 v27, v27, v25
v_mul_f32 v28, v28, v25
v_mul_f32 v2, v2, v25
AW 4,v26
AW 5,v27
AW 6,v28
AW 7,v2
AR 26,12
AR 27,13
AR 28,14
AR 2,15
v_mul_f32 v26, v26, v25
v_mul_f32 v27, v27, v25
v_mul_f32 v28, v28, v25
v_mul_f32 v2, v2, v25
AW 12,v26
AW 13,v27
AW 14,v28
AW 15,v2
AR 26,20
AR 27,21
AR 28,22
AR 2,23
v_mul_f32 v26, v26, v25
v_mul_f32 v27, v27, v25
v_mul_f32 v28, v28, v25
v_mul_f32 v2, v2, v25
AW 20,v26
AW 21,v27
AW 22,v28
AW 23,v2
AR 26,28
AR 27,29
AR 28,30
AR 2,31
v_mul_f32 v26, v26, v25
v_mul_f32 v27, v27, v25
v_mul_f32 v28, v28, v25
v_mul_f32 v2, v2, v25
AW 28,v26
AW 29,v27
AW 30,v28
AW 31,v2
AR 26,36
AR 27,37
AR 28,38
AR 2,39
v_mul_f32 v26, v26, v25
v_mul_f32 v27, v27, v25
v_mul_f32 v28, v28, v25
v_mul_f32 v2, v2, v25
AW 36,v26
AW 37,v27
AW 38,v28
AW 39,v2
AR 26,44
AR 27,45
AR 28,46
AR 2,47
v_mul_f32 v26, v26, v25
v_mul_f32 v27, v27, v25
v_mul_f32 v28, v28, v25
v_mul_f32 v2, v2, v25
AW 44,v26
AW 45,v27
AW 46,v28
AW 47,v2
AR 26,52
AR 27,53
AR 28,54
AR 2,55
v_mul_f32 v26, v26, v25
v_mul_f32 v27, v27, v25
v_mul_f32 v28, v28, v25
v_mul_f32 v2, v2, v25
AW 52,v26
AW 53,v27
AW 54,v28
AW 55,v2
AR 26,60
AR 27,61
AR 28,62
AR 2,63
v_mul_f32 v26, v26, v25
v_mul_f32 v27, v27, v25
v_mul_f32 v28, v28, v25
v_mul_f32 v2, v2, v25
AW 60,v26
AW 61,v27
AW 62,v28
AW 63,v2
AR 26,68
AR 27,69
AR 28,70
AR 2,71
v_mul_f32 v26, v26, v25
v_mul_f32 v27, v27, v25
v_mul_f32 v28, v28, v25
v_mul_f32 v2, v2, v25
AW 68,v26
AW 69,v27
AW 70,v28
AW 71,v2
AR 26,76
AR 27,77
AR 28,78
AR 2,79
v_mul_f32 v26, v26, v25
v_mul_f32 v27, v27, v25
v_mul_f32 v28, v28, v25
v_mul_f32 v2, v2, v25
AW 76,v26
AW 77,v27
AW 78,v28
AW 79,v2
AR 26,84
AR 27,85
AR 28,86
AR 2,87
v_mul_f32 v26, v26, v25
v_mul_f32 v27, v27, v25
v_mul_f32 v28, v28, v25
v_mul_f32 v2, v2, v25
AW 84,v26
AW 85,v27
AW 86,v28
AW 87,v2
AR 26,92
AR 27,93
AR 28,94
AR 2,95
v_mul_f32 v26, v26, v25
v_mul_f32 v27, v27, v25
v_mul_f32 v28, v28, v25
v_mul_f32 v2, v2, v25
AW 92,v26
AW 93,v27
AW 94,v28
AW 95,v2
AR 26,100
AR 27,101
AR 28,102
AR 2,103
v_mul_f32 v26, v26, v25
v_mul_f32 v27, v27, v25
v_mul_f32 v28, v28, v25
v_mul_f32 v2, v2, v25
AW 100,v26
AW 101,v27
AW 102,v28
AW 103,v2
AR 26,108
AR 27,109
AR 28,110
AR 2,111
v_mul_f32 v26, v26, v25
v_mul_f32 v27, v27, v25
v_mul_f32 v28, v28, v25
v_mul_f32 v2, v2, v25
AW 108,v26
AW 109,v27
AW 110,v28
AW 111,v2
AR 26,116
AR 27,117
AR 28,118
AR 2,119
v_mul_f32 v26, v26, v25
v_mul_f32 v27, v27, v25
v_mul_f32 v28, v28, v25
v_mul_f32 v2, v2, v25
AW 116,v26
AW 117,v27
AW 118,v28
AW 119,v2
AR 26,124
AR 27,125
AR 28,126
AR 2,127
v_mul_f32 v26, v26, v25
v_mul_f32 v27, v27, v25
v_mul_f32 v28, v28, v25
v_mul_f32 v2, v2, v25
AW 124,v26
AW 125,v27
AW 126,v28
AW 127,v2
s_nop 1
s_cmp_lg_u32 s80, 0
s_setpc_b64 s[84:85]
M_CODE_END:
.section .rodata,"a"
.p2align 6
.amdhsa_kernel parallel_sum__compressed_kv_cla__dense_activation_squared_relu__prompt_kernel
  .amdhsa_next_free_vgpr 512
  .amdhsa_next_free_sgpr 102
  .amdhsa_accum_offset 256
  .amdhsa_group_segment_fixed_size 0
  .amdhsa_kernarg_size 112
  .amdhsa_user_sgpr_count 2
  .amdhsa_user_sgpr_kernarg_segment_ptr 1
  .amdhsa_system_sgpr_workgroup_id_x 1
.end_amdhsa_kernel
```
